```python
import torch

def _softmax(x, axis=-1):
    return torch.softmax(x, dim=axis)
def _gelu(x):
    return torch.nn.functional.gelu(x, approximate="tanh")
def _silu(x):
    return torch.nn.functional.silu(x)
def _sigmoid(x):
    return torch.sigmoid(x)
def _layernorm(x, axis=-1, eps=1e-5):
    m = x.mean(dim=axis, keepdim=True)
    v = x.var(dim=axis, keepdim=True, unbiased=False)
    return (x - m) / torch.sqrt(v + eps)
def _scatter_add(tgt, idx, src, axis=0):
    return tgt.clone().index_add_(axis, idx, src)
def _segment_sum(src, seg, n):
    out = torch.zeros((n,) + src.shape[1:], dtype=src.dtype)
    return out.index_add_(0, seg, src)
def _pad(x, pw):
    flat = tuple(v for pair in reversed(pw) for v in pair)
    return torch.nn.functional.pad(x, flat)

kernel_name = 'recurrent_scan__sliding_block_cached__moe_arch_mod__prompt'

def setup_inputs():

    _w = (lambda a: (lambda t: t.to(torch.bfloat16) if t.is_floating_point() else t)(torch.as_tensor(a)))
    def _A_setup():
        B, Sq, D = 1, 2048, 512
        Hq, Hkv, Sk, Dh = 32, 32, 2048, 128
        assert Hq % Hkv == 0, (Hq, Hkv)
        return {
            "x": _w((lambda *s: torch.randn(*s, dtype=torch.bfloat16) * 0.05)(B, Sq, D)),
            "k_cache": _w((lambda *s: torch.randn(*s, dtype=torch.bfloat16) * 0.8)(B, Hkv, Sk, Dh)),
            "v_cache": _w((lambda *s: torch.randn(*s, dtype=torch.bfloat16) * 0.2)(B, Hkv, Sk, Dh)),
            "wq": _w((lambda *s: torch.randn(*s, dtype=torch.bfloat16) * 0.8)(D, Hq * Dh) * (D ** -0.5)),
            "wo": _w((lambda *s: torch.randn(*s, dtype=torch.bfloat16) * 0.2)(Hq * Dh, D) * ((Hq * Dh) ** -0.5)),
        }
    _A_in = _A_setup()

    def _B_setup():
        B, S, D, F, C = 1, 2048, 512, 1376, 2
        return {
            "x": _w((lambda *s: torch.randn(*s, dtype=torch.bfloat16) * 0.05)(B, S, D)),
            "w_r": _w((lambda *s: torch.randn(*s, dtype=torch.bfloat16) * 0.2)(D)),
            "w_gate": _w((lambda *s: torch.randn(*s, dtype=torch.bfloat16) * 0.1)(D, F)),
            "w_up": _w((lambda *s: torch.randn(*s, dtype=torch.bfloat16) * 0.1)(D, F)),
            "w_down": _w((lambda *s: torch.randn(*s, dtype=torch.bfloat16) * 0.1)(F, D)),
        }
    _B_in = _B_setup()

    return {
        "A_x": _A_in["x"],
        "A_k_cache": _A_in["k_cache"],
        "A_v_cache": _A_in["v_cache"],
        "A_wq": _A_in["wq"],
        "A_wo": _A_in["wo"],
        "B_x": _B_in["x"],
        "B_w_r": _B_in["w_r"],
        "B_w_gate": _B_in["w_gate"],
        "B_w_up": _B_in["w_up"],
        "B_w_down": _B_in["w_down"],
    }

def reference(A_x, A_k_cache, A_v_cache, A_wq, A_wo, B_x, B_w_r, B_w_gate, B_w_up, B_w_down):
    def _A_ref(x, k_cache, v_cache, wq, wo):
        B, Sq, D = x.shape
        Hq, Dh = 32, 128
        Hkv, Sk = k_cache.shape[1], k_cache.shape[2]
        W = min(4096, max(256, Sk // 4))
        rep = Hq // Hkv
        q = (lambda x, *d: x.permute(*d))((x @ wq).reshape(B, Sq, Hq, Dh), 0, 2, 1, 3)
        k = (lambda x, n, axis: torch.repeat_interleave(x, n, dim=axis))(k_cache[:, :, Sk - W:, :], rep, axis=1)
        v = (lambda x, n, axis: torch.repeat_interleave(x, n, dim=axis))(v_cache[:, :, Sk - W:, :], rep, axis=1)
        scores = torch.einsum("bhqd,bhkd->bhqk", q, k) * (Dh ** -0.5)
        p = _softmax(scores, axis=-1)
        o = torch.einsum("bhqk,bhkd->bhqd", p, v)
        return (lambda x, *d: x.permute(*d))(o, 0, 2, 1, 3).reshape(B, Sq, Hq * Dh) @ wo

    def _B_ref(x, w_r, w_gate, w_up, w_down):
        B, S, D = x.shape
        C = 2
        r = x @ w_r
        idx = torch.argsort(-r, axis=-1)[:, :C]
        idx_e = (lambda x, n, axis: torch.repeat_interleave(x, n, dim=axis))(idx.reshape(B, C, 1), D, axis=2)
        x_sel = (lambda x, i, axis: torch.take_along_dim(x, i, dim=axis))(x, idx_e, axis=1)
        g = _silu(x_sel @ w_gate)
        u = x_sel @ w_up
        y = (g * u) @ w_down
        r_sel = _sigmoid((lambda x, i, axis: torch.take_along_dim(x, i, dim=axis))(r, idx, axis=1))
        y = y * r_sel.reshape(B, C, 1)
        b_off = (torch.arange(B) * S).reshape(B, 1)
        flat_idx = (idx + b_off).reshape(B * C)
        zero = (x * 0.0).reshape(B * S, D)
        upd = _scatter_add(zero, flat_idx, y.reshape(B * C, D), axis=0)
        return x + upd.reshape(B, S, D)

    x = A_x
    xn = _layernorm(x, axis=-1)
    s = _A_ref(xn, A_k_cache, A_v_cache, A_wq, A_wo)
    g = _silu(_B_ref(xn, B_w_r, B_w_gate, B_w_up, B_w_down))
    return x + s * g
```

```asm
; @launch grid=(256,1,1) block=(256,1,1) lds=163840
.amdgcn_target "amdgcn-amd-amdhsa--gfx950"
.text
.globl recurrent_scan__sliding_block_cached__moe_arch_mod__prompt_kernel
.p2align 8
.type recurrent_scan__sliding_block_cached__moe_arch_mod__prompt_kernel,@function
recurrent_scan__sliding_block_cached__moe_arch_mod__prompt_kernel:
  s_cmp_ge_u32 s2, 256
  s_cbranch_scc1 L_end1
  s_memrealtime s[66:67]
  s_load_dwordx2 s[4:5], s[0:1], 0
  s_load_dwordx2 s[12:13], s[0:1], 24
  s_load_dwordx2 s[40:41], s[0:1], 48
  s_load_dwordx2 s[8:9], s[0:1], 96
  s_load_dwordx2 s[16:17], s[0:1], 8
  s_load_dwordx2 s[20:21], s[0:1], 16
  s_load_dwordx2 s[24:25], s[0:1], 32
  s_load_dwordx8 s[28:35], s[0:1], 56
  s_load_dwordx2 s[36:37], s[0:1], 88
  v_and_b32 v1, 63, v0
  v_lshrrev_b32 v2, 6, v0
  s_and_b32 s3, s2, 7
  s_lshr_b32 s59, s2, 3
  v_readfirstlane_b32 s44, v2
  s_lshr_b32 s47, s3, 1
  s_and_b32 s48, s3, 1
  s_lshl_b32 s48, s48, 3
  s_and_b32 s69, s59, 7
  s_add_u32 s48, s48, s69
  s_lshr_b32 s49, s59, 3
  s_lshl_b32 s3, s3, 2
  s_and_b32 s69, s59, 3
  s_add_u32 s45, s3, s69
  s_lshr_b32 s46, s59, 2
  s_mul_i32 s58, s46, 0
  s_and_b32 s58, s58, 7
  s_mul_i32 s52, s46, 0
  s_mul_i32 s3, s69, 0
  s_add_u32 s52, s52, s3
  s_and_b32 s3, s2, 7
  s_mul_i32 s3, s3, 2
  s_add_u32 s52, s52, s3
  s_mov_b32 s6, 0x200000
  s_mov_b32 s7, 0x00020000
  s_mov_b32 s14, 0x400000
  s_mov_b32 s15, 0x00020000
  s_mov_b32 s10, 0x10000000
  s_mov_b32 s11, 0x00020000
  v_lshrrev_b32 v2, 4, v1
  v_and_b32 v3, 15, v1
  v_lshlrev_b32 v28, 4, v1
  s_lshl_b32 s3, s46, 8
  s_lshl_b32 s59, s45, 3
  s_add_u32 s3, s3, s59
  s_lshl_b32 s59, s44, 1
  s_add_u32 s3, s3, s59
  v_lshrrev_b32 v128, 5, v1
  v_add_u32 v128, s3, v128
  v_and_b32 v129, 31, v1
  v_lshlrev_b32 v130, 4, v129
  v_lshl_add_u32 v131, v128, 10, v130
  v_lshlrev_b32 v29, 2, v2
  v_xor_b32 v29, v29, v3
  v_lshlrev_b32 v29, 4, v29
  v_lshl_add_u32 v26, v2, 13, v29
  v_add_u32 v27, 31744, v26
  v_and_b32 v29, 7, v1
  v_xor_b32 v29, v29, v2
  v_lshrrev_b32 v30, 3, v1
  v_lshlrev_b32 v30, 10, v30
  v_lshl_add_u32 v120, v29, 4, v30
  v_xor_b32 v29, 4, v29
  v_lshl_add_u32 v121, v29, 4, v30
  v_add_u32 v121, 7168, v121
  v_add_u32 v122, 14336, v120
  v_add_u32 v123, 14336, v121
  s_lshl_b32 s53, s45, 8
  s_lshl_b32 s3, s44, 16
  s_add_u32 s53, s53, s3
  s_lshl_b32 s55, s46, 18
  s_add_u32 s55, s55, s3
  s_lshl_b32 s57, s44, 11
  s_lshl_b32 s50, s44, 12
  s_lshl_b32 s51, s44, 13
  s_mov_b32 s18, 0x1000000
  s_mov_b32 s19, 0x00020000
  s_mov_b32 s22, 0x1000000
  s_mov_b32 s23, 0x00020000
  s_mov_b32 s26, 0x400000
  s_mov_b32 s27, 0x00020000
  s_lshl_b32 s60, s45, 19
  s_add_u32 s60, s60, 393216
  s_add_u32 s60, s60, s50
  s_waitcnt lgkmcnt(0)
  buffer_load_dwordx4 v[136:139], v131, s[4:7], 0 offen
  buffer_load_dwordx4 v[140:143], v131, s[4:7], 0 offen offset:512
  s_mov_b32 s38, 256
  s_mov_b32 s39, 0x00020000
  s_or_b32 s43, s66, 1
  v_mov_b32 v152, s43
  v_mov_b32 v110, 0
  s_or_b32 s3, s2, s44
  s_cmp_eq_u32 s3, 0
  s_cselect_b32 s3, 0, 0x1000
  buffer_store_dword v152, v110, s[36:39], s3 offen sc1
  s_add_u32 s59, s52, 0
  s_and_b32 s59, s59, 15
  s_lshl_b32 s54, s59, 18
  s_add_u32 s54, s54, s53
  s_add_u32 m0, s57, 0
  s_nop 0
  buffer_load_dwordx4 v26, s[12:15], s54 offen lds
  buffer_load_dwordx4 v27, s[12:15], s54 offen offset:1024 lds
  s_add_u32 s59, s52, 0
  s_and_b32 s59, s59, 15
  s_lshl_b32 s56, s59, 6
  s_add_u32 s56, s56, s55
  s_add_u32 m0, s51, 98304
  s_nop 0
  buffer_load_dwordx4 v120, s[4:7], s56 offen lds
  buffer_load_dwordx4 v121, s[4:7], s56 offen offset:1024 lds
  buffer_load_dwordx4 v122, s[4:7], s56 offen offset:2048 lds
  buffer_load_dwordx4 v123, s[4:7], s56 offen offset:3072 lds
  s_add_u32 s56, s56, 32768
  s_add_u32 m0, s51, 102400
  s_nop 0
  buffer_load_dwordx4 v120, s[4:7], s56 offen lds
  buffer_load_dwordx4 v121, s[4:7], s56 offen offset:1024 lds
  buffer_load_dwordx4 v122, s[4:7], s56 offen offset:2048 lds
  buffer_load_dwordx4 v123, s[4:7], s56 offen offset:3072 lds
  s_add_u32 s59, s52, 1
  s_and_b32 s59, s59, 15
  s_lshl_b32 s54, s59, 18
  s_add_u32 s54, s54, s53
  s_add_u32 m0, s57, 8192
  s_nop 0
  buffer_load_dwordx4 v26, s[12:15], s54 offen lds
  buffer_load_dwordx4 v27, s[12:15], s54 offen offset:1024 lds
  v_bfe_u32 v29, v1, 2, 2
  v_and_b32 v30, 3, v1
  v_lshl_add_u32 v31, v2, 3, v29
  v_lshlrev_b32 v31, 8, v31
  v_lshl_add_u32 v31, v30, 4, v31
  s_add_u32 s3, s44, 0
  s_and_b32 s3, s3, 3
  v_xor_b32 v4, s3, v29
  v_lshl_add_u32 v4, v4, 6, v31
  s_add_u32 s3, s44, 1
  s_and_b32 s3, s3, 3
  v_xor_b32 v5, s3, v29
  v_lshl_add_u32 v5, v5, 6, v31
  s_add_u32 s3, s44, 2
  s_and_b32 s3, s3, 3
  v_xor_b32 v6, s3, v29
  v_lshl_add_u32 v6, v6, 6, v31
  s_add_u32 s3, s44, 3
  s_and_b32 s3, s3, 3
  v_xor_b32 v7, s3, v29
  v_lshl_add_u32 v7, v7, 6, v31
  v_lshrrev_b32 v31, 1, v3
  v_xor_b32 v31, v31, v2
  v_lshlrev_b32 v13, 7, v3
  v_add_u32 v13, s51, v13
  v_add_u32 v13, 0x10000, v13
  v_lshl_add_u32 v12, v31, 4, v13
  v_xor_b32 v31, 4, v31
  v_lshl_add_u32 v13, v31, 4, v13
  v_add_u32 v14, 0x10000, v12
  v_add_u32 v15, 0x10000, v13
  v_mov_b32 v124, 0x3f803f80
  v_mov_b32 v125, 0x3f803f80
  v_mov_b32 v126, 0x3f803f80
  v_mov_b32 v127, 0x3f803f80
  v_lshlrev_b32 v109, 4, v128
  v_lshlrev_b32 v108, 3, v128
  v_sub_u32 v135, 0xffff, v128
  s_getpc_b64 s[68:69]
L_pc2:
  s_lshr_b32 s3, s2, 3
  s_lshl_b32 s3, s3, 2
  s_add_u32 s3, s3, s44
  s_lshl_b32 s3, s3, 9
  s_min_u32 s3, s3, L_end1-L_pc2-512
  v_lshl_add_u32 v133, v1, 3, s3
  s_waitcnt vmcnt(13)
  v_lshlrev_b32 v160, 16, v136
  v_and_b32 v161, 0xffff0000, v136
  v_lshlrev_b32 v162, 16, v137
  v_and_b32 v163, 0xffff0000, v137
  v_lshlrev_b32 v164, 16, v138
  v_and_b32 v165, 0xffff0000, v138
  v_lshlrev_b32 v166, 16, v139
  v_and_b32 v167, 0xffff0000, v139
  v_lshlrev_b32 v168, 16, v140
  v_and_b32 v169, 0xffff0000, v140
  v_lshlrev_b32 v170, 16, v141
  v_and_b32 v171, 0xffff0000, v141
  v_lshlrev_b32 v172, 16, v142
  v_and_b32 v173, 0xffff0000, v142
  v_lshlrev_b32 v174, 16, v143
  v_and_b32 v175, 0xffff0000, v143
  v_add_f32 v176, v160, v161
  v_add_f32 v177, v162, v163
  v_add_f32 v178, v164, v165
  v_add_f32 v179, v166, v167
  v_add_f32 v180, v168, v169
  v_add_f32 v181, v170, v171
  v_add_f32 v182, v172, v173
  v_add_f32 v183, v174, v175
  v_add_f32 v176, v176, v180
  v_add_f32 v177, v177, v181
  v_add_f32 v178, v178, v182
  v_add_f32 v179, v179, v183
  v_add_f32 v176, v176, v178
  v_add_f32 v177, v177, v179
  v_add_f32 v154, v176, v177
  s_nop 1
  v_add_f32_dpp v154, v154, v154 quad_perm:[1,0,3,2] row_mask:0xf bank_mask:0xf
  s_nop 1
  v_add_f32_dpp v154, v154, v154 quad_perm:[2,3,0,1] row_mask:0xf bank_mask:0xf
  s_nop 1
  v_add_f32_dpp v154, v154, v154 row_half_mirror row_mask:0xf bank_mask:0xf
  s_nop 1
  v_add_f32_dpp v154, v154, v154 row_mirror row_mask:0xf bank_mask:0xf
  v_mov_b32 v155, v154
  s_nop 1
  v_permlane16_swap_b32 v154, v155
  v_add_f32 v154, v154, v155
  v_mul_f32 v154, 0x3b000000, v154
  v_sub_f32 v176, v160, v154
  v_sub_f32 v177, v161, v154
  v_sub_f32 v178, v162, v154
  v_sub_f32 v179, v163, v154
  v_sub_f32 v180, v164, v154
  v_sub_f32 v181, v165, v154
  v_sub_f32 v182, v166, v154
  v_sub_f32 v183, v167, v154
  v_sub_f32 v184, v168, v154
  v_sub_f32 v185, v169, v154
  v_sub_f32 v186, v170, v154
  v_sub_f32 v187, v171, v154
  v_sub_f32 v188, v172, v154
  v_sub_f32 v189, v173, v154
  v_sub_f32 v190, v174, v154
  v_sub_f32 v191, v175, v154
  v_mul_f32 v155, v176, v176
  v_mul_f32 v158, v177, v177
  v_fmac_f32 v155, v178, v178
  v_fmac_f32 v158, v179, v179
  v_fmac_f32 v155, v180, v180
  v_fmac_f32 v158, v181, v181
  v_fmac_f32 v155, v182, v182
  v_fmac_f32 v158, v183, v183
  v_fmac_f32 v155, v184, v184
  v_fmac_f32 v158, v185, v185
  v_fmac_f32 v155, v186, v186
  v_fmac_f32 v158, v187, v187
  v_fmac_f32 v155, v188, v188
  v_fmac_f32 v158, v189, v189
  v_fmac_f32 v155, v190, v190
  v_fmac_f32 v158, v191, v191
  v_add_f32 v155, v155, v158
  s_nop 1
  v_add_f32_dpp v155, v155, v155 quad_perm:[1,0,3,2] row_mask:0xf bank_mask:0xf
  s_nop 1
  v_add_f32_dpp v155, v155, v155 quad_perm:[2,3,0,1] row_mask:0xf bank_mask:0xf
  s_nop 1
  v_add_f32_dpp v155, v155, v155 row_half_mirror row_mask:0xf bank_mask:0xf
  s_nop 1
  v_add_f32_dpp v155, v155, v155 row_mirror row_mask:0xf bank_mask:0xf
  v_mov_b32 v158, v155
  s_nop 1
  v_permlane16_swap_b32 v155, v158
  v_add_f32 v155, v155, v158
  v_mul_f32 v155, 0x3b000000, v155
  v_cvt_pk_bf16_f32 v158, v154, v155
  v_lshlrev_b32 v154, 16, v158
  v_and_b32 v155, 0xffff0000, v158
  v_add_f32 v155, 0x3727c5ac, v155
  global_load_dwordx4 v[144:147], v130, s[40:41]
  v_cvt_pk_bf16_f32 v155, v155, v155
  v_lshlrev_b32 v155, 16, v155
  v_sqrt_f32 v155, v155
  v_sub_f32 v176, v160, v154
  v_sub_f32 v177, v161, v154
  v_sub_f32 v178, v162, v154
  v_sub_f32 v179, v163, v154
  global_load_dwordx4 v[148:151], v130, s[40:41] offset:512
  v_sub_f32 v180, v164, v154
  v_sub_f32 v181, v165, v154
  v_sub_f32 v182, v166, v154
  v_sub_f32 v183, v167, v154
  v_sub_f32 v184, v168, v154
  v_sub_f32 v185, v169, v154
  v_sub_f32 v186, v170, v154
  global_load_dwordx2 a[254:255], v133, s[68:69]
  v_sub_f32 v187, v171, v154
  v_sub_f32 v188, v172, v154
  v_sub_f32 v189, v173, v154
  v_sub_f32 v190, v174, v154
  v_sub_f32 v191, v175, v154
  v_cvt_pk_bf16_f32 v104, v154, v155
  v_and_b32 v155, 0xffff0000, v104
  s_add_u32 s59, s52, 2
  s_and_b32 s59, s59, 15
  s_lshl_b32 s54, s59, 18
  s_add_u32 s54, s54, s53
  s_add_u32 m0, s57, 16384
  s_nop 0
  buffer_load_dwordx4 v26, s[12:15], s54 offen lds
  v_rcp_f32 v155, v155
  v_cvt_pk_bf16_f32 v136, v176, v177
  v_cvt_pk_bf16_f32 v137, v178, v179
  v_cvt_pk_bf16_f32 v138, v180, v181
  v_cvt_pk_bf16_f32 v139, v182, v183
  v_cvt_pk_bf16_f32 v140, v184, v185
  v_cvt_pk_bf16_f32 v141, v186, v187
  buffer_load_dwordx4 v27, s[12:15], s54 offen offset:1024 lds
  v_cvt_pk_bf16_f32 v142, v188, v189
  v_cvt_pk_bf16_f32 v143, v190, v191
  v_lshlrev_b32 v176, 16, v136
  v_and_b32 v177, 0xffff0000, v136
  v_lshlrev_b32 v178, 16, v137
  v_and_b32 v179, 0xffff0000, v137
  v_lshlrev_b32 v180, 16, v138
  s_add_u32 s59, s52, 3
  s_and_b32 s59, s59, 15
  s_lshl_b32 s54, s59, 18
  s_add_u32 s54, s54, s53
  s_add_u32 m0, s57, 24576
  s_nop 0
  buffer_load_dwordx4 v26, s[12:15], s54 offen lds
  v_and_b32 v181, 0xffff0000, v138
  v_lshlrev_b32 v182, 16, v139
  v_and_b32 v183, 0xffff0000, v139
  v_lshlrev_b32 v184, 16, v140
  v_and_b32 v185, 0xffff0000, v140
  v_lshlrev_b32 v186, 16, v141
  v_and_b32 v187, 0xffff0000, v141
  buffer_load_dwordx4 v27, s[12:15], s54 offen offset:1024 lds
  v_lshlrev_b32 v188, 16, v142
  v_and_b32 v189, 0xffff0000, v142
  v_lshlrev_b32 v190, 16, v143
  v_and_b32 v191, 0xffff0000, v143
  v_mul_f32 v176, v176, v155
  v_mul_f32 v177, v177, v155
  v_mul_f32 v178, v178, v155
  s_add_u32 s59, s52, 2
  s_and_b32 s59, s59, 15
  s_lshl_b32 s56, s59, 6
  s_add_u32 s56, s56, s55
  s_add_u32 m0, s51, 131072
  s_nop 0
  buffer_load_dwordx4 v120, s[4:7], s56 offen lds
  v_mul_f32 v179, v179, v155
  v_mul_f32 v180, v180, v155
  v_mul_f32 v181, v181, v155
  v_mul_f32 v182, v182, v155
  v_mul_f32 v183, v183, v155
  v_mul_f32 v184, v184, v155
  v_mul_f32 v185, v185, v155
  buffer_load_dwordx4 v121, s[4:7], s56 offen offset:1024 lds
  v_mul_f32 v186, v186, v155
  v_mul_f32 v187, v187, v155
  v_mul_f32 v188, v188, v155
  v_mul_f32 v189, v189, v155
  v_mul_f32 v190, v190, v155
  v_mul_f32 v191, v191, v155
  v_cvt_pk_bf16_f32 v136, v176, v177
  buffer_load_dwordx4 v122, s[4:7], s56 offen offset:2048 lds
  v_cvt_pk_bf16_f32 v137, v178, v179
  v_cvt_pk_bf16_f32 v138, v180, v181
  v_cvt_pk_bf16_f32 v139, v182, v183
  v_cvt_pk_bf16_f32 v140, v184, v185
  v_cvt_pk_bf16_f32 v141, v186, v187
  v_cvt_pk_bf16_f32 v142, v188, v189
  v_cvt_pk_bf16_f32 v143, v190, v191
  buffer_load_dwordx4 v123, s[4:7], s56 offen offset:3072 lds
  s_waitcnt vmcnt(11)
  s_barrier
  ds_read_b128 a[0:3], v12 offset:32768
  ds_read_b128 a[4:7], v12 offset:34816
  ds_read_b128 a[8:11], v12 offset:36864
  ds_read_b128 a[12:15], v12 offset:38912
  ds_read_b64_tr_b16 v[32:33], v4 offset:0
  ds_read_b64_tr_b16 v[34:35], v4 offset:1024
  ds_read_b64_tr_b16 v[36:37], v4 offset:8
  ds_read_b64_tr_b16 v[38:39], v4 offset:1032
  ds_read_b64_tr_b16 v[40:41], v5 offset:0
  ds_read_b64_tr_b16 v[42:43], v5 offset:1024
  ds_read_b64_tr_b16 v[44:45], v5 offset:8
  ds_read_b64_tr_b16 v[46:47], v5 offset:1032
  ds_read_b64_tr_b16 v[48:49], v6 offset:0
  ds_read_b64_tr_b16 v[50:51], v6 offset:1024
  ds_read_b64_tr_b16 v[52:53], v6 offset:8
  ds_read_b64_tr_b16 v[54:55], v6 offset:1032
  ds_read_b64_tr_b16 v[56:57], v7 offset:0
  ds_read_b64_tr_b16 v[58:59], v7 offset:1024
  ds_read_b64_tr_b16 v[60:61], v7 offset:8
  ds_read_b64_tr_b16 v[62:63], v7 offset:1032
  ds_read_b128 a[16:19], v13 offset:32768
  ds_read_b128 a[20:23], v13 offset:34816
  ds_read_b128 a[24:27], v13 offset:36864
  ds_read_b128 a[28:31], v13 offset:38912
  s_waitcnt vmcnt(9)
  v_mov_b32 v154, 0
  v_dot2c_f32_bf16 v154, v136, v144
  v_dot2c_f32_bf16 v154, v137, v145
  v_dot2c_f32_bf16 v154, v138, v146
  v_dot2c_f32_bf16 v154, v139, v147
  v_dot2c_f32_bf16 v154, v140, v148
  v_dot2c_f32_bf16 v154, v141, v149
  v_dot2c_f32_bf16 v154, v142, v150
  v_dot2c_f32_bf16 v154, v143, v151
  s_nop 2
  v_add_f32_dpp v154, v154, v154 quad_perm:[1,0,3,2] row_mask:0xf bank_mask:0xf
  s_nop 1
  v_add_f32_dpp v154, v154, v154 quad_perm:[2,3,0,1] row_mask:0xf bank_mask:0xf
  s_nop 1
  v_add_f32_dpp v154, v154, v154 row_half_mirror row_mask:0xf bank_mask:0xf
  s_nop 1
  v_add_f32_dpp v154, v154, v154 row_mirror row_mask:0xf bank_mask:0xf
  v_mov_b32 v155, v154
  s_nop 1
  v_permlane16_swap_b32 v154, v155
  v_add_f32 v154, v154, v155
  v_cvt_pk_bf16_f32 v154, v154, v154
  v_bfe_i32 v155, v154, 15, 1
  v_and_b32 v155, 0x7fff, v155
  v_or_b32 v155, 0x8000, v155
  v_xor_b32 v154, v154, v155
  v_lshl_or_b32 v106, v154, 16, v135
  s_waitcnt lgkmcnt(0)
  v_mfma_f32_16x16x32_bf16 v[128:131], v[32:35], a[0:3], 0
  s_lshl_b32 s3, s46, 2
  ds_read_b64_tr_b16 v[64:65], v4 offset:8192
  v_mfma_f32_16x16x32_bf16 v[132:135], v[32:35], a[4:7], 0
  s_add_u32 s56, s56, 32768
  ds_read_b64_tr_b16 v[66:67], v4 offset:9216
  v_mfma_f32_16x16x32_bf16 v[136:139], v[32:35], a[8:11], 0
  s_add_u32 s3, s3, s44
  v_mfma_f32_16x16x32_bf16 v[140:143], v[32:35], a[12:15], 0
  s_add_u32 m0, s51, 135168
  ds_read_b64_tr_b16 v[68:69], v4 offset:8200
  v_mfma_f32_16x16x32_bf16 v[96:99], v[32:35], v[124:127], 0
  s_mul_i32 s65, s3, 33
  v_mfma_f32_16x16x32_bf16 v[144:147], v[36:39], a[0:3], 0
  s_add_u32 s65, s65, s45
  ds_read_b64_tr_b16 v[70:71], v4 offset:9224
  v_mfma_f32_16x16x32_bf16 v[148:151], v[36:39], a[4:7], 0
  s_mul_i32 s65, s65, 17664
  ds_read_b64_tr_b16 v[72:73], v5 offset:8192
  v_mfma_f32_16x16x32_bf16 v[152:155], v[36:39], a[8:11], 0
  s_add_u32 s65, s65, 0x400000
  buffer_load_dwordx4 v120, s[4:7], s56 offen lds
  v_mfma_f32_16x16x32_bf16 v[156:159], v[36:39], a[12:15], 0
  s_lshl_b32 s63, s47, 20
  ds_read_b64_tr_b16 v[74:75], v5 offset:9216
  v_mfma_f32_16x16x32_bf16 v[100:103], v[36:39], v[124:127], 0
  s_lshl_b32 s3, s49, 8
  buffer_load_dwordx4 v121, s[4:7], s56 offen offset:1024 lds
  v_mfma_f32_16x16x32_bf16 v[160:163], v[40:43], a[0:3], 0
  s_add_u32 s63, s63, s3
  ds_read_b64_tr_b16 v[76:77], v5 offset:8200
  v_mfma_f32_16x16x32_bf16 v[164:167], v[40:43], a[4:7], 0
  s_and_b32 s3, s44, 1
  ds_read_b64_tr_b16 v[78:79], v5 offset:9224
  v_mfma_f32_16x16x32_bf16 v[168:171], v[40:43], a[8:11], 0
  s_lshl_b32 s3, s3, 7
  buffer_load_dwordx4 v122, s[4:7], s56 offen offset:2048 lds
  v_mfma_f32_16x16x32_bf16 v[172:175], v[40:43], a[12:15], 0
  s_add_u32 s63, s63, s3
  ds_read_b64_tr_b16 v[80:81], v6 offset:8192
  v_mfma_f32_16x16x32_bf16 v[176:179], v[44:47], a[0:3], 0
  s_lshl_b32 s3, s49, 1
  v_mfma_f32_16x16x32_bf16 v[180:183], v[44:47], a[4:7], 0
  s_add_u32 s3, s3, s48
  ds_read_b64_tr_b16 v[82:83], v6 offset:9216
  v_mfma_f32_16x16x32_bf16 v[184:187], v[44:47], a[8:11], 0
  s_mul_i32 s3, s3, 1
  ds_read_b64_tr_b16 v[84:85], v6 offset:8200
  v_mfma_f32_16x16x32_bf16 v[188:191], v[44:47], a[12:15], 0
  s_and_b32 s3, s3, 7
  buffer_load_dwordx4 v123, s[4:7], s56 offen offset:3072 lds
  v_mfma_f32_16x16x32_bf16 v[192:195], v[48:51], a[0:3], 0
  s_lshl_b32 s62, s3, 17
  ds_read_b64_tr_b16 v[86:87], v6 offset:9224
  v_mfma_f32_16x16x32_bf16 v[196:199], v[48:51], a[4:7], 0
  s_lshr_b32 s3, s44, 1
  buffer_load_dword v105, v110, s[36:39], 0 offen sc1
  v_mfma_f32_16x16x32_bf16 v[200:203], v[48:51], a[8:11], 0
  s_add_u32 s59, s52, 4
  ds_read_b64_tr_b16 v[88:89], v7 offset:8192
  v_mfma_f32_16x16x32_bf16 v[204:207], v[48:51], a[12:15], 0
  s_and_b32 s59, s59, 15
  ds_read_b64_tr_b16 v[90:91], v7 offset:9216
  v_mfma_f32_16x16x32_bf16 v[208:211], v[52:55], a[0:3], 0
  s_lshl_b32 s54, s59, 18
  v_mfma_f32_16x16x32_bf16 v[212:215], v[52:55], a[4:7], 0
  s_add_u32 s54, s54, s53
  ds_read_b64_tr_b16 v[92:93], v7 offset:8200
  v_mfma_f32_16x16x32_bf16 v[216:219], v[52:55], a[8:11], 0
  s_add_u32 m0, s57, 32768
  v_mfma_f32_16x16x32_bf16 v[220:223], v[52:55], a[12:15], 0
  s_lshl_b32 s3, s3, 19
  ds_read_b64_tr_b16 v[94:95], v7 offset:9224
  v_mfma_f32_16x16x32_bf16 v[224:227], v[56:59], a[0:3], 0
  s_xor_b32 s62, s62, s3
  buffer_load_dwordx4 v26, s[12:15], s54 offen lds
  v_mfma_f32_16x16x32_bf16 v[228:231], v[56:59], a[4:7], 0
  s_or_b32 s64, s62, s63
  buffer_load_dwordx4 v27, s[12:15], s54 offen offset:1024 lds
  v_mfma_f32_16x16x32_bf16 v[232:235], v[56:59], a[8:11], 0
  s_add_u32 s59, s52, 5
  v_mfma_f32_16x16x32_bf16 v[236:239], v[56:59], a[12:15], 0
  s_and_b32 s59, s59, 15
  v_mfma_f32_16x16x32_bf16 v[240:243], v[60:63], a[0:3], 0
  s_lshl_b32 s54, s59, 18
  v_mfma_f32_16x16x32_bf16 v[244:247], v[60:63], a[4:7], 0
  s_add_u32 s54, s54, s53
  v_mfma_f32_16x16x32_bf16 v[248:251], v[60:63], a[8:11], 0
  s_add_u32 m0, s57, 40960
  v_mfma_f32_16x16x32_bf16 v[252:255], v[60:63], a[12:15], 0
  s_waitcnt lgkmcnt(0)
  buffer_load_dwordx4 v26, s[12:15], s54 offen lds
  v_mfma_f32_16x16x32_bf16 v[128:131], v[64:67], a[16:19], v[128:131]
  s_waitcnt vmcnt(12)
  buffer_load_dwordx4 v27, s[12:15], s54 offen offset:1024 lds
  v_mfma_f32_16x16x32_bf16 v[132:135], v[64:67], a[20:23], v[132:135]
  s_barrier
  ds_read_b64_tr_b16 v[32:33], v4 offset:16384
  v_mfma_f32_16x16x32_bf16 v[136:139], v[64:67], a[24:27], v[136:139]
  s_add_u32 s59, s52, 4
  ds_read_b64_tr_b16 v[34:35], v4 offset:17408
  v_mfma_f32_16x16x32_bf16 v[140:143], v[64:67], a[28:31], v[140:143]
  s_and_b32 s59, s59, 15
  v_mfma_f32_16x16x32_bf16 v[96:99], v[64:67], v[124:127], v[96:99]
  s_mov_b64 s[40:41], 0
  ds_read_b64_tr_b16 v[36:37], v4 offset:16392
  v_mfma_f32_16x16x32_bf16 v[144:147], v[68:71], a[16:19], v[144:147]
  s_lshl_b32 s56, s59, 6
  ds_read_b64_tr_b16 v[38:39], v4 offset:17416
  v_mfma_f32_16x16x32_bf16 v[148:151], v[68:71], a[20:23], v[148:151]
  s_add_u32 s3, s44, 0
  v_mfma_f32_16x16x32_bf16 v[152:155], v[68:71], a[24:27], v[152:155]
  s_add_u32 s56, s56, s55
  ds_read_b64_tr_b16 v[40:41], v5 offset:16384
  v_mfma_f32_16x16x32_bf16 v[156:159], v[68:71], a[28:31], v[156:159]
  s_and_b32 s3, s3, 3
  v_mfma_f32_16x16x32_bf16 v[100:103], v[68:71], v[124:127], v[100:103]
  s_add_u32 m0, s51, 65536
  ds_read_b64_tr_b16 v[42:43], v5 offset:17408
  v_mfma_f32_16x16x32_bf16 v[160:163], v[72:75], a[16:19], v[160:163]
  s_lshl_b32 s3, s3, 2
  ds_read_b64_tr_b16 v[44:45], v5 offset:16392
  v_add_u32 v31, s3, v2
  v_mfma_f32_16x16x32_bf16 v[164:167], v[72:75], a[20:23], v[164:167]
  buffer_load_dwordx4 v120, s[4:7], s56 offen lds
  v_mfma_f32_16x16x32_bf16 v[168:171], v[72:75], a[24:27], v[168:171]
  ds_read_b64_tr_b16 v[46:47], v5 offset:17416
  v_xor_b32 v31, v31, v3
  v_mfma_f32_16x16x32_bf16 v[172:175], v[72:75], a[28:31], v[172:175]
  buffer_load_dwordx4 v121, s[4:7], s56 offen offset:1024 lds
  v_mfma_f32_16x16x32_bf16 v[176:179], v[76:79], a[16:19], v[176:179]
  ds_read_b64_tr_b16 v[48:49], v6 offset:16384
  v_lshlrev_b32 v31, 4, v31
  v_mfma_f32_16x16x32_bf16 v[180:183], v[76:79], a[20:23], v[180:183]
  ds_read_b64_tr_b16 v[50:51], v6 offset:17408
  buffer_load_dwordx4 v122, s[4:7], s56 offen offset:2048 lds
  v_mfma_f32_16x16x32_bf16 v[184:187], v[76:79], a[24:27], v[184:187]
  s_waitcnt vmcnt(8)
  ds_read_b128 a[32:35], v14 offset:0
  ds_read_b128 a[36:39], v14 offset:2048
  v_mfma_f32_16x16x32_bf16 v[188:191], v[76:79], a[28:31], v[188:191]
  ds_read_b64_tr_b16 v[52:53], v6 offset:16392
  ds_read_b128 a[40:43], v14 offset:4096
  v_mfma_f32_16x16x32_bf16 v[192:195], v[80:83], a[16:19], v[192:195]
  ds_read_b64_tr_b16 v[54:55], v6 offset:17416
  buffer_load_dwordx4 v123, s[4:7], s56 offen offset:3072 lds
  v_mfma_f32_16x16x32_bf16 v[196:199], v[80:83], a[20:23], v[196:199]
  ds_read_b128 a[44:47], v14 offset:6144
  v_lshl_add_u32 v8, v3, 8, v31
  v_mfma_f32_16x16x32_bf16 v[200:203], v[80:83], a[24:27], v[200:203]
  s_add_u32 s56, s56, 32768
  ds_read_b64_tr_b16 v[56:57], v7 offset:16384
  v_add_u32 v8, 0x10000, v8
  v_mfma_f32_16x16x32_bf16 v[204:207], v[80:83], a[28:31], v[204:207]
  s_add_u32 s3, s44, 1
  ds_read_b128 a[48:51], v15 offset:0
  ds_read_b128 a[52:55], v15 offset:2048
  v_mfma_f32_16x16x32_bf16 v[208:211], v[84:87], a[16:19], v[208:211]
  s_add_u32 m0, s51, 69632
  ds_read_b64_tr_b16 v[58:59], v7 offset:17408
  ds_read_b128 a[56:59], v15 offset:4096
  v_mfma_f32_16x16x32_bf16 v[212:215], v[84:87], a[20:23], v[212:215]
  s_and_b32 s3, s3, 3
  ds_read_b64_tr_b16 v[60:61], v7 offset:16392
  v_mfma_f32_16x16x32_bf16 v[216:219], v[84:87], a[24:27], v[216:219]
  s_lshl_b32 s3, s3, 2
  ds_read_b128 a[60:63], v15 offset:6144
  v_add_u32 v31, s3, v2
  v_mfma_f32_16x16x32_bf16 v[220:223], v[84:87], a[28:31], v[220:223]
  ds_read_b64_tr_b16 v[62:63], v7 offset:17416
  v_xor_b32 v31, v31, v3
  v_mfma_f32_16x16x32_bf16 v[224:227], v[88:91], a[16:19], v[224:227]
  buffer_load_dwordx4 v120, s[4:7], s56 offen lds
  v_mfma_f32_16x16x32_bf16 v[228:231], v[88:91], a[20:23], v[228:231]
  buffer_load_dwordx4 v121, s[4:7], s56 offen offset:1024 lds
  v_mfma_f32_16x16x32_bf16 v[232:235], v[88:91], a[24:27], v[232:235]
  buffer_load_dwordx4 v122, s[4:7], s56 offen offset:2048 lds
  v_mfma_f32_16x16x32_bf16 v[236:239], v[88:91], a[28:31], v[236:239]
  v_lshlrev_b32 v31, 4, v31
  v_lshl_add_u32 v9, v3, 8, v31
  v_mfma_f32_16x16x32_bf16 v[240:243], v[92:95], a[16:19], v[240:243]
  buffer_load_dwordx4 v123, s[4:7], s56 offen offset:3072 lds
  v_mfma_f32_16x16x32_bf16 v[244:247], v[92:95], a[20:23], v[244:247]
  s_add_u32 s59, s52, 6
  v_add_u32 v9, 0x10000, v9
  v_mfma_f32_16x16x32_bf16 v[248:251], v[92:95], a[24:27], v[248:251]
  s_add_u32 s3, s44, 2
  v_mfma_f32_16x16x32_bf16 v[252:255], v[92:95], a[28:31], v[252:255]
  s_waitcnt lgkmcnt(0)
  v_mfma_f32_16x16x32_bf16 v[128:131], v[32:35], a[32:35], v[128:131]
  s_and_b32 s59, s59, 15
  ds_read_b64_tr_b16 v[64:65], v4 offset:24576
  v_mfma_f32_16x16x32_bf16 v[132:135], v[32:35], a[36:39], v[132:135]
  s_lshl_b32 s56, s59, 6
  ds_read_b64_tr_b16 v[66:67], v4 offset:25600
  v_mfma_f32_16x16x32_bf16 v[136:139], v[32:35], a[40:43], v[136:139]
  s_and_b32 s3, s3, 3
  v_mfma_f32_16x16x32_bf16 v[140:143], v[32:35], a[44:47], v[140:143]
  s_add_u32 s56, s56, s55
  ds_read_b64_tr_b16 v[68:69], v4 offset:24584
  v_mfma_f32_16x16x32_bf16 v[96:99], v[32:35], v[124:127], v[96:99]
  s_lshl_b32 s3, s3, 2
  v_add_u32 v31, s3, v2
  v_xor_b32 v31, v31, v3
  v_mfma_f32_16x16x32_bf16 v[144:147], v[36:39], a[32:35], v[144:147]
  s_add_u32 m0, s51, 98304
  ds_read_b64_tr_b16 v[70:71], v4 offset:25608
  v_lshlrev_b32 v31, 4, v31
  v_mfma_f32_16x16x32_bf16 v[148:151], v[36:39], a[36:39], v[148:151]
  s_waitcnt vmcnt(12)
  ds_read_b64_tr_b16 v[72:73], v5 offset:24576
  v_lshl_add_u32 v10, v3, 8, v31
  v_cmp_eq_u32 vcc, 0, v105
  v_mfma_f32_16x16x32_bf16 v[152:155], v[36:39], a[40:43], v[152:155]
  s_cbranch_vccnz L_spin3
L_back5:
  buffer_load_dwordx4 v120, s[4:7], s56 offen lds
  v_mfma_f32_16x16x32_bf16 v[156:159], v[36:39], a[44:47], v[156:159]
  s_mov_b32 s69, 0x8000
  ds_read_b64_tr_b16 v[74:75], v5 offset:25600
  v_add_u32 v10, 0x10000, v10
  v_mfma_f32_16x16x32_bf16 v[100:103], v[36:39], v[124:127], v[100:103]
  s_add_u32 s3, s44, 3
  buffer_load_dwordx4 v121, s[4:7], s56 offen offset:1024 lds
  v_mfma_f32_16x16x32_bf16 v[160:163], v[40:43], a[32:35], v[160:163]
  s_and_b32 s3, s3, 3
  ds_read_b64_tr_b16 v[76:77], v5 offset:24584
  buffer_store_dwordx2 v[104:105], v109, s[8:11], s69 offen sc1
  v_mfma_f32_16x16x32_bf16 v[164:167], v[40:43], a[36:39], v[164:167]
  s_lshl_b32 s3, s3, 2
  ds_read_b64_tr_b16 v[78:79], v5 offset:25608
  v_add_u32 v31, s3, v2
  v_readfirstlane_b32 s43, v105
  v_mfma_f32_16x16x32_bf16 v[168:171], v[40:43], a[40:43], v[168:171]
  buffer_load_dwordx4 v122, s[4:7], s56 offen offset:2048 lds
  v_mov_b32 v107, v105
  v_mfma_f32_16x16x32_bf16 v[172:175], v[40:43], a[44:47], v[172:175]
  ds_read_b64_tr_b16 v[80:81], v6 offset:24576
  v_xor_b32 v31, v31, v3
  v_mfma_f32_16x16x32_bf16 v[176:179], v[44:47], a[32:35], v[176:179]
  buffer_load_dwordx4 v123, s[4:7], s56 offen offset:3072 lds
  v_mfma_f32_16x16x32_bf16 v[180:183], v[44:47], a[36:39], v[180:183]
  ds_read_b64_tr_b16 v[82:83], v6 offset:25600
  v_lshlrev_b32 v31, 4, v31
  v_mfma_f32_16x16x32_bf16 v[184:187], v[44:47], a[40:43], v[184:187]
  s_add_u32 s56, s56, 32768
  ds_read_b64_tr_b16 v[84:85], v6 offset:24584
  v_lshl_add_u32 v11, v3, 8, v31
  v_mfma_f32_16x16x32_bf16 v[188:191], v[44:47], a[44:47], v[188:191]
  v_add_u32 v11, 0x10000, v11
  v_add_u32 v31, 0, v2
  v_mfma_f32_16x16x32_bf16 v[192:195], v[48:51], a[32:35], v[192:195]
  s_add_u32 m0, s51, 102400
  ds_read_b64_tr_b16 v[86:87], v6 offset:25608
  v_xor_b32 v31, v31, v3
  v_mfma_f32_16x16x32_bf16 v[196:199], v[48:51], a[36:39], v[196:199]
  v_lshlrev_b32 v31, 4, v31
  v_lshl_add_u32 v20, v2, 8, v31
  v_mfma_f32_16x16x32_bf16 v[200:203], v[48:51], a[40:43], v[200:203]
  ds_read_b64_tr_b16 v[88:89], v7 offset:24576
  v_add_u32 v31, 4, v2
  v_mfma_f32_16x16x32_bf16 v[204:207], v[48:51], a[44:47], v[204:207]
  ds_read_b64_tr_b16 v[90:91], v7 offset:25600
  v_xor_b32 v31, v31, v3
  v_mfma_f32_16x16x32_bf16 v[208:211], v[52:55], a[32:35], v[208:211]
  buffer_load_dwordx4 v120, s[4:7], s56 offen lds
  v_mfma_f32_16x16x32_bf16 v[212:215], v[52:55], a[36:39], v[212:215]
  ds_read_b64_tr_b16 v[92:93], v7 offset:24584
  v_lshlrev_b32 v31, 4, v31
  v_mfma_f32_16x16x32_bf16 v[216:219], v[52:55], a[40:43], v[216:219]
  buffer_load_dwordx4 v121, s[4:7], s56 offen offset:1024 lds
  v_mfma_f32_16x16x32_bf16 v[220:223], v[52:55], a[44:47], v[220:223]
  ds_read_b64_tr_b16 v[94:95], v7 offset:25608
  v_lshl_add_u32 v21, v2, 8, v31
  v_mfma_f32_16x16x32_bf16 v[224:227], v[56:59], a[32:35], v[224:227]
  buffer_load_dwordx4 v122, s[4:7], s56 offen offset:2048 lds
  v_mfma_f32_16x16x32_bf16 v[228:231], v[56:59], a[36:39], v[228:231]
  buffer_load_dwordx4 v123, s[4:7], s56 offen offset:3072 lds
  v_mfma_f32_16x16x32_bf16 v[232:235], v[56:59], a[40:43], v[232:235]
  s_add_u32 s59, s52, 6
  v_add_u32 v31, 8, v2
  v_xor_b32 v31, v31, v3
  v_mfma_f32_16x16x32_bf16 v[236:239], v[56:59], a[44:47], v[236:239]
  s_and_b32 s59, s59, 15
  v_lshlrev_b32 v31, 4, v31
  v_lshl_add_u32 v22, v2, 8, v31
  v_mfma_f32_16x16x32_bf16 v[240:243], v[60:63], a[32:35], v[240:243]
  s_lshl_b32 s54, s59, 18
  v_add_u32 v31, 12, v2
  v_xor_b32 v31, v31, v3
  v_mfma_f32_16x16x32_bf16 v[244:247], v[60:63], a[36:39], v[244:247]
  s_add_u32 s54, s54, s53
  v_lshlrev_b32 v31, 4, v31
  v_lshl_add_u32 v23, v2, 8, v31
  v_mfma_f32_16x16x32_bf16 v[248:251], v[60:63], a[40:43], v[248:251]
  s_add_u32 m0, s57, 49152
  v_add_u32 v31, 0, v2
  v_lshlrev_b32 v31, 1, v31
  v_mfma_f32_16x16x32_bf16 v[252:255], v[60:63], a[44:47], v[252:255]
  s_waitcnt lgkmcnt(0)
  buffer_load_dwordx4 v26, s[12:15], s54 offen lds
  v_mfma_f32_16x16x32_bf16 v[128:131], v[64:67], a[48:51], v[128:131]
  s_waitcnt vmcnt(18)
  buffer_load_dwordx4 v27, s[12:15], s54 offen offset:1024 lds
  v_mfma_f32_16x16x32_bf16 v[132:135], v[64:67], a[52:55], v[132:135]
  s_barrier
  ds_read_b64_tr_b16 v[32:33], v4 offset:32768
  v_xor_b32 v31, v31, v3
  v_mfma_f32_16x16x32_bf16 v[136:139], v[64:67], a[56:59], v[136:139]
  s_add_u32 s59, s52, 7
  ds_read_b64_tr_b16 v[34:35], v4 offset:33792
  v_lshlrev_b32 v31, 4, v31
  v_mfma_f32_16x16x32_bf16 v[140:143], v[64:67], a[60:63], v[140:143]
  s_and_b32 s59, s59, 15
  v_lshl_add_u32 v24, v2, 8, v31
  v_add_u32 v31, 4, v2
  v_mfma_f32_16x16x32_bf16 v[96:99], v[64:67], v[124:127], v[96:99]
  s_lshl_b32 s54, s59, 18
  ds_read_b64_tr_b16 v[36:37], v4 offset:32776
  v_lshlrev_b32 v31, 1, v31
  v_mfma_f32_16x16x32_bf16 v[144:147], v[68:71], a[48:51], v[144:147]
  s_add_u32 s54, s54, s53
  ds_read_b64_tr_b16 v[38:39], v4 offset:33800
  v_xor_b32 v31, v31, v3
  v_mfma_f32_16x16x32_bf16 v[148:151], v[68:71], a[52:55], v[148:151]
  s_add_u32 m0, s57, 57344
  v_lshlrev_b32 v31, 4, v31
  v_lshl_add_u32 v25, v2, 8, v31
  v_mfma_f32_16x16x32_bf16 v[152:155], v[68:71], a[56:59], v[152:155]
  ds_read_b64_tr_b16 v[40:41], v5 offset:32768
  v_mfma_f32_16x16x32_bf16 v[156:159], v[68:71], a[60:63], v[156:159]
  buffer_load_dwordx4 v26, s[12:15], s54 offen lds
  v_mfma_f32_16x16x32_bf16 v[100:103], v[68:71], v[124:127], v[100:103]
  ds_read_b64_tr_b16 v[42:43], v5 offset:33792
  buffer_load_dwordx4 v27, s[12:15], s54 offen offset:1024 lds
  v_mfma_f32_16x16x32_bf16 v[160:163], v[72:75], a[48:51], v[160:163]
  s_add_u32 s59, s52, 8
  ds_read_b64_tr_b16 v[44:45], v5 offset:32776
  v_mfma_f32_16x16x32_bf16 v[164:167], v[72:75], a[52:55], v[164:167]
  s_and_b32 s59, s59, 15
  v_mfma_f32_16x16x32_bf16 v[168:171], v[72:75], a[56:59], v[168:171]
  s_lshl_b32 s54, s59, 18
  ds_read_b64_tr_b16 v[46:47], v5 offset:33800
  v_mfma_f32_16x16x32_bf16 v[172:175], v[72:75], a[60:63], v[172:175]
  s_add_u32 s54, s54, s53
  v_mfma_f32_16x16x32_bf16 v[176:179], v[76:79], a[48:51], v[176:179]
  s_add_u32 m0, s57, 0
  ds_read_b64_tr_b16 v[48:49], v6 offset:32768
  v_mfma_f32_16x16x32_bf16 v[180:183], v[76:79], a[52:55], v[180:183]
  ds_read_b64_tr_b16 v[50:51], v6 offset:33792
  buffer_load_dwordx4 v26, s[12:15], s54 offen lds
  v_mfma_f32_16x16x32_bf16 v[184:187], v[76:79], a[56:59], v[184:187]
  s_waitcnt vmcnt(14)
  ds_read_b128 a[64:67], v12 offset:0
  ds_read_b128 a[68:71], v12 offset:2048
  v_mfma_f32_16x16x32_bf16 v[188:191], v[76:79], a[60:63], v[188:191]
  ds_read_b64_tr_b16 v[52:53], v6 offset:32776
  ds_read_b128 a[72:75], v12 offset:4096
  v_mfma_f32_16x16x32_bf16 v[192:195], v[80:83], a[48:51], v[192:195]
  ds_read_b64_tr_b16 v[54:55], v6 offset:33800
  buffer_load_dwordx4 v27, s[12:15], s54 offen offset:1024 lds
  v_mfma_f32_16x16x32_bf16 v[196:199], v[80:83], a[52:55], v[196:199]
  s_add_u32 s59, s52, 9
  ds_read_b128 a[76:79], v12 offset:6144
  v_mfma_f32_16x16x32_bf16 v[200:203], v[80:83], a[56:59], v[200:203]
  s_and_b32 s59, s59, 15
  ds_read_b64_tr_b16 v[56:57], v7 offset:32768
  v_mfma_f32_16x16x32_bf16 v[204:207], v[80:83], a[60:63], v[204:207]
  s_lshl_b32 s54, s59, 18
  ds_read_b128 a[80:83], v13 offset:0
  ds_read_b128 a[84:87], v13 offset:2048
  v_mfma_f32_16x16x32_bf16 v[208:211], v[84:87], a[48:51], v[208:211]
  s_add_u32 s54, s54, s53
  ds_read_b64_tr_b16 v[58:59], v7 offset:33792
  ds_read_b128 a[88:91], v13 offset:4096
  v_mfma_f32_16x16x32_bf16 v[212:215], v[84:87], a[52:55], v[212:215]
  s_add_u32 m0, s57, 8192
  ds_read_b64_tr_b16 v[60:61], v7 offset:32776
  v_mfma_f32_16x16x32_bf16 v[216:219], v[84:87], a[56:59], v[216:219]
  ds_read_b128 a[92:95], v13 offset:6144
  buffer_load_dwordx4 v26, s[12:15], s54 offen lds
  v_mfma_f32_16x16x32_bf16 v[220:223], v[84:87], a[60:63], v[220:223]
  ds_read_b64_tr_b16 v[62:63], v7 offset:33800
  buffer_load_dwordx4 v27, s[12:15], s54 offen offset:1024 lds
  v_mfma_f32_16x16x32_bf16 v[224:227], v[88:91], a[48:51], v[224:227]
  s_add_u32 s59, s52, 8
  v_mfma_f32_16x16x32_bf16 v[228:231], v[88:91], a[52:55], v[228:231]
  v_mfma_f32_16x16x32_bf16 v[232:235], v[88:91], a[56:59], v[232:235]
  s_and_b32 s59, s59, 15
  v_mfma_f32_16x16x32_bf16 v[236:239], v[88:91], a[60:63], v[236:239]
  v_mfma_f32_16x16x32_bf16 v[240:243], v[92:95], a[48:51], v[240:243]
  s_lshl_b32 s56, s59, 6
  v_mfma_f32_16x16x32_bf16 v[244:247], v[92:95], a[52:55], v[244:247]
  v_mfma_f32_16x16x32_bf16 v[248:251], v[92:95], a[56:59], v[248:251]
  s_add_u32 s56, s56, s55
  v_mfma_f32_16x16x32_bf16 v[252:255], v[92:95], a[60:63], v[252:255]
  s_waitcnt lgkmcnt(0)
  v_mfma_f32_16x16x32_bf16 v[128:131], v[32:35], a[64:67], v[128:131]
  s_add_u32 m0, s51, 131072
  ds_read_b64_tr_b16 v[64:65], v4 offset:40960
  v_mfma_f32_16x16x32_bf16 v[132:135], v[32:35], a[68:71], v[132:135]
  ds_read_b64_tr_b16 v[66:67], v4 offset:41984
  v_mfma_f32_16x16x32_bf16 v[136:139], v[32:35], a[72:75], v[136:139]
  buffer_load_dwordx4 v120, s[4:7], s56 offen lds
  v_mfma_f32_16x16x32_bf16 v[140:143], v[32:35], a[76:79], v[140:143]
  ds_read_b64_tr_b16 v[68:69], v4 offset:40968
  v_mfma_f32_16x16x32_bf16 v[96:99], v[32:35], v[124:127], v[96:99]
  buffer_load_dwordx4 v121, s[4:7], s56 offen offset:1024 lds
  v_mfma_f32_16x16x32_bf16 v[144:147], v[36:39], a[64:67], v[144:147]
  ds_read_b64_tr_b16 v[70:71], v4 offset:41992
  v_mfma_f32_16x16x32_bf16 v[148:151], v[36:39], a[68:71], v[148:151]
  ds_read_b64_tr_b16 v[72:73], v5 offset:40960
  v_mfma_f32_16x16x32_bf16 v[152:155], v[36:39], a[72:75], v[152:155]
  buffer_load_dwordx4 v122, s[4:7], s56 offen offset:2048 lds
  v_mfma_f32_16x16x32_bf16 v[156:159], v[36:39], a[76:79], v[156:159]
  ds_read_b64_tr_b16 v[74:75], v5 offset:41984
  v_mfma_f32_16x16x32_bf16 v[100:103], v[36:39], v[124:127], v[100:103]
  buffer_load_dwordx4 v123, s[4:7], s56 offen offset:3072 lds
  v_mfma_f32_16x16x32_bf16 v[160:163], v[40:43], a[64:67], v[160:163]
  ds_read_b64_tr_b16 v[76:77], v5 offset:40968
  v_mfma_f32_16x16x32_bf16 v[164:167], v[40:43], a[68:71], v[164:167]
  s_add_u32 s56, s56, 32768
  ds_read_b64_tr_b16 v[78:79], v5 offset:41992
  v_mfma_f32_16x16x32_bf16 v[168:171], v[40:43], a[72:75], v[168:171]
  v_mfma_f32_16x16x32_bf16 v[172:175], v[40:43], a[76:79], v[172:175]
  s_add_u32 m0, s51, 135168
  ds_read_b64_tr_b16 v[80:81], v6 offset:40960
  v_mfma_f32_16x16x32_bf16 v[176:179], v[44:47], a[64:67], v[176:179]
  v_mfma_f32_16x16x32_bf16 v[180:183], v[44:47], a[68:71], v[180:183]
  ds_read_b64_tr_b16 v[82:83], v6 offset:41984
  buffer_load_dwordx4 v120, s[4:7], s56 offen lds
  v_mfma_f32_16x16x32_bf16 v[184:187], v[44:47], a[72:75], v[184:187]
  s_waitcnt vmcnt(13)
  ds_read_b64_tr_b16 v[84:85], v6 offset:40968
  v_mfma_f32_16x16x32_bf16 v[188:191], v[44:47], a[76:79], v[188:191]
  ds_read_b128 a[96:99], v12 offset:32768
  buffer_load_dwordx4 v121, s[4:7], s56 offen offset:1024 lds
  v_mfma_f32_16x16x32_bf16 v[192:195], v[48:51], a[64:67], v[192:195]
  ds_read_b64_tr_b16 v[86:87], v6 offset:41992
  v_mfma_f32_16x16x32_bf16 v[196:199], v[48:51], a[68:71], v[196:199]
  ds_read_b128 a[100:103], v12 offset:34816
  ds_read_b128 a[104:107], v12 offset:36864
  v_mfma_f32_16x16x32_bf16 v[200:203], v[48:51], a[72:75], v[200:203]
  ds_read_b64_tr_b16 v[88:89], v7 offset:40960
  ds_read_b128 a[108:111], v12 offset:38912
  v_mfma_f32_16x16x32_bf16 v[204:207], v[48:51], a[76:79], v[204:207]
  ds_read_b64_tr_b16 v[90:91], v7 offset:41984
  buffer_load_dwordx4 v122, s[4:7], s56 offen offset:2048 lds
  v_mfma_f32_16x16x32_bf16 v[208:211], v[52:55], a[64:67], v[208:211]
  ds_read_b128 a[112:115], v13 offset:32768
  buffer_load_dwordx4 v123, s[4:7], s56 offen offset:3072 lds
  v_mfma_f32_16x16x32_bf16 v[212:215], v[52:55], a[68:71], v[212:215]
  s_add_u32 s59, s52, 10
  ds_read_b64_tr_b16 v[92:93], v7 offset:40968
  v_mfma_f32_16x16x32_bf16 v[216:219], v[52:55], a[72:75], v[216:219]
  s_and_b32 s59, s59, 15
  ds_read_b128 a[116:119], v13 offset:34816
  v_mfma_f32_16x16x32_bf16 v[220:223], v[52:55], a[76:79], v[220:223]
  s_lshl_b32 s54, s59, 18
  ds_read_b64_tr_b16 v[94:95], v7 offset:41992
  v_mfma_f32_16x16x32_bf16 v[224:227], v[56:59], a[64:67], v[224:227]
  s_add_u32 s54, s54, s53
  ds_read_b128 a[120:123], v13 offset:36864
  v_mfma_f32_16x16x32_bf16 v[228:231], v[56:59], a[68:71], v[228:231]
  s_add_u32 m0, s57, 16384
  ds_read_b128 a[124:127], v13 offset:38912
  v_mfma_f32_16x16x32_bf16 v[232:235], v[56:59], a[72:75], v[232:235]
  buffer_load_dwordx4 v26, s[12:15], s54 offen lds
  v_mfma_f32_16x16x32_bf16 v[236:239], v[56:59], a[76:79], v[236:239]
  buffer_load_dwordx4 v27, s[12:15], s54 offen offset:1024 lds
  v_mfma_f32_16x16x32_bf16 v[240:243], v[60:63], a[64:67], v[240:243]
  v_mfma_f32_16x16x32_bf16 v[244:247], v[60:63], a[68:71], v[244:247]
  s_add_u32 s59, s52, 11
  v_mfma_f32_16x16x32_bf16 v[248:251], v[60:63], a[72:75], v[248:251]
  s_and_b32 s59, s59, 15
  v_mfma_f32_16x16x32_bf16 v[252:255], v[60:63], a[76:79], v[252:255]
  s_waitcnt lgkmcnt(0)
  s_lshl_b32 s54, s59, 18
  v_mfma_f32_16x16x32_bf16 v[128:131], v[64:67], a[80:83], v[128:131]
  s_waitcnt vmcnt(14)
  v_mfma_f32_16x16x32_bf16 v[132:135], v[64:67], a[84:87], v[132:135]
  s_barrier
  ds_read_b64_tr_b16 v[32:33], v4 offset:49152
  v_mfma_f32_16x16x32_bf16 v[136:139], v[64:67], a[88:91], v[136:139]
  s_add_u32 s54, s54, s53
  ds_read_b64_tr_b16 v[34:35], v4 offset:50176
  v_mfma_f32_16x16x32_bf16 v[140:143], v[64:67], a[92:95], v[140:143]
  s_add_u32 m0, s57, 24576
  v_mfma_f32_16x16x32_bf16 v[96:99], v[64:67], v[124:127], v[96:99]
  ds_read_b64_tr_b16 v[36:37], v4 offset:49160
  buffer_load_dwordx4 v26, s[12:15], s54 offen lds
  buffer_load_dwordx4 v27, s[12:15], s54 offen offset:1024 lds
  v_mfma_f32_16x16x32_bf16 v[144:147], v[68:71], a[80:83], v[144:147]
  s_add_u32 s59, s52, 10
  ds_read_b64_tr_b16 v[38:39], v4 offset:50184
  v_mfma_f32_16x16x32_bf16 v[148:151], v[68:71], a[84:87], v[148:151]
  v_mfma_f32_16x16x32_bf16 v[152:155], v[68:71], a[88:91], v[152:155]
  s_and_b32 s59, s59, 15
  ds_read_b64_tr_b16 v[40:41], v5 offset:49152
  v_mfma_f32_16x16x32_bf16 v[156:159], v[68:71], a[92:95], v[156:159]
  v_mfma_f32_16x16x32_bf16 v[100:103], v[68:71], v[124:127], v[100:103]
  s_lshl_b32 s56, s59, 6
  ds_read_b64_tr_b16 v[42:43], v5 offset:50176
  v_mfma_f32_16x16x32_bf16 v[160:163], v[72:75], a[80:83], v[160:163]
  ds_read_b64_tr_b16 v[44:45], v5 offset:49160
  v_mfma_f32_16x16x32_bf16 v[164:167], v[72:75], a[84:87], v[164:167]
  s_add_u32 s56, s56, s55
  v_mfma_f32_16x16x32_bf16 v[168:171], v[72:75], a[88:91], v[168:171]
  ds_read_b64_tr_b16 v[46:47], v5 offset:50184
  v_mfma_f32_16x16x32_bf16 v[172:175], v[72:75], a[92:95], v[172:175]
  s_add_u32 m0, s51, 65536
  v_mfma_f32_16x16x32_bf16 v[176:179], v[76:79], a[80:83], v[176:179]
  ds_read_b64_tr_b16 v[48:49], v6 offset:49152
  v_mfma_f32_16x16x32_bf16 v[180:183], v[76:79], a[84:87], v[180:183]
  ds_read_b64_tr_b16 v[50:51], v6 offset:50176
  v_mfma_f32_16x16x32_bf16 v[184:187], v[76:79], a[88:91], v[184:187]
  buffer_load_dwordx4 v120, s[4:7], s56 offen lds
  v_mfma_f32_16x16x32_bf16 v[188:191], v[76:79], a[92:95], v[188:191]
  ds_read_b64_tr_b16 v[52:53], v6 offset:49160
  v_mfma_f32_16x16x32_bf16 v[192:195], v[80:83], a[80:83], v[192:195]
  ds_read_b64_tr_b16 v[54:55], v6 offset:50184
  v_mfma_f32_16x16x32_bf16 v[196:199], v[80:83], a[84:87], v[196:199]
  buffer_load_dwordx4 v121, s[4:7], s56 offen offset:1024 lds
  v_mfma_f32_16x16x32_bf16 v[200:203], v[80:83], a[88:91], v[200:203]
  ds_read_b64_tr_b16 v[56:57], v7 offset:49152
  v_mfma_f32_16x16x32_bf16 v[204:207], v[80:83], a[92:95], v[204:207]
  buffer_load_dwordx4 v122, s[4:7], s56 offen offset:2048 lds
  v_mfma_f32_16x16x32_bf16 v[208:211], v[84:87], a[80:83], v[208:211]
  ds_read_b64_tr_b16 v[58:59], v7 offset:50176
  v_mfma_f32_16x16x32_bf16 v[212:215], v[84:87], a[84:87], v[212:215]
  ds_read_b64_tr_b16 v[60:61], v7 offset:49160
  v_mfma_f32_16x16x32_bf16 v[216:219], v[84:87], a[88:91], v[216:219]
  buffer_load_dwordx4 v123, s[4:7], s56 offen offset:3072 lds
  v_mfma_f32_16x16x32_bf16 v[220:223], v[84:87], a[92:95], v[220:223]
  s_add_u32 s56, s56, 32768
  ds_read_b64_tr_b16 v[62:63], v7 offset:50184
  v_mfma_f32_16x16x32_bf16 v[224:227], v[88:91], a[80:83], v[224:227]
  s_add_u32 m0, s51, 69632
  v_mfma_f32_16x16x32_bf16 v[228:231], v[88:91], a[84:87], v[228:231]
  v_mfma_f32_16x16x32_bf16 v[232:235], v[88:91], a[88:91], v[232:235]
  buffer_load_dwordx4 v120, s[4:7], s56 offen lds
  v_mfma_f32_16x16x32_bf16 v[236:239], v[88:91], a[92:95], v[236:239]
  v_mfma_f32_16x16x32_bf16 v[240:243], v[92:95], a[80:83], v[240:243]
  buffer_load_dwordx4 v121, s[4:7], s56 offen offset:1024 lds
  v_mfma_f32_16x16x32_bf16 v[244:247], v[92:95], a[84:87], v[244:247]
  v_mfma_f32_16x16x32_bf16 v[248:251], v[92:95], a[88:91], v[248:251]
  buffer_load_dwordx4 v122, s[4:7], s56 offen offset:2048 lds
  v_mfma_f32_16x16x32_bf16 v[252:255], v[92:95], a[92:95], v[252:255]
  s_waitcnt lgkmcnt(0)
  v_mfma_f32_16x16x32_bf16 v[128:131], v[32:35], a[96:99], v[128:131]
  ds_read_b64_tr_b16 v[64:65], v4 offset:57344
  v_mfma_f32_16x16x32_bf16 v[132:135], v[32:35], a[100:103], v[132:135]
  ds_read_b64_tr_b16 v[66:67], v4 offset:58368
  v_mfma_f32_16x16x32_bf16 v[136:139], v[32:35], a[104:107], v[136:139]
  buffer_load_dwordx4 v123, s[4:7], s56 offen offset:3072 lds
  v_mfma_f32_16x16x32_bf16 v[140:143], v[32:35], a[108:111], v[140:143]
  s_add_u32 s59, s52, 12
  ds_read_b64_tr_b16 v[68:69], v4 offset:57352
  v_mfma_f32_16x16x32_bf16 v[96:99], v[32:35], v[124:127], v[96:99]
  v_mfma_f32_16x16x32_bf16 v[144:147], v[36:39], a[96:99], v[144:147]
  s_and_b32 s59, s59, 15
  ds_read_b64_tr_b16 v[70:71], v4 offset:58376
  v_mfma_f32_16x16x32_bf16 v[148:151], v[36:39], a[100:103], v[148:151]
  ds_read_b64_tr_b16 v[72:73], v5 offset:57344
  v_mfma_f32_16x16x32_bf16 v[152:155], v[36:39], a[104:107], v[152:155]
  s_lshl_b32 s56, s59, 6
  v_mfma_f32_16x16x32_bf16 v[156:159], v[36:39], a[108:111], v[156:159]
  ds_read_b64_tr_b16 v[74:75], v5 offset:58368
  v_mfma_f32_16x16x32_bf16 v[100:103], v[36:39], v[124:127], v[100:103]
  s_add_u32 s56, s56, s55
  v_mfma_f32_16x16x32_bf16 v[160:163], v[40:43], a[96:99], v[160:163]
  ds_read_b64_tr_b16 v[76:77], v5 offset:57352
  v_mfma_f32_16x16x32_bf16 v[164:167], v[40:43], a[100:103], v[164:167]
  s_add_u32 m0, s51, 98304
  ds_read_b64_tr_b16 v[78:79], v5 offset:58376
  v_mfma_f32_16x16x32_bf16 v[168:171], v[40:43], a[104:107], v[168:171]
  v_mfma_f32_16x16x32_bf16 v[172:175], v[40:43], a[108:111], v[172:175]
  ds_read_b64_tr_b16 v[80:81], v6 offset:57344
  v_mfma_f32_16x16x32_bf16 v[176:179], v[44:47], a[96:99], v[176:179]
  buffer_load_dwordx4 v120, s[4:7], s56 offen lds
  v_mfma_f32_16x16x32_bf16 v[180:183], v[44:47], a[100:103], v[180:183]
  ds_read_b64_tr_b16 v[82:83], v6 offset:58368
  buffer_load_dwordx4 v121, s[4:7], s56 offen offset:1024 lds
  v_mfma_f32_16x16x32_bf16 v[184:187], v[44:47], a[104:107], v[184:187]
  s_waitcnt vmcnt(14)
  ds_read_b64_tr_b16 v[84:85], v6 offset:57352
  v_mfma_f32_16x16x32_bf16 v[188:191], v[44:47], a[108:111], v[188:191]
  ds_read_b128 a[128:131], v14 offset:0
  buffer_load_dwordx4 v122, s[4:7], s56 offen offset:2048 lds
  v_mfma_f32_16x16x32_bf16 v[192:195], v[48:51], a[96:99], v[192:195]
  ds_read_b64_tr_b16 v[86:87], v6 offset:58376
  v_mfma_f32_16x16x32_bf16 v[196:199], v[48:51], a[100:103], v[196:199]
  ds_read_b128 a[132:135], v14 offset:2048
  ds_read_b128 a[136:139], v14 offset:4096
  v_mfma_f32_16x16x32_bf16 v[200:203], v[48:51], a[104:107], v[200:203]
  ds_read_b64_tr_b16 v[88:89], v7 offset:57344
  ds_read_b128 a[140:143], v14 offset:6144
  v_mfma_f32_16x16x32_bf16 v[204:207], v[48:51], a[108:111], v[204:207]
  ds_read_b64_tr_b16 v[90:91], v7 offset:58368
  buffer_load_dwordx4 v123, s[4:7], s56 offen offset:3072 lds
  v_mfma_f32_16x16x32_bf16 v[208:211], v[52:55], a[96:99], v[208:211]
  s_add_u32 s56, s56, 32768
  ds_read_b128 a[144:147], v15 offset:0
  v_mfma_f32_16x16x32_bf16 v[212:215], v[52:55], a[100:103], v[212:215]
  ds_read_b64_tr_b16 v[92:93], v7 offset:57352
  v_mfma_f32_16x16x32_bf16 v[216:219], v[52:55], a[104:107], v[216:219]
  s_add_u32 m0, s51, 102400
  ds_read_b128 a[148:151], v15 offset:2048
  v_mfma_f32_16x16x32_bf16 v[220:223], v[52:55], a[108:111], v[220:223]
  ds_read_b64_tr_b16 v[94:95], v7 offset:58376
  v_mfma_f32_16x16x32_bf16 v[224:227], v[56:59], a[96:99], v[224:227]
  ds_read_b128 a[152:155], v15 offset:4096
  v_mfma_f32_16x16x32_bf16 v[228:231], v[56:59], a[100:103], v[228:231]
  ds_read_b128 a[156:159], v15 offset:6144
  v_mfma_f32_16x16x32_bf16 v[232:235], v[56:59], a[104:107], v[232:235]
  buffer_load_dwordx4 v120, s[4:7], s56 offen lds
  v_mfma_f32_16x16x32_bf16 v[236:239], v[56:59], a[108:111], v[236:239]
  buffer_load_dwordx4 v121, s[4:7], s56 offen offset:1024 lds
  v_mfma_f32_16x16x32_bf16 v[240:243], v[60:63], a[96:99], v[240:243]
  buffer_load_dwordx4 v122, s[4:7], s56 offen offset:2048 lds
  v_mfma_f32_16x16x32_bf16 v[244:247], v[60:63], a[100:103], v[244:247]
  v_mfma_f32_16x16x32_bf16 v[248:251], v[60:63], a[104:107], v[248:251]
  buffer_load_dwordx4 v123, s[4:7], s56 offen offset:3072 lds
  v_mfma_f32_16x16x32_bf16 v[252:255], v[60:63], a[108:111], v[252:255]
  s_waitcnt lgkmcnt(0)
  s_add_u32 s59, s52, 12
  v_mfma_f32_16x16x32_bf16 v[128:131], v[64:67], a[112:115], v[128:131]
  s_waitcnt vmcnt(28)
  v_mfma_f32_16x16x32_bf16 v[132:135], v[64:67], a[116:119], v[132:135]
  s_barrier
  ds_read_b64_tr_b16 v[32:33], v4 offset:0
  v_mfma_f32_16x16x32_bf16 v[136:139], v[64:67], a[120:123], v[136:139]
  s_and_b32 s59, s59, 15
  ds_read_b64_tr_b16 v[34:35], v4 offset:1024
  v_mfma_f32_16x16x32_bf16 v[140:143], v[64:67], a[124:127], v[140:143]
  s_lshl_b32 s54, s59, 18
  v_mfma_f32_16x16x32_bf16 v[96:99], v[64:67], v[124:127], v[96:99]
  s_add_u32 s54, s54, s53
  ds_read_b64_tr_b16 v[36:37], v4 offset:8
  v_mfma_f32_16x16x32_bf16 v[144:147], v[68:71], a[112:115], v[144:147]
  s_add_u32 m0, s57, 32768
  ds_read_b64_tr_b16 v[38:39], v4 offset:1032
  v_mfma_f32_16x16x32_bf16 v[148:151], v[68:71], a[116:119], v[148:151]
  s_waitcnt vmcnt(42)
  buffer_load_dwordx4 v26, s[12:15], s54 offen lds
  v_mfma_f32_16x16x32_bf16 v[152:155], v[68:71], a[120:123], v[152:155]
  ds_read_b64_tr_b16 v[40:41], v5 offset:0
  buffer_store_dwordx2 v[106:107], v108, s[8:11], 0 offen sc1
  v_mfma_f32_16x16x32_bf16 v[156:159], v[68:71], a[124:127], v[156:159]
  buffer_load_dwordx4 v27, s[12:15], s54 offen offset:1024 lds
  v_mfma_f32_16x16x32_bf16 v[100:103], v[68:71], v[124:127], v[100:103]
  s_add_u32 s59, s52, 13
  ds_read_b64_tr_b16 v[42:43], v5 offset:1024
  v_mfma_f32_16x16x32_bf16 v[160:163], v[72:75], a[112:115], v[160:163]
  s_and_b32 s59, s59, 15
  ds_read_b64_tr_b16 v[44:45], v5 offset:8
  v_mfma_f32_16x16x32_bf16 v[164:167], v[72:75], a[116:119], v[164:167]
  s_lshl_b32 s54, s59, 18
  v_mfma_f32_16x16x32_bf16 v[168:171], v[72:75], a[120:123], v[168:171]
  s_add_u32 s54, s54, s53
  ds_read_b64_tr_b16 v[46:47], v5 offset:1032
  v_mfma_f32_16x16x32_bf16 v[172:175], v[72:75], a[124:127], v[172:175]
  s_add_u32 m0, s57, 40960
  v_mfma_f32_16x16x32_bf16 v[176:179], v[76:79], a[112:115], v[176:179]
  ds_read_b64_tr_b16 v[48:49], v6 offset:0
  buffer_load_dwordx4 v26, s[12:15], s54 offen lds
  buffer_load_dwordx4 v27, s[12:15], s54 offen offset:1024 lds
  v_mfma_f32_16x16x32_bf16 v[180:183], v[76:79], a[116:119], v[180:183]
  s_add_u32 s59, s52, 14
  ds_read_b64_tr_b16 v[50:51], v6 offset:1024
  v_mfma_f32_16x16x32_bf16 v[184:187], v[76:79], a[120:123], v[184:187]
  s_waitcnt vmcnt(13)
  ds_read_b128 a[160:163], v12 offset:0
  ds_read_b128 a[164:167], v12 offset:2048
  v_mfma_f32_16x16x32_bf16 v[188:191], v[76:79], a[124:127], v[188:191]
  s_and_b32 s59, s59, 15
  ds_read_b64_tr_b16 v[52:53], v6 offset:8
  ds_read_b128 a[168:171], v12 offset:4096
  v_mfma_f32_16x16x32_bf16 v[192:195], v[80:83], a[112:115], v[192:195]
  ds_read_b64_tr_b16 v[54:55], v6 offset:1032
  v_mfma_f32_16x16x32_bf16 v[196:199], v[80:83], a[116:119], v[196:199]
  s_lshl_b32 s56, s59, 6
  ds_read_b128 a[172:175], v12 offset:6144
  v_mfma_f32_16x16x32_bf16 v[200:203], v[80:83], a[120:123], v[200:203]
  ds_read_b64_tr_b16 v[56:57], v7 offset:0
  v_mfma_f32_16x16x32_bf16 v[204:207], v[80:83], a[124:127], v[204:207]
  s_add_u32 s56, s56, s55
  ds_read_b128 a[176:179], v13 offset:0
  ds_read_b128 a[180:183], v13 offset:2048
  v_mfma_f32_16x16x32_bf16 v[208:211], v[84:87], a[112:115], v[208:211]
  ds_read_b64_tr_b16 v[58:59], v7 offset:1024
  ds_read_b128 a[184:187], v13 offset:4096
  v_mfma_f32_16x16x32_bf16 v[212:215], v[84:87], a[116:119], v[212:215]
  s_add_u32 m0, s51, 131072
  ds_read_b64_tr_b16 v[60:61], v7 offset:8
  v_mfma_f32_16x16x32_bf16 v[216:219], v[84:87], a[120:123], v[216:219]
  ds_read_b128 a[188:191], v13 offset:6144
  v_mfma_f32_16x16x32_bf16 v[220:223], v[84:87], a[124:127], v[220:223]
  ds_read_b64_tr_b16 v[62:63], v7 offset:1032
  v_mfma_f32_16x16x32_bf16 v[224:227], v[88:91], a[112:115], v[224:227]
  buffer_load_dwordx4 v120, s[4:7], s56 offen lds
  v_mfma_f32_16x16x32_bf16 v[228:231], v[88:91], a[116:119], v[228:231]
  buffer_load_dwordx4 v121, s[4:7], s56 offen offset:1024 lds
  v_mfma_f32_16x16x32_bf16 v[232:235], v[88:91], a[120:123], v[232:235]
  v_mfma_f32_16x16x32_bf16 v[236:239], v[88:91], a[124:127], v[236:239]
  buffer_load_dwordx4 v122, s[4:7], s56 offen offset:2048 lds
  v_mfma_f32_16x16x32_bf16 v[240:243], v[92:95], a[112:115], v[240:243]
  v_mfma_f32_16x16x32_bf16 v[244:247], v[92:95], a[116:119], v[244:247]
  v_mfma_f32_16x16x32_bf16 v[248:251], v[92:95], a[120:123], v[248:251]
  buffer_load_dwordx4 v123, s[4:7], s56 offen offset:3072 lds
  v_mfma_f32_16x16x32_bf16 v[252:255], v[92:95], a[124:127], v[252:255]
  s_waitcnt lgkmcnt(0)
  v_mfma_f32_16x16x32_bf16 v[128:131], v[32:35], a[128:131], v[128:131]
  s_add_u32 s56, s56, 32768
  ds_read_b64_tr_b16 v[64:65], v4 offset:8192
  v_mfma_f32_16x16x32_bf16 v[132:135], v[32:35], a[132:135], v[132:135]
  ds_read_b64_tr_b16 v[66:67], v4 offset:9216
  v_mfma_f32_16x16x32_bf16 v[136:139], v[32:35], a[136:139], v[136:139]
  s_add_u32 m0, s51, 135168
  v_mfma_f32_16x16x32_bf16 v[140:143], v[32:35], a[140:143], v[140:143]
  ds_read_b64_tr_b16 v[68:69], v4 offset:8200
  v_mfma_f32_16x16x32_bf16 v[96:99], v[32:35], v[124:127], v[96:99]
  buffer_load_dwordx4 v120, s[4:7], s56 offen lds
  v_mfma_f32_16x16x32_bf16 v[144:147], v[36:39], a[128:131], v[144:147]
  ds_read_b64_tr_b16 v[70:71], v4 offset:9224
  v_mfma_f32_16x16x32_bf16 v[148:151], v[36:39], a[132:135], v[148:151]
  ds_read_b64_tr_b16 v[72:73], v5 offset:8192
  v_mfma_f32_16x16x32_bf16 v[152:155], v[36:39], a[136:139], v[152:155]
  buffer_load_dwordx4 v121, s[4:7], s56 offen offset:1024 lds
  v_mfma_f32_16x16x32_bf16 v[156:159], v[36:39], a[140:143], v[156:159]
  ds_read_b64_tr_b16 v[74:75], v5 offset:9216
  v_mfma_f32_16x16x32_bf16 v[100:103], v[36:39], v[124:127], v[100:103]
  buffer_load_dwordx4 v122, s[4:7], s56 offen offset:2048 lds
  v_mfma_f32_16x16x32_bf16 v[160:163], v[40:43], a[128:131], v[160:163]
  ds_read_b64_tr_b16 v[76:77], v5 offset:8200
  v_mfma_f32_16x16x32_bf16 v[164:167], v[40:43], a[132:135], v[164:167]
  ds_read_b64_tr_b16 v[78:79], v5 offset:9224
  v_mfma_f32_16x16x32_bf16 v[168:171], v[40:43], a[136:139], v[168:171]
  buffer_load_dwordx4 v123, s[4:7], s56 offen offset:3072 lds
  v_mfma_f32_16x16x32_bf16 v[172:175], v[40:43], a[140:143], v[172:175]
  s_add_u32 s59, s52, 14
  ds_read_b64_tr_b16 v[80:81], v6 offset:8192
  v_mfma_f32_16x16x32_bf16 v[176:179], v[44:47], a[128:131], v[176:179]
  s_and_b32 s59, s59, 15
  v_mfma_f32_16x16x32_bf16 v[180:183], v[44:47], a[132:135], v[180:183]
  s_lshl_b32 s54, s59, 18
  ds_read_b64_tr_b16 v[82:83], v6 offset:9216
  v_mfma_f32_16x16x32_bf16 v[184:187], v[44:47], a[136:139], v[184:187]
  s_add_u32 s54, s54, s53
  ds_read_b64_tr_b16 v[84:85], v6 offset:8200
  v_mfma_f32_16x16x32_bf16 v[188:191], v[44:47], a[140:143], v[188:191]
  s_add_u32 m0, s57, 49152
  v_mfma_f32_16x16x32_bf16 v[192:195], v[48:51], a[128:131], v[192:195]
  ds_read_b64_tr_b16 v[86:87], v6 offset:9224
  v_mfma_f32_16x16x32_bf16 v[196:199], v[48:51], a[132:135], v[196:199]
  buffer_load_dwordx4 v26, s[12:15], s54 offen lds
  v_mfma_f32_16x16x32_bf16 v[200:203], v[48:51], a[136:139], v[200:203]
  ds_read_b64_tr_b16 v[88:89], v7 offset:8192
  buffer_load_dwordx4 v27, s[12:15], s54 offen offset:1024 lds
  v_mfma_f32_16x16x32_bf16 v[204:207], v[48:51], a[140:143], v[204:207]
  s_add_u32 s59, s52, 15
  ds_read_b64_tr_b16 v[90:91], v7 offset:9216
  v_mfma_f32_16x16x32_bf16 v[208:211], v[52:55], a[128:131], v[208:211]
  s_and_b32 s59, s59, 15
  v_mfma_f32_16x16x32_bf16 v[212:215], v[52:55], a[132:135], v[212:215]
  s_lshl_b32 s54, s59, 18
  ds_read_b64_tr_b16 v[92:93], v7 offset:8200
  v_mfma_f32_16x16x32_bf16 v[216:219], v[52:55], a[136:139], v[216:219]
  s_add_u32 s54, s54, s53
  v_mfma_f32_16x16x32_bf16 v[220:223], v[52:55], a[140:143], v[220:223]
  s_add_u32 m0, s57, 57344
  ds_read_b64_tr_b16 v[94:95], v7 offset:9224
  v_mfma_f32_16x16x32_bf16 v[224:227], v[56:59], a[128:131], v[224:227]
  buffer_load_dwordx4 v26, s[12:15], s54 offen lds
  v_mfma_f32_16x16x32_bf16 v[228:231], v[56:59], a[132:135], v[228:231]
  buffer_load_dwordx4 v27, s[12:15], s54 offen offset:1024 lds
  v_mfma_f32_16x16x32_bf16 v[232:235], v[56:59], a[136:139], v[232:235]
  s_lshr_b32 s69, s55, 6
  v_mfma_f32_16x16x32_bf16 v[236:239], v[56:59], a[140:143], v[236:239]
  v_mfma_f32_16x16x32_bf16 v[240:243], v[60:63], a[128:131], v[240:243]
  s_add_u32 s69, s69, 0x8000
  v_mfma_f32_16x16x32_bf16 v[244:247], v[60:63], a[132:135], v[244:247]
  v_mfma_f32_16x16x32_bf16 v[248:251], v[60:63], a[136:139], v[248:251]
  v_lshlrev_b32 v111, 4, v3
  v_mfma_f32_16x16x32_bf16 v[252:255], v[60:63], a[140:143], v[252:255]
  s_waitcnt lgkmcnt(0)
  v_mfma_f32_16x16x32_bf16 v[128:131], v[64:67], a[144:147], v[128:131]
  s_waitcnt vmcnt(33)
  buffer_load_dwordx2 v[112:113], v111, s[8:11], s69 offen sc1
  v_mfma_f32_16x16x32_bf16 v[132:135], v[64:67], a[148:151], v[132:135]
  s_barrier
  ds_read_b64_tr_b16 v[32:33], v4 offset:16384
  v_mfma_f32_16x16x32_bf16 v[136:139], v[64:67], a[152:155], v[136:139]
  ds_read_b64_tr_b16 v[34:35], v4 offset:17408
  v_mfma_f32_16x16x32_bf16 v[140:143], v[64:67], a[156:159], v[140:143]
  buffer_load_dwordx2 v[114:115], v111, s[8:11], s69 offen offset:256 sc1
  v_mfma_f32_16x16x32_bf16 v[96:99], v[64:67], v[124:127], v[96:99]
  ds_read_b64_tr_b16 v[36:37], v4 offset:16392
  v_mfma_f32_16x16x32_bf16 v[144:147], v[68:71], a[144:147], v[144:147]
  ds_read_b64_tr_b16 v[38:39], v4 offset:17416
  v_mfma_f32_16x16x32_bf16 v[148:151], v[68:71], a[148:151], v[148:151]
  buffer_load_dwordx2 v[116:117], v111, s[8:11], s69 offen offset:512 sc1
  v_mfma_f32_16x16x32_bf16 v[152:155], v[68:71], a[152:155], v[152:155]
  ds_read_b64_tr_b16 v[40:41], v5 offset:16384
  v_mfma_f32_16x16x32_bf16 v[156:159], v[68:71], a[156:159], v[156:159]
  buffer_load_dwordx2 v[118:119], v111, s[8:11], s69 offen offset:768 sc1
  v_mfma_f32_16x16x32_bf16 v[100:103], v[68:71], v[124:127], v[100:103]
  s_add_u32 s59, s58, 0
  ds_read_b64_tr_b16 v[42:43], v5 offset:17408
  v_mfma_f32_16x16x32_bf16 v[160:163], v[72:75], a[144:147], v[160:163]
  ds_read_b64_tr_b16 v[44:45], v5 offset:16392
  v_mfma_f32_16x16x32_bf16 v[164:167], v[72:75], a[148:151], v[164:167]
  s_and_b32 s59, s59, 7
  v_mfma_f32_16x16x32_bf16 v[168:171], v[72:75], a[152:155], v[168:171]
  ds_read_b64_tr_b16 v[46:47], v5 offset:17416
  v_mfma_f32_16x16x32_bf16 v[172:175], v[72:75], a[156:159], v[172:175]
  s_lshl_b32 s61, s59, 14
  v_mfma_f32_16x16x32_bf16 v[176:179], v[76:79], a[144:147], v[176:179]
  ds_read_b64_tr_b16 v[48:49], v6 offset:16384
  v_mfma_f32_16x16x32_bf16 v[180:183], v[76:79], a[148:151], v[180:183]
  s_add_u32 s61, s61, s60
  ds_read_b64_tr_b16 v[50:51], v6 offset:17408
  v_mfma_f32_16x16x32_bf16 v[184:187], v[76:79], a[152:155], v[184:187]
  s_waitcnt vmcnt(21)
  ds_read_b128 a[192:195], v12 offset:32768
  ds_read_b128 a[196:199], v12 offset:34816
  v_mfma_f32_16x16x32_bf16 v[188:191], v[76:79], a[156:159], v[188:191]
  ds_read_b64_tr_b16 v[52:53], v6 offset:16392
  ds_read_b128 a[200:203], v12 offset:36864
  v_mfma_f32_16x16x32_bf16 v[192:195], v[80:83], a[144:147], v[192:195]
  s_add_u32 m0, s51, 65536
  ds_read_b64_tr_b16 v[54:55], v6 offset:17416
  v_mfma_f32_16x16x32_bf16 v[196:199], v[80:83], a[148:151], v[196:199]
  ds_read_b128 a[204:207], v12 offset:38912
  v_mfma_f32_16x16x32_bf16 v[200:203], v[80:83], a[152:155], v[200:203]
  ds_read_b64_tr_b16 v[56:57], v7 offset:16384
  buffer_load_dwordx4 v20, s[16:19], s61 offen lds
  v_mfma_f32_16x16x32_bf16 v[204:207], v[80:83], a[156:159], v[204:207]
  ds_read_b128 a[208:211], v13 offset:32768
  ds_read_b128 a[212:215], v13 offset:34816
  v_mfma_f32_16x16x32_bf16 v[208:211], v[84:87], a[144:147], v[208:211]
  ds_read_b64_tr_b16 v[58:59], v7 offset:17408
  ds_read_b128 a[216:219], v13 offset:36864
  v_mfma_f32_16x16x32_bf16 v[212:215], v[84:87], a[148:151], v[212:215]
  ds_read_b64_tr_b16 v[60:61], v7 offset:16392
  buffer_load_dwordx4 v21, s[16:19], s61 offen offset:1024 lds
  v_mfma_f32_16x16x32_bf16 v[216:219], v[84:87], a[152:155], v[216:219]
  ds_read_b128 a[220:223], v13 offset:38912
  v_mfma_f32_16x16x32_bf16 v[220:223], v[84:87], a[156:159], v[220:223]
  ds_read_b64_tr_b16 v[62:63], v7 offset:17416
  v_mfma_f32_16x16x32_bf16 v[224:227], v[88:91], a[144:147], v[224:227]
  buffer_load_dwordx4 v22, s[16:19], s61 offen offset:2048 lds
  v_mfma_f32_16x16x32_bf16 v[228:231], v[88:91], a[148:151], v[228:231]
  buffer_load_dwordx4 v23, s[16:19], s61 offen offset:3072 lds
  v_mfma_f32_16x16x32_bf16 v[232:235], v[88:91], a[152:155], v[232:235]
  v_mfma_f32_16x16x32_bf16 v[236:239], v[88:91], a[156:159], v[236:239]
  s_add_u32 m0, s51, 69632
  v_mfma_f32_16x16x32_bf16 v[240:243], v[92:95], a[144:147], v[240:243]
  v_mfma_f32_16x16x32_bf16 v[244:247], v[92:95], a[148:151], v[244:247]
  buffer_load_dwordx4 v24, s[20:23], s61 offen lds
  v_mfma_f32_16x16x32_bf16 v[248:251], v[92:95], a[152:155], v[248:251]
  v_mfma_f32_16x16x32_bf16 v[252:255], v[92:95], a[156:159], v[252:255]
  s_waitcnt lgkmcnt(0)
  v_mfma_f32_16x16x32_bf16 v[128:131], v[32:35], a[160:163], v[128:131]
  ds_read_b64_tr_b16 v[64:65], v4 offset:24576
  v_mfma_f32_16x16x32_bf16 v[132:135], v[32:35], a[164:167], v[132:135]
  ds_read_b64_tr_b16 v[66:67], v4 offset:25600
  v_mfma_f32_16x16x32_bf16 v[136:139], v[32:35], a[168:171], v[136:139]
  buffer_load_dwordx4 v25, s[20:23], s61 offen offset:1024 lds
  v_mfma_f32_16x16x32_bf16 v[140:143], v[32:35], a[172:175], v[140:143]
  ds_read_b64_tr_b16 v[68:69], v4 offset:24584
  v_mfma_f32_16x16x32_bf16 v[96:99], v[32:35], v[124:127], v[96:99]
  buffer_load_dwordx4 v24, s[20:23], s61 offen offset:2048 lds
  v_mfma_f32_16x16x32_bf16 v[144:147], v[36:39], a[160:163], v[144:147]
  ds_read_b64_tr_b16 v[70:71], v4 offset:25608
  buffer_load_dwordx4 v25, s[20:23], s61 offen offset:3072 lds
  v_mfma_f32_16x16x32_bf16 v[148:151], v[36:39], a[164:167], v[148:151]
  ds_read_b64_tr_b16 v[72:73], v5 offset:24576
  v_mfma_f32_16x16x32_bf16 v[152:155], v[36:39], a[168:171], v[152:155]
  v_mfma_f32_16x16x32_bf16 v[156:159], v[36:39], a[172:175], v[156:159]
  ds_read_b64_tr_b16 v[74:75], v5 offset:25600
  v_mfma_f32_16x16x32_bf16 v[100:103], v[36:39], v[124:127], v[100:103]
  v_mfma_f32_16x16x32_bf16 v[160:163], v[40:43], a[160:163], v[160:163]
  ds_read_b64_tr_b16 v[76:77], v5 offset:24584
  v_mfma_f32_16x16x32_bf16 v[164:167], v[40:43], a[164:167], v[164:167]
  ds_read_b64_tr_b16 v[78:79], v5 offset:25608
  v_mfma_f32_16x16x32_bf16 v[168:171], v[40:43], a[168:171], v[168:171]
  v_mfma_f32_16x16x32_bf16 v[172:175], v[40:43], a[172:175], v[172:175]
  ds_read_b64_tr_b16 v[80:81], v6 offset:24576
  v_mfma_f32_16x16x32_bf16 v[176:179], v[44:47], a[160:163], v[176:179]
  v_mfma_f32_16x16x32_bf16 v[180:183], v[44:47], a[164:167], v[180:183]
  ds_read_b64_tr_b16 v[82:83], v6 offset:25600
  v_mfma_f32_16x16x32_bf16 v[184:187], v[44:47], a[168:171], v[184:187]
  s_waitcnt vmcnt(16)
  ds_read_b64_tr_b16 v[84:85], v6 offset:24584
  v_mfma_f32_16x16x32_bf16 v[188:191], v[44:47], a[172:175], v[188:191]
  ds_read_b128 a[224:227], v14 offset:0
  v_mfma_f32_16x16x32_bf16 v[192:195], v[48:51], a[160:163], v[192:195]
  ds_read_b64_tr_b16 v[86:87], v6 offset:25608
  v_mfma_f32_16x16x32_bf16 v[196:199], v[48:51], a[164:167], v[196:199]
  ds_read_b128 a[228:231], v14 offset:2048
  ds_read_b128 a[232:235], v14 offset:4096
  v_mfma_f32_16x16x32_bf16 v[200:203], v[48:51], a[168:171], v[200:203]
  ds_read_b64_tr_b16 v[88:89], v7 offset:24576
  ds_read_b128 a[236:239], v14 offset:6144
  v_mfma_f32_16x16x32_bf16 v[204:207], v[48:51], a[172:175], v[204:207]
  ds_read_b64_tr_b16 v[90:91], v7 offset:25600
  v_mfma_f32_16x16x32_bf16 v[208:211], v[52:55], a[160:163], v[208:211]
  ds_read_b128 a[240:243], v15 offset:0
  v_mfma_f32_16x16x32_bf16 v[212:215], v[52:55], a[164:167], v[212:215]
  ds_read_b64_tr_b16 v[92:93], v7 offset:24584
  v_mfma_f32_16x16x32_bf16 v[216:219], v[52:55], a[168:171], v[216:219]
  ds_read_b128 a[244:247], v15 offset:2048
  v_mfma_f32_16x16x32_bf16 v[220:223], v[52:55], a[172:175], v[220:223]
  ds_read_b64_tr_b16 v[94:95], v7 offset:25608
  v_mfma_f32_16x16x32_bf16 v[224:227], v[56:59], a[160:163], v[224:227]
  ds_read_b128 a[248:251], v15 offset:4096
  v_mfma_f32_16x16x32_bf16 v[228:231], v[56:59], a[164:167], v[228:231]
  ds_read_b128 a[252:255], v15 offset:6144
  v_mfma_f32_16x16x32_bf16 v[232:235], v[56:59], a[168:171], v[232:235]
  v_mfma_f32_16x16x32_bf16 v[236:239], v[56:59], a[172:175], v[236:239]
  v_mfma_f32_16x16x32_bf16 v[240:243], v[60:63], a[160:163], v[240:243]
  v_mfma_f32_16x16x32_bf16 v[244:247], v[60:63], a[164:167], v[244:247]
  v_mfma_f32_16x16x32_bf16 v[248:251], v[60:63], a[168:171], v[248:251]
  v_mfma_f32_16x16x32_bf16 v[252:255], v[60:63], a[172:175], v[252:255]
  s_waitcnt lgkmcnt(0)
  v_mfma_f32_16x16x32_bf16 v[128:131], v[64:67], a[176:179], v[128:131]
  s_waitcnt vmcnt(12)
  v_lshl_add_u32 v19, v2, 2, v29
  v_and_b32 v108, 7, v19
  v_mfma_f32_16x16x32_bf16 v[132:135], v[64:67], a[180:183], v[132:135]
  s_barrier
  ds_read_b64_tr_b16 v[32:33], v4 offset:32768
  v_lshlrev_b32 v108, 1, v108
  v_mfma_f32_16x16x32_bf16 v[136:139], v[64:67], a[184:187], v[136:139]
  ds_read_b64_tr_b16 v[34:35], v4 offset:33792
  v_lshrrev_b32 v109, 1, v30
  v_mfma_f32_16x16x32_bf16 v[140:143], v[64:67], a[188:191], v[140:143]
  v_xor_b32 v108, v108, v109
  v_and_b32 v109, 1, v30
  v_mfma_f32_16x16x32_bf16 v[96:99], v[64:67], v[124:127], v[96:99]
  ds_read_b64_tr_b16 v[36:37], v4 offset:32776
  v_lshlrev_b32 v109, 3, v109
  v_mfma_f32_16x16x32_bf16 v[144:147], v[68:71], a[176:179], v[144:147]
  ds_read_b64_tr_b16 v[38:39], v4 offset:33800
  v_lshl_add_u32 v109, v19, 8, v109
  v_mfma_f32_16x16x32_bf16 v[148:151], v[68:71], a[180:183], v[148:151]
  v_add_u32 v109, 69632, v109
  v_xor_b32 v12, 0, v108
  v_mfma_f32_16x16x32_bf16 v[152:155], v[68:71], a[184:187], v[152:155]
  ds_read_b64_tr_b16 v[40:41], v4 offset:40960
  v_lshl_add_u32 v12, v12, 4, v109
  v_mfma_f32_16x16x32_bf16 v[156:159], v[68:71], a[188:191], v[156:159]
  v_xor_b32 v13, 2, v108
  v_lshl_add_u32 v13, v13, 4, v109
  v_mfma_f32_16x16x32_bf16 v[100:103], v[68:71], v[124:127], v[100:103]
  ds_read_b64_tr_b16 v[42:43], v4 offset:41984
  v_xor_b32 v14, 4, v108
  v_mfma_f32_16x16x32_bf16 v[160:163], v[72:75], a[176:179], v[160:163]
  ds_read_b64_tr_b16 v[44:45], v4 offset:40968
  v_lshl_add_u32 v14, v14, 4, v109
  v_mfma_f32_16x16x32_bf16 v[164:167], v[72:75], a[180:183], v[164:167]
  v_xor_b32 v15, 6, v108
  v_lshl_add_u32 v15, v15, 4, v109
  v_mfma_f32_16x16x32_bf16 v[168:171], v[72:75], a[184:187], v[168:171]
  ds_read_b64_tr_b16 v[46:47], v4 offset:41992
  v_xor_b32 v16, 8, v108
  v_mfma_f32_16x16x32_bf16 v[172:175], v[72:75], a[188:191], v[172:175]
  v_lshl_add_u32 v16, v16, 4, v109
  v_xor_b32 v17, 10, v108
  v_mfma_f32_16x16x32_bf16 v[176:179], v[76:79], a[176:179], v[176:179]
  ds_read_b64_tr_b16 v[48:49], v4 offset:49152
  v_lshl_add_u32 v17, v17, 4, v109
  v_mfma_f32_16x16x32_bf16 v[180:183], v[76:79], a[180:183], v[180:183]
  ds_read_b64_tr_b16 v[50:51], v4 offset:50176
  v_xor_b32 v18, 12, v108
  v_mfma_f32_16x16x32_bf16 v[184:187], v[76:79], a[184:187], v[184:187]
  v_lshl_add_u32 v18, v18, 4, v109
  v_xor_b32 v19, 14, v108
  v_mfma_f32_16x16x32_bf16 v[188:191], v[76:79], a[188:191], v[188:191]
  ds_read_b64_tr_b16 v[52:53], v4 offset:49160
  v_lshl_add_u32 v19, v19, 4, v109
  v_mfma_f32_16x16x32_bf16 v[192:195], v[80:83], a[176:179], v[192:195]
  ds_read_b64_tr_b16 v[54:55], v4 offset:50184
  v_lshlrev_b32 v31, 1, v2
  v_mfma_f32_16x16x32_bf16 v[196:199], v[80:83], a[180:183], v[196:199]
  v_and_b32 v120, 7, v1
  v_xor_b32 v31, v31, v120
  v_mfma_f32_16x16x32_bf16 v[200:203], v[80:83], a[184:187], v[200:203]
  ds_read_b64_tr_b16 v[56:57], v4 offset:57344
  v_lshlrev_b32 v31, 4, v31
  v_mfma_f32_16x16x32_bf16 v[204:207], v[80:83], a[188:191], v[204:207]
  v_lshrrev_b32 v120, 3, v1
  v_lshl_add_u32 v120, v120, 10, v31
  v_mfma_f32_16x16x32_bf16 v[208:211], v[84:87], a[176:179], v[208:211]
  ds_read_b64_tr_b16 v[58:59], v4 offset:58368
  v_add_u32 v121, 7168, v120
  v_mfma_f32_16x16x32_bf16 v[212:215], v[84:87], a[180:183], v[212:215]
  ds_read_b64_tr_b16 v[60:61], v4 offset:57352
  v_add_u32 v122, 14336, v120
  v_mfma_f32_16x16x32_bf16 v[216:219], v[84:87], a[184:187], v[216:219]
  v_add_u32 v123, 21504, v120
  v_add_u32 v26, s51, v28
  v_mfma_f32_16x16x32_bf16 v[220:223], v[84:87], a[188:191], v[220:223]
  ds_read_b64_tr_b16 v[62:63], v4 offset:58376
  v_add_u32 v26, 137216, v26
  v_mfma_f32_16x16x32_bf16 v[224:227], v[88:91], a[176:179], v[224:227]
  v_add_u32 v27, 137216, v28
  v_mfma_f32_16x16x32_bf16 v[228:231], v[88:91], a[180:183], v[228:231]
  v_mfma_f32_16x16x32_bf16 v[232:235], v[88:91], a[184:187], v[232:235]
  v_mfma_f32_16x16x32_bf16 v[236:239], v[88:91], a[188:191], v[236:239]
  v_mfma_f32_16x16x32_bf16 v[240:243], v[92:95], a[176:179], v[240:243]
  v_mfma_f32_16x16x32_bf16 v[244:247], v[92:95], a[180:183], v[244:247]
  v_mfma_f32_16x16x32_bf16 v[248:251], v[92:95], a[184:187], v[248:251]
  v_mfma_f32_16x16x32_bf16 v[252:255], v[92:95], a[188:191], v[252:255]
  s_waitcnt lgkmcnt(0)
  v_mfma_f32_16x16x32_bf16 v[128:131], v[32:35], a[192:195], v[128:131]
  s_add_u32 s59, s58, 1
  ds_read_b64_tr_b16 v[64:65], v5 offset:32768
  v_mfma_f32_16x16x32_bf16 v[132:135], v[32:35], a[196:199], v[132:135]
  v_mfma_f32_16x16x32_bf16 v[136:139], v[32:35], a[200:203], v[136:139]
  s_and_b32 s59, s59, 7
  ds_read_b64_tr_b16 v[66:67], v5 offset:33792
  v_mfma_f32_16x16x32_bf16 v[140:143], v[32:35], a[204:207], v[140:143]
  s_waitcnt vmcnt(8)
  v_xor_b32 v104, s43, v113
  v_xor_b32 v105, s43, v115
  v_mfma_f32_16x16x32_bf16 v[96:99], v[32:35], v[124:127], v[96:99]
  s_lshl_b32 s61, s59, 14
  ds_read_b64_tr_b16 v[68:69], v5 offset:32776
  v_xor_b32 v107, s43, v117
  v_mfma_f32_16x16x32_bf16 v[144:147], v[36:39], a[192:195], v[144:147]
  v_or3_b32 v104, v104, v105, v107
  v_xor_b32 v105, s43, v119
  v_mfma_f32_16x16x32_bf16 v[148:151], v[36:39], a[196:199], v[148:151]
  s_add_u32 s61, s61, s60
  ds_read_b64_tr_b16 v[70:71], v5 offset:33800
  v_or_b32 v104, v104, v105
  v_mfma_f32_16x16x32_bf16 v[152:155], v[36:39], a[200:203], v[152:155]
  v_cmp_ne_u32 vcc, 0, v104
  v_mfma_f32_16x16x32_bf16 v[156:159], v[36:39], a[204:207], v[156:159]
  s_cbranch_vccnz L_spin6
L_back8:
  ds_read_b64_tr_b16 v[72:73], v5 offset:40960
  v_mfma_f32_16x16x32_bf16 v[100:103], v[36:39], v[124:127], v[100:103]
  s_add_u32 m0, s51, 98304
  v_and_b32 v113, 0xffff0000, v112
  v_rcp_f32 v113, v113
  v_mfma_f32_16x16x32_bf16 v[128:131], v[40:43], a[208:211], v[128:131]
  ds_read_b64_tr_b16 v[74:75], v5 offset:41984
  v_lshlrev_b32 v112, 16, v112
  v_mfma_f32_16x16x32_bf16 v[132:135], v[40:43], a[212:215], v[132:135]
  buffer_load_dwordx4 v20, s[16:19], s61 offen lds
  v_mfma_f32_16x16x32_bf16 v[136:139], v[40:43], a[216:219], v[136:139]
  ds_read_b64_tr_b16 v[76:77], v5 offset:40968
  v_sub_f32 v112, 0, v112
  v_mfma_f32_16x16x32_bf16 v[140:143], v[40:43], a[220:223], v[140:143]
  buffer_load_dwordx4 v21, s[16:19], s61 offen offset:1024 lds
  v_mfma_f32_16x16x32_bf16 v[96:99], v[40:43], v[124:127], v[96:99]
  ds_read_b64_tr_b16 v[78:79], v5 offset:41992
  v_mul_f32 v113, 0x3e0293ee, v113
  v_mfma_f32_16x16x32_bf16 v[144:147], v[44:47], a[208:211], v[144:147]
  v_and_b32 v115, 0xffff0000, v114
  v_rcp_f32 v115, v115
  v_mfma_f32_16x16x32_bf16 v[148:151], v[44:47], a[212:215], v[148:151]
  ds_read_b64_tr_b16 v[80:81], v5 offset:49152
  v_lshlrev_b32 v114, 16, v114
  v_mfma_f32_16x16x32_bf16 v[152:155], v[44:47], a[216:219], v[152:155]
  buffer_load_dwordx4 v22, s[16:19], s61 offen offset:2048 lds
  v_mfma_f32_16x16x32_bf16 v[156:159], v[44:47], a[220:223], v[156:159]
  ds_read_b64_tr_b16 v[82:83], v5 offset:50176
  v_sub_f32 v114, 0, v114
  v_mfma_f32_16x16x32_bf16 v[100:103], v[44:47], v[124:127], v[100:103]
  buffer_load_dwordx4 v23, s[16:19], s61 offen offset:3072 lds
  v_mfma_f32_16x16x32_bf16 v[128:131], v[48:51], a[224:227], v[128:131]
  s_add_u32 m0, s51, 102400
  ds_read_b64_tr_b16 v[84:85], v5 offset:49160
  v_mul_f32 v115, 0x3e0293ee, v115
  v_mfma_f32_16x16x32_bf16 v[132:135], v[48:51], a[228:231], v[132:135]
  v_and_b32 v117, 0xffff0000, v116
  v_rcp_f32 v117, v117
  v_mfma_f32_16x16x32_bf16 v[136:139], v[48:51], a[232:235], v[136:139]
  ds_read_b64_tr_b16 v[86:87], v5 offset:50184
  v_lshlrev_b32 v116, 16, v116
  v_mfma_f32_16x16x32_bf16 v[140:143], v[48:51], a[236:239], v[140:143]
  buffer_load_dwordx4 v24, s[20:23], s61 offen lds
  v_mfma_f32_16x16x32_bf16 v[96:99], v[48:51], v[124:127], v[96:99]
  ds_read_b64_tr_b16 v[88:89], v5 offset:57344
  v_sub_f32 v116, 0, v116
  v_mfma_f32_16x16x32_bf16 v[144:147], v[52:55], a[224:227], v[144:147]
  buffer_load_dwordx4 v25, s[20:23], s61 offen offset:1024 lds
  v_mfma_f32_16x16x32_bf16 v[148:151], v[52:55], a[228:231], v[148:151]
  ds_read_b64_tr_b16 v[90:91], v5 offset:58368
  v_mul_f32 v117, 0x3e0293ee, v117
  v_mfma_f32_16x16x32_bf16 v[152:155], v[52:55], a[232:235], v[152:155]
  buffer_load_dwordx4 v24, s[20:23], s61 offen offset:2048 lds
  v_mfma_f32_16x16x32_bf16 v[156:159], v[52:55], a[236:239], v[156:159]
  ds_read_b64_tr_b16 v[92:93], v5 offset:57352
  v_and_b32 v119, 0xffff0000, v118
  v_mfma_f32_16x16x32_bf16 v[100:103], v[52:55], v[124:127], v[100:103]
  buffer_load_dwordx4 v25, s[20:23], s61 offen offset:3072 lds
  v_mfma_f32_16x16x32_bf16 v[128:131], v[56:59], a[240:243], v[128:131]
  ds_read_b64_tr_b16 v[94:95], v5 offset:58376
  v_rcp_f32 v119, v119
  v_mfma_f32_16x16x32_bf16 v[132:135], v[56:59], a[244:247], v[132:135]
  v_lshlrev_b32 v118, 16, v118
  v_sub_f32 v118, 0, v118
  v_mfma_f32_16x16x32_bf16 v[136:139], v[56:59], a[248:251], v[136:139]
  v_mul_f32 v119, 0x3e0293ee, v119
  v_mfma_f32_16x16x32_bf16 v[140:143], v[56:59], a[252:255], v[140:143]
  v_mfma_f32_16x16x32_bf16 v[96:99], v[56:59], v[124:127], v[96:99]
  v_mfma_f32_16x16x32_bf16 v[144:147], v[60:63], a[240:243], v[144:147]
  v_mfma_f32_16x16x32_bf16 v[148:151], v[60:63], a[244:247], v[148:151]
  v_mfma_f32_16x16x32_bf16 v[152:155], v[60:63], a[248:251], v[152:155]
  v_mfma_f32_16x16x32_bf16 v[156:159], v[60:63], a[252:255], v[156:159]
  v_mfma_f32_16x16x32_bf16 v[100:103], v[60:63], v[124:127], v[100:103]
  s_waitcnt lgkmcnt(0)
  v_mfma_f32_16x16x32_bf16 v[160:163], v[64:67], a[192:195], v[160:163]
  ds_read_b64_tr_b16 v[32:33], v6 offset:32768
  v_mfma_f32_16x16x32_bf16 v[164:167], v[64:67], a[196:199], v[164:167]
  ds_read_b64_tr_b16 v[34:35], v6 offset:33792
  v_mfma_f32_16x16x32_bf16 v[168:171], v[64:67], a[200:203], v[168:171]
  v_mfma_f32_16x16x32_bf16 v[172:175], v[64:67], a[204:207], v[172:175]
  ds_read_b64_tr_b16 v[36:37], v6 offset:32776
  ds_write_b128 v26, v[96:99]
  v_fmac_f32 v128, v96, v112
  v_fmac_f32 v129, v97, v112
  v_fmac_f32 v130, v98, v112
  v_fmac_f32 v131, v99, v112
  v_mfma_f32_16x16x32_bf16 v[176:179], v[68:71], a[192:195], v[176:179]
  ds_read_b64_tr_b16 v[38:39], v6 offset:33800
  ds_write_b128 v26, v[100:103] offset:1024
  v_fmac_f32 v144, v100, v112
  v_fmac_f32 v145, v101, v112
  v_fmac_f32 v146, v102, v112
  v_mfma_f32_16x16x32_bf16 v[180:183], v[68:71], a[196:199], v[180:183]
  v_fmac_f32 v147, v103, v112
  v_mul_f32 v128, v128, v113
  v_mul_f32 v129, v129, v113
  v_mul_f32 v130, v130, v113
  v_mfma_f32_16x16x32_bf16 v[184:187], v[68:71], a[200:203], v[184:187]
  ds_read_b64_tr_b16 v[40:41], v6 offset:40960
  v_mul_f32 v131, v131, v113
  v_mul_f32 v144, v144, v113
  v_mul_f32 v145, v145, v113
  v_mfma_f32_16x16x32_bf16 v[188:191], v[68:71], a[204:207], v[188:191]
  ds_read_b64_tr_b16 v[42:43], v6 offset:41984
  v_mul_f32 v146, v146, v113
  v_mul_f32 v147, v147, v113
  v_cvt_pk_bf16_f32 v128, v128, v129
  v_cvt_pk_bf16_f32 v129, v130, v131
  v_mfma_f32_16x16x32_bf16 v[160:163], v[72:75], a[208:211], v[160:163]
  v_cvt_pk_bf16_f32 v130, v144, v145
  v_cvt_pk_bf16_f32 v131, v146, v147
  v_accvgpr_write_b32 a0, v128
  v_mfma_f32_16x16x32_bf16 v[164:167], v[72:75], a[212:215], v[164:167]
  ds_read_b64_tr_b16 v[44:45], v6 offset:40968
  v_accvgpr_write_b32 a1, v129
  v_accvgpr_write_b32 a2, v130
  v_accvgpr_write_b32 a3, v131
  v_mfma_f32_16x16x32_bf16 v[168:171], v[72:75], a[216:219], v[168:171]
  ds_read_b64_tr_b16 v[46:47], v6 offset:41992
  v_fmac_f32 v132, v96, v114
  v_fmac_f32 v133, v97, v114
  v_fmac_f32 v134, v98, v114
  v_mfma_f32_16x16x32_bf16 v[172:175], v[72:75], a[220:223], v[172:175]
  v_fmac_f32 v135, v99, v114
  v_fmac_f32 v148, v100, v114
  v_fmac_f32 v149, v101, v114
  v_mfma_f32_16x16x32_bf16 v[176:179], v[76:79], a[208:211], v[176:179]
  s_add_u32 s3, s44, 1
  ds_read_b64_tr_b16 v[48:49], v6 offset:49152
  v_fmac_f32 v150, v102, v114
  v_fmac_f32 v151, v103, v114
  v_mul_f32 v132, v132, v115
  v_mfma_f32_16x16x32_bf16 v[180:183], v[76:79], a[212:215], v[180:183]
  s_and_b32 s3, s3, 3
  v_mul_f32 v133, v133, v115
  v_mul_f32 v134, v134, v115
  v_mul_f32 v135, v135, v115
  v_mfma_f32_16x16x32_bf16 v[184:187], v[76:79], a[216:219], v[184:187]
  s_lshl_b32 s3, s3, 13
  ds_read_b64_tr_b16 v[50:51], v6 offset:50176
  v_mul_f32 v148, v148, v115
  v_mul_f32 v149, v149, v115
  v_mul_f32 v150, v150, v115
  v_add_u32 v31, s3, v27
  v_mfma_f32_16x16x32_bf16 v[188:191], v[76:79], a[220:223], v[188:191]
  s_waitcnt lgkmcnt(6)
  ds_read_b64_tr_b16 v[52:53], v6 offset:49160
  v_mul_f32 v151, v151, v115
  v_cvt_pk_bf16_f32 v132, v132, v133
  v_cvt_pk_bf16_f32 v133, v134, v135
  v_mfma_f32_16x16x32_bf16 v[160:163], v[80:83], a[224:227], v[160:163]
  s_barrier
  ds_read_b128 v[104:107], v31
  ds_read_b128 v[108:111], v31 offset:1024
  v_cvt_pk_bf16_f32 v134, v148, v149
  v_cvt_pk_bf16_f32 v135, v150, v151
  v_accvgpr_write_b32 a16, v132
  v_mfma_f32_16x16x32_bf16 v[164:167], v[80:83], a[228:231], v[164:167]
  ds_read_b64_tr_b16 v[54:55], v6 offset:50184
  v_accvgpr_write_b32 a17, v133
  v_accvgpr_write_b32 a18, v134
  v_accvgpr_write_b32 a19, v135
  v_mfma_f32_16x16x32_bf16 v[168:171], v[80:83], a[232:235], v[168:171]
  ds_read_b64_tr_b16 v[56:57], v6 offset:57344
  v_fmac_f32 v136, v96, v116
  v_fmac_f32 v137, v97, v116
  v_fmac_f32 v138, v98, v116
  v_mfma_f32_16x16x32_bf16 v[172:175], v[80:83], a[236:239], v[172:175]
  v_fmac_f32 v139, v99, v116
  v_fmac_f32 v152, v100, v116
  v_fmac_f32 v153, v101, v116
  v_mfma_f32_16x16x32_bf16 v[176:179], v[84:87], a[224:227], v[176:179]
  ds_read_b64_tr_b16 v[58:59], v6 offset:58368
  v_fmac_f32 v154, v102, v116
  v_fmac_f32 v155, v103, v116
  v_mul_f32 v136, v136, v117
  v_mfma_f32_16x16x32_bf16 v[180:183], v[84:87], a[228:231], v[180:183]
  ds_read_b64_tr_b16 v[60:61], v6 offset:57352
  v_mul_f32 v137, v137, v117
  v_mul_f32 v138, v138, v117
  v_mul_f32 v139, v139, v117
  v_mfma_f32_16x16x32_bf16 v[184:187], v[84:87], a[232:235], v[184:187]
  v_mul_f32 v152, v152, v117
  v_mul_f32 v153, v153, v117
  v_mul_f32 v154, v154, v117
  v_mfma_f32_16x16x32_bf16 v[188:191], v[84:87], a[236:239], v[188:191]
  ds_read_b64_tr_b16 v[62:63], v6 offset:58376
  v_mul_f32 v155, v155, v117
  v_cvt_pk_bf16_f32 v136, v136, v137
  v_cvt_pk_bf16_f32 v137, v138, v139
  v_mfma_f32_16x16x32_bf16 v[160:163], v[88:91], a[240:243], v[160:163]
  v_cvt_pk_bf16_f32 v138, v152, v153
  v_cvt_pk_bf16_f32 v139, v154, v155
  v_accvgpr_write_b32 a32, v136
  v_mfma_f32_16x16x32_bf16 v[164:167], v[88:91], a[244:247], v[164:167]
  v_accvgpr_write_b32 a33, v137
  v_accvgpr_write_b32 a34, v138
  v_accvgpr_write_b32 a35, v139
  v_mfma_f32_16x16x32_bf16 v[168:171], v[88:91], a[248:251], v[168:171]
  v_fmac_f32 v140, v96, v118
  v_fmac_f32 v141, v97, v118
  v_fmac_f32 v142, v98, v118
  v_mfma_f32_16x16x32_bf16 v[172:175], v[88:91], a[252:255], v[172:175]
  v_fmac_f32 v143, v99, v118
  v_fmac_f32 v156, v100, v118
  v_fmac_f32 v157, v101, v118
  v_mfma_f32_16x16x32_bf16 v[176:179], v[92:95], a[240:243], v[176:179]
  v_fmac_f32 v158, v102, v118
  v_fmac_f32 v159, v103, v118
  v_mul_f32 v140, v140, v119
  v_mfma_f32_16x16x32_bf16 v[180:183], v[92:95], a[244:247], v[180:183]
  v_mul_f32 v141, v141, v119
  v_mul_f32 v142, v142, v119
  v_mul_f32 v143, v143, v119
  v_mfma_f32_16x16x32_bf16 v[184:187], v[92:95], a[248:251], v[184:187]
  v_mul_f32 v156, v156, v119
  v_mul_f32 v157, v157, v119
  v_mul_f32 v158, v158, v119
  v_mfma_f32_16x16x32_bf16 v[188:191], v[92:95], a[252:255], v[188:191]
  s_waitcnt lgkmcnt(0)
  v_mul_f32 v159, v159, v119
  v_cvt_pk_bf16_f32 v140, v140, v141
  v_cvt_pk_bf16_f32 v141, v142, v143
  v_mfma_f32_16x16x32_bf16 v[192:195], v[32:35], a[192:195], v[192:195]
  s_add_u32 s59, s58, 2
  ds_read_b64_tr_b16 v[64:65], v7 offset:32768
  v_cvt_pk_bf16_f32 v142, v156, v157
  v_cvt_pk_bf16_f32 v143, v158, v159
  v_accvgpr_write_b32 a48, v140
  v_mfma_f32_16x16x32_bf16 v[196:199], v[32:35], a[196:199], v[196:199]
  ds_read_b64_tr_b16 v[66:67], v7 offset:33792
  v_accvgpr_write_b32 a49, v141
  v_accvgpr_write_b32 a50, v142
  v_accvgpr_write_b32 a51, v143
  v_mfma_f32_16x16x32_bf16 v[200:203], v[32:35], a[200:203], v[200:203]
  s_and_b32 s59, s59, 7
  s_waitcnt lgkmcnt(7)
  v_mfma_f32_16x16x32_bf16 v[204:207], v[32:35], a[204:207], v[204:207]
  s_add_u32 s3, s44, 2
  ds_read_b64_tr_b16 v[68:69], v7 offset:32776
  v_fmac_f32 v160, v104, v112
  v_fmac_f32 v161, v105, v112
  v_fmac_f32 v162, v106, v112
  v_fmac_f32 v163, v107, v112
  v_mfma_f32_16x16x32_bf16 v[208:211], v[36:39], a[192:195], v[208:211]
  s_lshl_b32 s61, s59, 14
  s_and_b32 s3, s3, 3
  ds_read_b64_tr_b16 v[70:71], v7 offset:33800
  v_fmac_f32 v176, v108, v112
  v_fmac_f32 v177, v109, v112
  v_fmac_f32 v178, v110, v112
  v_mfma_f32_16x16x32_bf16 v[212:215], v[36:39], a[196:199], v[212:215]
  s_lshl_b32 s3, s3, 13
  v_fmac_f32 v179, v111, v112
  v_mul_f32 v160, v160, v113
  v_mul_f32 v161, v161, v113
  v_mul_f32 v162, v162, v113
  v_add_u32 v31, s3, v27
  v_mfma_f32_16x16x32_bf16 v[216:219], v[36:39], a[200:203], v[216:219]
  s_add_u32 s61, s61, s60
  ds_read_b64_tr_b16 v[72:73], v7 offset:40960
  ds_read_b128 v[96:99], v31
  ds_read_b128 v[100:103], v31 offset:1024
  v_mul_f32 v163, v163, v113
  v_mul_f32 v176, v176, v113
  v_mul_f32 v177, v177, v113
  v_mfma_f32_16x16x32_bf16 v[220:223], v[36:39], a[204:207], v[220:223]
  ds_read_b64_tr_b16 v[74:75], v7 offset:41984
  v_mul_f32 v178, v178, v113
  v_mul_f32 v179, v179, v113
  v_cvt_pk_bf16_f32 v160, v160, v161
  v_cvt_pk_bf16_f32 v161, v162, v163
  v_mfma_f32_16x16x32_bf16 v[192:195], v[40:43], a[208:211], v[192:195]
  v_cvt_pk_bf16_f32 v162, v176, v177
  v_cvt_pk_bf16_f32 v163, v178, v179
  v_accvgpr_write_b32 a4, v160
  v_mfma_f32_16x16x32_bf16 v[196:199], v[40:43], a[212:215], v[196:199]
  s_add_u32 m0, s51, 0
  ds_read_b64_tr_b16 v[76:77], v7 offset:40968
  v_accvgpr_write_b32 a5, v161
  v_accvgpr_write_b32 a6, v162
  v_accvgpr_write_b32 a7, v163
  v_mfma_f32_16x16x32_bf16 v[200:203], v[40:43], a[216:219], v[200:203]
  ds_read_b64_tr_b16 v[78:79], v7 offset:41992
  v_fmac_f32 v164, v104, v114
  v_fmac_f32 v165, v105, v114
  v_fmac_f32 v166, v106, v114
  v_mfma_f32_16x16x32_bf16 v[204:207], v[40:43], a[220:223], v[204:207]
  buffer_load_dwordx4 v20, s[16:19], s61 offen lds
  v_fmac_f32 v167, v107, v114
  v_fmac_f32 v180, v108, v114
  v_fmac_f32 v181, v109, v114
  v_mfma_f32_16x16x32_bf16 v[208:211], v[44:47], a[208:211], v[208:211]
  ds_read_b64_tr_b16 v[80:81], v7 offset:49152
  v_fmac_f32 v182, v110, v114
  v_fmac_f32 v183, v111, v114
  v_mul_f32 v164, v164, v115
  v_mfma_f32_16x16x32_bf16 v[212:215], v[44:47], a[212:215], v[212:215]
  buffer_load_dwordx4 v21, s[16:19], s61 offen offset:1024 lds
  v_mul_f32 v165, v165, v115
  v_mul_f32 v166, v166, v115
  v_mul_f32 v167, v167, v115
  v_mfma_f32_16x16x32_bf16 v[216:219], v[44:47], a[216:219], v[216:219]
  ds_read_b64_tr_b16 v[82:83], v7 offset:50176
  v_mul_f32 v180, v180, v115
  v_mul_f32 v181, v181, v115
  v_mul_f32 v182, v182, v115
  v_mfma_f32_16x16x32_bf16 v[220:223], v[44:47], a[220:223], v[220:223]
  ds_read_b64_tr_b16 v[84:85], v7 offset:49160
  v_mul_f32 v183, v183, v115
  v_cvt_pk_bf16_f32 v164, v164, v165
  v_cvt_pk_bf16_f32 v165, v166, v167
  v_mfma_f32_16x16x32_bf16 v[192:195], v[48:51], a[224:227], v[192:195]
  buffer_load_dwordx4 v22, s[16:19], s61 offen offset:2048 lds
  v_cvt_pk_bf16_f32 v166, v180, v181
  v_cvt_pk_bf16_f32 v167, v182, v183
  v_accvgpr_write_b32 a20, v164
  v_mfma_f32_16x16x32_bf16 v[196:199], v[48:51], a[228:231], v[196:199]
  ds_read_b64_tr_b16 v[86:87], v7 offset:50184
  v_accvgpr_write_b32 a21, v165
  v_accvgpr_write_b32 a22, v166
  v_accvgpr_write_b32 a23, v167
  v_mfma_f32_16x16x32_bf16 v[200:203], v[48:51], a[232:235], v[200:203]
  ds_read_b64_tr_b16 v[88:89], v7 offset:57344
  v_fmac_f32 v168, v104, v116
  v_fmac_f32 v169, v105, v116
  v_fmac_f32 v170, v106, v116
  v_mfma_f32_16x16x32_bf16 v[204:207], v[48:51], a[236:239], v[204:207]
  buffer_load_dwordx4 v23, s[16:19], s61 offen offset:3072 lds
  v_fmac_f32 v171, v107, v116
  v_fmac_f32 v184, v108, v116
  v_fmac_f32 v185, v109, v116
  v_mfma_f32_16x16x32_bf16 v[208:211], v[52:55], a[224:227], v[208:211]
  s_add_u32 m0, s51, 4096
  ds_read_b64_tr_b16 v[90:91], v7 offset:58368
  v_fmac_f32 v186, v110, v116
  v_fmac_f32 v187, v111, v116
  v_mul_f32 v168, v168, v117
  v_mfma_f32_16x16x32_bf16 v[212:215], v[52:55], a[228:231], v[212:215]
  ds_read_b64_tr_b16 v[92:93], v7 offset:57352
  v_mul_f32 v169, v169, v117
  v_mul_f32 v170, v170, v117
  v_mul_f32 v171, v171, v117
  v_mfma_f32_16x16x32_bf16 v[216:219], v[52:55], a[232:235], v[216:219]
  buffer_load_dwordx4 v24, s[20:23], s61 offen lds
  v_mul_f32 v184, v184, v117
  v_mul_f32 v185, v185, v117
  v_mul_f32 v186, v186, v117
  v_mfma_f32_16x16x32_bf16 v[220:223], v[52:55], a[236:239], v[220:223]
  ds_read_b64_tr_b16 v[94:95], v7 offset:58376
  v_mul_f32 v187, v187, v117
  v_cvt_pk_bf16_f32 v168, v168, v169
  v_cvt_pk_bf16_f32 v169, v170, v171
  v_mfma_f32_16x16x32_bf16 v[192:195], v[56:59], a[240:243], v[192:195]
  v_cvt_pk_bf16_f32 v170, v184, v185
  v_cvt_pk_bf16_f32 v171, v186, v187
  v_accvgpr_write_b32 a36, v168
  v_mfma_f32_16x16x32_bf16 v[196:199], v[56:59], a[244:247], v[196:199]
  buffer_load_dwordx4 v25, s[20:23], s61 offen offset:1024 lds
  v_accvgpr_write_b32 a37, v169
  v_accvgpr_write_b32 a38, v170
  v_accvgpr_write_b32 a39, v171
  v_mfma_f32_16x16x32_bf16 v[200:203], v[56:59], a[248:251], v[200:203]
  v_fmac_f32 v172, v104, v118
  v_fmac_f32 v173, v105, v118
  v_fmac_f32 v174, v106, v118
  v_mfma_f32_16x16x32_bf16 v[204:207], v[56:59], a[252:255], v[204:207]
  buffer_load_dwordx4 v24, s[20:23], s61 offen offset:2048 lds
  v_fmac_f32 v175, v107, v118
  v_fmac_f32 v188, v108, v118
  v_fmac_f32 v189, v109, v118
  v_mfma_f32_16x16x32_bf16 v[208:211], v[60:63], a[240:243], v[208:211]
  v_fmac_f32 v190, v110, v118
  v_fmac_f32 v191, v111, v118
  v_mul_f32 v172, v172, v119
  v_mfma_f32_16x16x32_bf16 v[212:215], v[60:63], a[244:247], v[212:215]
  buffer_load_dwordx4 v25, s[20:23], s61 offen offset:3072 lds
  v_mul_f32 v173, v173, v119
  v_mul_f32 v174, v174, v119
  v_mul_f32 v175, v175, v119
  v_mfma_f32_16x16x32_bf16 v[216:219], v[60:63], a[248:251], v[216:219]
  v_mul_f32 v188, v188, v119
  v_mul_f32 v189, v189, v119
  v_mul_f32 v190, v190, v119
  v_mfma_f32_16x16x32_bf16 v[220:223], v[60:63], a[252:255], v[220:223]
  s_waitcnt lgkmcnt(0)
  v_mul_f32 v191, v191, v119
  v_cvt_pk_bf16_f32 v172, v172, v173
  v_cvt_pk_bf16_f32 v173, v174, v175
  v_mfma_f32_16x16x32_bf16 v[224:227], v[64:67], a[192:195], v[224:227]
  s_waitcnt vmcnt(16)
  v_cvt_pk_bf16_f32 v174, v188, v189
  v_cvt_pk_bf16_f32 v175, v190, v191
  v_accvgpr_write_b32 a52, v172
  v_mfma_f32_16x16x32_bf16 v[228:231], v[64:67], a[196:199], v[228:231]
  s_barrier
  v_accvgpr_write_b32 a53, v173
  v_accvgpr_write_b32 a54, v174
  v_accvgpr_write_b32 a55, v175
  v_mfma_f32_16x16x32_bf16 v[232:235], v[64:67], a[200:203], v[232:235]
  s_add_u32 s59, s58, 3
  s_waitcnt lgkmcnt(11)
  ds_read_b128 a[64:67], v8 offset:0
  v_mfma_f32_16x16x32_bf16 v[236:239], v[64:67], a[204:207], v[236:239]
  s_add_u32 s3, s44, 3
  s_and_b32 s3, s3, 3
  v_fmac_f32 v192, v96, v112
  v_fmac_f32 v193, v97, v112
  v_fmac_f32 v194, v98, v112
  v_fmac_f32 v195, v99, v112
  v_mfma_f32_16x16x32_bf16 v[240:243], v[68:71], a[192:195], v[240:243]
  s_and_b32 s59, s59, 7
  s_lshl_b32 s3, s3, 13
  ds_read_b128 a[68:71], v9 offset:0
  v_fmac_f32 v208, v100, v112
  v_fmac_f32 v209, v101, v112
  v_fmac_f32 v210, v102, v112
  v_fmac_f32 v211, v103, v112
  v_mfma_f32_16x16x32_bf16 v[244:247], v[68:71], a[196:199], v[244:247]
  v_mul_f32 v192, v192, v113
  v_mul_f32 v193, v193, v113
  v_mul_f32 v194, v194, v113
  v_mul_f32 v195, v195, v113
  v_add_u32 v31, s3, v27
  v_mfma_f32_16x16x32_bf16 v[248:251], v[68:71], a[200:203], v[248:251]
  s_lshl_b32 s61, s59, 14
  ds_read_b128 v[104:107], v31
  v_mul_f32 v208, v208, v113
  v_mul_f32 v209, v209, v113
  v_mul_f32 v210, v210, v113
  v_mul_f32 v211, v211, v113
  v_mfma_f32_16x16x32_bf16 v[252:255], v[68:71], a[204:207], v[252:255]
  ds_read_b128 v[108:111], v31 offset:1024
  v_cvt_pk_bf16_f32 v192, v192, v193
  v_cvt_pk_bf16_f32 v193, v194, v195
  v_cvt_pk_bf16_f32 v194, v208, v209
  v_cvt_pk_bf16_f32 v195, v210, v211
  v_mfma_f32_16x16x32_bf16 v[224:227], v[72:75], a[208:211], v[224:227]
  s_add_u32 s61, s61, s60
  ds_read_b128 a[72:75], v10 offset:0
  v_accvgpr_write_b32 a8, v192
  v_accvgpr_write_b32 a9, v193
  v_accvgpr_write_b32 a10, v194
  v_accvgpr_write_b32 a11, v195
  v_mfma_f32_16x16x32_bf16 v[228:231], v[72:75], a[212:215], v[228:231]
  v_fmac_f32 v196, v96, v114
  v_fmac_f32 v197, v97, v114
  v_fmac_f32 v198, v98, v114
  v_fmac_f32 v199, v99, v114
  v_mfma_f32_16x16x32_bf16 v[232:235], v[72:75], a[216:219], v[232:235]
  v_fmac_f32 v212, v100, v114
  v_fmac_f32 v213, v101, v114
  v_fmac_f32 v214, v102, v114
  v_mfma_f32_16x16x32_bf16 v[236:239], v[72:75], a[220:223], v[236:239]
  s_add_u32 m0, s51, 32768
  v_fmac_f32 v215, v103, v114
  v_mul_f32 v196, v196, v115
  v_mul_f32 v197, v197, v115
  v_mul_f32 v198, v198, v115
  v_mfma_f32_16x16x32_bf16 v[240:243], v[76:79], a[208:211], v[240:243]
  ds_read_b128 a[76:79], v11 offset:0
  v_mul_f32 v199, v199, v115
  v_mul_f32 v212, v212, v115
  v_mul_f32 v213, v213, v115
  v_mfma_f32_16x16x32_bf16 v[244:247], v[76:79], a[212:215], v[244:247]
  buffer_load_dwordx4 v20, s[16:19], s61 offen lds
  v_mul_f32 v214, v214, v115
  v_mul_f32 v215, v215, v115
  v_cvt_pk_bf16_f32 v196, v196, v197
  v_cvt_pk_bf16_f32 v197, v198, v199
  v_mfma_f32_16x16x32_bf16 v[248:251], v[76:79], a[216:219], v[248:251]
  ds_read_b128 a[80:83], v8 offset:8192
  v_cvt_pk_bf16_f32 v198, v212, v213
  v_cvt_pk_bf16_f32 v199, v214, v215
  v_accvgpr_write_b32 a24, v196
  v_mfma_f32_16x16x32_bf16 v[252:255], v[76:79], a[220:223], v[252:255]
  buffer_load_dwordx4 v21, s[16:19], s61 offen offset:1024 lds
  v_accvgpr_write_b32 a25, v197
  v_accvgpr_write_b32 a26, v198
  v_accvgpr_write_b32 a27, v199
  v_mfma_f32_16x16x32_bf16 v[224:227], v[80:83], a[224:227], v[224:227]
  v_fmac_f32 v200, v96, v116
  v_fmac_f32 v201, v97, v116
  v_fmac_f32 v202, v98, v116
  v_fmac_f32 v203, v99, v116
  v_mfma_f32_16x16x32_bf16 v[228:231], v[80:83], a[228:231], v[228:231]
  ds_read_b128 a[84:87], v9 offset:8192
  v_fmac_f32 v216, v100, v116
  v_fmac_f32 v217, v101, v116
  v_fmac_f32 v218, v102, v116
  v_mfma_f32_16x16x32_bf16 v[232:235], v[80:83], a[232:235], v[232:235]
  buffer_load_dwordx4 v22, s[16:19], s61 offen offset:2048 lds
  v_fmac_f32 v219, v103, v116
  v_mul_f32 v200, v200, v117
  v_mul_f32 v201, v201, v117
  v_mul_f32 v202, v202, v117
  v_mfma_f32_16x16x32_bf16 v[236:239], v[80:83], a[236:239], v[236:239]
  v_mul_f32 v203, v203, v117
  v_mul_f32 v216, v216, v117
  v_mul_f32 v217, v217, v117
  v_mfma_f32_16x16x32_bf16 v[240:243], v[84:87], a[224:227], v[240:243]
  buffer_load_dwordx4 v23, s[16:19], s61 offen offset:3072 lds
  v_mul_f32 v218, v218, v117
  v_mul_f32 v219, v219, v117
  v_cvt_pk_bf16_f32 v200, v200, v201
  v_cvt_pk_bf16_f32 v201, v202, v203
  v_mfma_f32_16x16x32_bf16 v[244:247], v[84:87], a[228:231], v[244:247]
  ds_read_b128 a[88:91], v10 offset:8192
  v_cvt_pk_bf16_f32 v202, v216, v217
  v_cvt_pk_bf16_f32 v203, v218, v219
  v_accvgpr_write_b32 a40, v200
  v_mfma_f32_16x16x32_bf16 v[248:251], v[84:87], a[232:235], v[248:251]
  s_add_u32 m0, s51, 36864
  v_accvgpr_write_b32 a41, v201
  v_accvgpr_write_b32 a42, v202
  v_accvgpr_write_b32 a43, v203
  v_mfma_f32_16x16x32_bf16 v[252:255], v[84:87], a[236:239], v[252:255]
  v_fmac_f32 v204, v96, v118
  v_fmac_f32 v205, v97, v118
  v_fmac_f32 v206, v98, v118
  v_fmac_f32 v207, v99, v118
  v_mfma_f32_16x16x32_bf16 v[224:227], v[88:91], a[240:243], v[224:227]
  buffer_load_dwordx4 v24, s[20:23], s61 offen lds
  v_fmac_f32 v220, v100, v118
  v_fmac_f32 v221, v101, v118
  v_fmac_f32 v222, v102, v118
  v_mfma_f32_16x16x32_bf16 v[228:231], v[88:91], a[244:247], v[228:231]
  ds_read_b128 a[92:95], v11 offset:8192
  v_fmac_f32 v223, v103, v118
  v_mul_f32 v204, v204, v119
  v_mul_f32 v205, v205, v119
  v_mul_f32 v206, v206, v119
  v_mfma_f32_16x16x32_bf16 v[232:235], v[88:91], a[248:251], v[232:235]
  ds_read_b64_tr_b16 a[128:129], v12 offset:0
  ds_read_b64_tr_b16 a[130:131], v12 offset:8192
  v_mul_f32 v207, v207, v119
  v_mul_f32 v220, v220, v119
  v_mul_f32 v221, v221, v119
  v_mfma_f32_16x16x32_bf16 v[236:239], v[88:91], a[252:255], v[236:239]
  buffer_load_dwordx4 v25, s[20:23], s61 offen offset:1024 lds
  v_mul_f32 v222, v222, v119
  v_mul_f32 v223, v223, v119
  v_cvt_pk_bf16_f32 v204, v204, v205
  v_cvt_pk_bf16_f32 v205, v206, v207
  v_mfma_f32_16x16x32_bf16 v[240:243], v[92:95], a[240:243], v[240:243]
  ds_read_b64_tr_b16 a[132:133], v13 offset:0
  v_cvt_pk_bf16_f32 v206, v220, v221
  v_cvt_pk_bf16_f32 v207, v222, v223
  v_accvgpr_write_b32 a56, v204
  v_mfma_f32_16x16x32_bf16 v[244:247], v[92:95], a[244:247], v[244:247]
  buffer_load_dwordx4 v24, s[20:23], s61 offen offset:2048 lds
  v_accvgpr_write_b32 a57, v205
  v_accvgpr_write_b32 a58, v206
  v_accvgpr_write_b32 a59, v207
  v_mfma_f32_16x16x32_bf16 v[248:251], v[92:95], a[248:251], v[248:251]
  s_waitcnt lgkmcnt(9)
  ds_read_b64_tr_b16 a[134:135], v13 offset:8192
  v_mfma_f32_16x16x32_bf16 v[252:255], v[92:95], a[252:255], v[252:255]
  s_waitcnt lgkmcnt(4)
  buffer_load_dwordx4 v25, s[20:23], s61 offen offset:3072 lds
  v_fmac_f32 v224, v104, v112
  v_fmac_f32 v225, v105, v112
  v_fmac_f32 v226, v106, v112
  v_fmac_f32 v227, v107, v112
  v_fmac_f32 v240, v108, v112
  v_fmac_f32 v241, v109, v112
  v_mfma_f32_16x16x32_bf16 v[32:35], a[64:67], a[0:3], 0
  ds_read_b64_tr_b16 a[136:137], v14 offset:0
  v_fmac_f32 v242, v110, v112
  v_fmac_f32 v243, v111, v112
  v_mul_f32 v224, v224, v113
  v_mul_f32 v225, v225, v113
  v_mul_f32 v226, v226, v113
  v_mul_f32 v227, v227, v113
  v_mfma_f32_16x16x32_bf16 v[32:35], a[68:71], a[4:7], v[32:35]
  ds_read_b64_tr_b16 a[138:139], v14 offset:8192
  v_mul_f32 v240, v240, v113
  v_mul_f32 v241, v241, v113
  v_mul_f32 v242, v242, v113
  v_mul_f32 v243, v243, v113
  v_cvt_pk_bf16_f32 v224, v224, v225
  v_cvt_pk_bf16_f32 v225, v226, v227
  v_mfma_f32_16x16x32_bf16 v[32:35], a[72:75], a[8:11], v[32:35]
  s_and_b32 s59, s2, 7
  v_cvt_pk_bf16_f32 v226, v240, v241
  v_cvt_pk_bf16_f32 v227, v242, v243
  v_accvgpr_write_b32 a12, v224
  v_accvgpr_write_b32 a13, v225
  v_accvgpr_write_b32 a14, v226
  v_accvgpr_write_b32 a15, v227
  v_fmac_f32 v228, v104, v114
  v_fmac_f32 v229, v105, v114
  v_fmac_f32 v230, v106, v114
  v_mfma_f32_16x16x32_bf16 v[32:35], a[76:79], a[12:15], v[32:35]
  s_lshl_b32 s52, s59, 3
  ds_read_b64_tr_b16 a[140:141], v15 offset:0
  v_fmac_f32 v231, v107, v114
  v_fmac_f32 v244, v108, v114
  v_fmac_f32 v245, v109, v114
  v_mfma_f32_16x16x32_bf16 v[36:39], a[80:83], a[0:3], 0
  s_mul_i32 s59, s59, 22
  ds_read_b64_tr_b16 a[142:143], v15 offset:8192
  v_fmac_f32 v246, v110, v114
  v_fmac_f32 v247, v111, v114
  v_mfma_f32_16x16x32_bf16 v[36:39], a[84:87], a[4:7], v[36:39]
  s_lshr_b32 s54, s2, 3
  ds_read_b64_tr_b16 a[144:145], v16 offset:0
  v_mul_f32 v228, v228, v115
  v_mul_f32 v229, v229, v115
  v_mul_f32 v230, v230, v115
  v_mfma_f32_16x16x32_bf16 v[36:39], a[88:91], a[8:11], v[36:39]
  s_add_u32 s59, s59, s54
  v_mul_f32 v231, v231, v115
  v_mul_f32 v244, v244, v115
  v_mul_f32 v245, v245, v115
  v_mfma_f32_16x16x32_bf16 v[36:39], a[92:95], a[12:15], v[36:39]
  s_cmp_lt_u32 s54, 22
  s_cselect_b32 s53, s59, 172
  ds_read_b64_tr_b16 a[146:147], v16 offset:8192
  v_mul_f32 v246, v246, v115
  v_mul_f32 v247, v247, v115
  v_mfma_f32_16x16x32_bf16 v[40:43], a[64:67], a[16:19], 0
  s_add_u32 s52, s52, s54
  ds_read_b64_tr_b16 a[148:149], v17 offset:0
  v_cvt_pk_bf16_f32 v228, v228, v229
  v_cvt_pk_bf16_f32 v229, v230, v231
  v_cvt_pk_bf16_f32 v230, v244, v245
  v_mfma_f32_16x16x32_bf16 v[40:43], a[68:71], a[20:23], v[40:43]
  s_sub_u32 s52, s52, 24
  v_cvt_pk_bf16_f32 v231, v246, v247
  v_accvgpr_write_b32 a28, v228
  v_accvgpr_write_b32 a29, v229
  v_mfma_f32_16x16x32_bf16 v[40:43], a[72:75], a[24:27], v[40:43]
  s_cmp_ge_u32 s54, 24
  s_cselect_b32 s52, s52, 64
  v_accvgpr_write_b32 a30, v230
  v_accvgpr_write_b32 a31, v231
  v_fmac_f32 v232, v104, v116
  v_fmac_f32 v233, v105, v116
  v_fmac_f32 v234, v106, v116
  v_mfma_f32_16x16x32_bf16 v[40:43], a[76:79], a[28:31], v[40:43]
  s_lshl_b32 s59, s53, 4
  ds_read_b64_tr_b16 a[150:151], v17 offset:8192
  v_fmac_f32 v235, v107, v116
  v_fmac_f32 v248, v108, v116
  v_fmac_f32 v249, v109, v116
  v_mfma_f32_16x16x32_bf16 v[44:47], a[80:83], a[16:19], 0
  s_mul_i32 s54, s44, 352256
  ds_read_b64_tr_b16 a[152:153], v18 offset:0
  v_fmac_f32 v250, v110, v116
  v_fmac_f32 v251, v111, v116
  v_mfma_f32_16x16x32_bf16 v[44:47], a[84:87], a[20:23], v[44:47]
  s_add_u32 s54, s54, s59
  ds_read_b64_tr_b16 a[154:155], v18 offset:8192
  v_mul_f32 v232, v232, v117
  v_mul_f32 v233, v233, v117
  v_mul_f32 v234, v234, v117
  v_mfma_f32_16x16x32_bf16 v[44:47], a[88:91], a[24:27], v[44:47]
  s_cmp_lt_u32 s53, 172
  s_cselect_b32 s54, s54, 0x40000000
  v_mul_f32 v235, v235, v117
  v_mul_f32 v248, v248, v117
  v_mul_f32 v249, v249, v117
  v_mfma_f32_16x16x32_bf16 v[44:47], a[92:95], a[28:31], v[44:47]
  s_lshr_b32 s57, s52, 5
  ds_read_b64_tr_b16 a[156:157], v19 offset:0
  v_mul_f32 v250, v250, v117
  v_mul_f32 v251, v251, v117
  v_mfma_f32_16x16x32_bf16 v[96:99], a[64:67], a[32:35], 0
  s_lshl_b32 s57, s57, 2
  ds_read_b64_tr_b16 a[158:159], v19 offset:8192
  v_cvt_pk_bf16_f32 v232, v232, v233
  v_cvt_pk_bf16_f32 v233, v234, v235
  v_cvt_pk_bf16_f32 v234, v248, v249
  v_mfma_f32_16x16x32_bf16 v[96:99], a[68:71], a[36:39], v[96:99]
  s_add_u32 s57, s57, s44
  v_cvt_pk_bf16_f32 v235, v250, v251
  v_accvgpr_write_b32 a44, v232
  v_accvgpr_write_b32 a45, v233
  v_mfma_f32_16x16x32_bf16 v[96:99], a[72:75], a[40:43], v[96:99]
  s_mul_i32 s57, s57, 6
  v_accvgpr_write_b32 a46, v234
  v_accvgpr_write_b32 a47, v235
  v_fmac_f32 v236, v104, v118
  v_fmac_f32 v237, v105, v118
  v_mfma_f32_16x16x32_bf16 v[96:99], a[76:79], a[44:47], v[96:99]
  s_lshl_b32 s56, s57, 15
  ds_read_b128 a[96:99], v8 offset:16384
  v_fmac_f32 v238, v106, v118
  v_mfma_f32_16x16x32_bf16 v[100:103], a[80:83], a[32:35], 0
  s_and_b32 s59, s52, 31
  ds_read_b128 a[100:103], v9 offset:16384
  v_fmac_f32 v239, v107, v118
  v_mfma_f32_16x16x32_bf16 v[100:103], a[84:87], a[36:39], v[100:103]
  s_lshl_b32 s59, s59, 5
  v_fmac_f32 v252, v108, v118
  v_fmac_f32 v253, v109, v118
  v_mfma_f32_16x16x32_bf16 v[100:103], a[88:91], a[40:43], v[100:103]
  s_add_u32 s56, s56, s59
  ds_read_b128 a[104:107], v10 offset:16384
  v_fmac_f32 v254, v110, v118
  v_mfma_f32_16x16x32_bf16 v[100:103], a[92:95], a[44:47], v[100:103]
  s_waitcnt lgkmcnt(3)
  v_fmac_f32 v255, v111, v118
  v_max3_f32 v0, v32, v33, v34
  v_max3_f32 v31, v35, v36, v37
  v_max3_f32 v0, v0, v38, v39
  v_max_f32 v0, v0, v31
  v_mov_b32 v31, v0
  s_nop 1
  v_permlane32_swap_b32 v0, v31
  v_max_f32 v0, v0, v31
  v_mov_b32 v31, v0
  s_nop 1
  v_permlane16_swap_b32 v0, v31
  v_max_f32 v0, v0, v31
  v_sub_f32 v32, v32, v0
  v_sub_f32 v33, v33, v0
  v_sub_f32 v34, v34, v0
  v_sub_f32 v35, v35, v0
  v_sub_f32 v36, v36, v0
  v_sub_f32 v37, v37, v0
  v_sub_f32 v38, v38, v0
  v_sub_f32 v39, v39, v0
  v_sub_f32 v80, 0, v0
  v_sub_f32 v81, 0, v0
  v_sub_f32 v82, 0, v0
  v_sub_f32 v83, 0, v0
  v_exp_f32 v32, v32
  v_exp_f32 v33, v33
  v_exp_f32 v34, v34
  v_cvt_pk_bf16_f32 v64, v32, v33
  v_exp_f32 v35, v35
  v_exp_f32 v36, v36
  v_cvt_pk_bf16_f32 v65, v34, v35
  v_exp_f32 v37, v37
  v_exp_f32 v38, v38
  v_cvt_pk_bf16_f32 v66, v36, v37
  v_exp_f32 v39, v39
  s_nop 0
  v_cvt_pk_bf16_f32 v67, v38, v39
  v_max3_f32 v0, v40, v41, v42
  v_max3_f32 v31, v43, v44, v45
  v_mfma_f32_16x16x32_bf16 v[48:51], v[124:127], v[64:67], 0
  s_cmp_lt_u32 s52, 64
  s_cselect_b32 s56, s56, 0x40000000
  v_mul_f32 v236, v236, v119
  v_mul_f32 v237, v237, v119
  v_max3_f32 v0, v0, v46, v47
  v_max_f32 v0, v0, v31
  v_mfma_f32_16x16x32_bf16 v[128:131], a[128:131], v[64:67], 0
  s_cmp_lt_u32 s52, 64
  s_cselect_b64 s[38:39], -1, 0
  v_mul_f32 v238, v238, v119
  v_mov_b32 v31, v0
  v_mfma_f32_16x16x32_bf16 v[144:147], a[132:135], v[64:67], 0
  s_mov_b32 s14, 0x158000
  v_mul_f32 v239, v239, v119
  v_permlane32_swap_b32 v0, v31
  v_max_f32 v0, v0, v31
  v_mov_b32 v31, v0
  v_mfma_f32_16x16x32_bf16 v[160:163], a[136:139], v[64:67], 0
  s_mov_b32 s15, 0x00020000
  v_mul_f32 v252, v252, v119
  v_mul_f32 v253, v253, v119
  v_permlane16_swap_b32 v0, v31
  v_max_f32 v0, v0, v31
  v_mfma_f32_16x16x32_bf16 v[176:179], a[140:143], v[64:67], 0
  v_mul_f32 v254, v254, v119
  v_sub_f32 v40, v40, v0
  v_sub_f32 v41, v41, v0
  v_mul_u32_u24 v5, 2752, v1
  v_mfma_f32_16x16x32_bf16 v[192:195], a[144:147], v[64:67], 0
  v_mul_f32 v255, v255, v119
  v_sub_f32 v42, v42, v0
  v_sub_f32 v43, v43, v0
  v_lshrrev_b32 v4, 1, v1
  v_mfma_f32_16x16x32_bf16 v[208:211], a[148:151], v[64:67], 0
  v_cvt_pk_bf16_f32 v236, v236, v237
  v_cvt_pk_bf16_f32 v237, v238, v239
  v_sub_f32 v44, v44, v0
  v_sub_f32 v45, v45, v0
  v_mfma_f32_16x16x32_bf16 v[224:227], a[152:155], v[64:67], 0
  v_cvt_pk_bf16_f32 v238, v252, v253
  v_sub_f32 v46, v46, v0
  v_lshlrev_b32 v4, 10, v4
  v_and_b32 v6, 1, v1
  v_mfma_f32_16x16x32_bf16 v[240:243], a[156:159], v[64:67], 0
  v_cvt_pk_bf16_f32 v239, v254, v255
  v_sub_f32 v47, v47, v0
  v_sub_f32 v84, 0, v0
  v_lshl_add_u32 v4, v6, 4, v4
  v_cndmask_b32 v5, v5, v4, s[38:39]
  v_mfma_f32_16x16x32_bf16 v[32:35], a[64:67], a[48:51], 0
  v_accvgpr_write_b32 a60, v236
  v_accvgpr_write_b32 a61, v237
  v_sub_f32 v85, 0, v0
  v_sub_f32 v86, 0, v0
  v_mfma_f32_16x16x32_bf16 v[32:35], a[68:71], a[52:55], v[32:35]
  s_cmp_lt_u32 s52, 64
  s_cselect_b64 s[12:13], s[32:33], s[28:29]
  v_accvgpr_write_b32 a62, v238
  v_sub_f32 v87, 0, v0
  v_exp_f32 v40, v40
  v_mfma_f32_16x16x32_bf16 v[32:35], a[72:75], a[56:59], v[32:35]
  s_add_u32 s59, s56, 0
  v_accvgpr_write_b32 a63, v239
  v_exp_f32 v41, v41
  v_exp_f32 v42, v42
  v_mfma_f32_16x16x32_bf16 v[32:35], a[76:79], a[60:63], v[32:35]
  s_add_u32 s61, s54, 0
  v_cvt_pk_bf16_f32 v68, v40, v41
  v_exp_f32 v43, v43
  v_mfma_f32_16x16x32_bf16 v[36:39], a[80:83], a[48:51], 0
  s_min_u32 s59, s59, s61
  v_exp_f32 v44, v44
  v_cvt_pk_bf16_f32 v69, v42, v43
  v_mfma_f32_16x16x32_bf16 v[36:39], a[84:87], a[52:55], v[36:39]
  s_add_u32 m0, s51, 131072
  v_exp_f32 v45, v45
  v_exp_f32 v46, v46
  v_mfma_f32_16x16x32_bf16 v[36:39], a[88:91], a[56:59], v[36:39]
  v_cvt_pk_bf16_f32 v70, v44, v45
  v_exp_f32 v47, v47
  v_mfma_f32_16x16x32_bf16 v[36:39], a[92:95], a[60:63], v[36:39]
  v_cvt_pk_bf16_f32 v71, v46, v47
  v_max3_f32 v0, v96, v97, v98
  v_max3_f32 v31, v99, v100, v101
  v_mfma_f32_16x16x32_bf16 v[52:55], v[124:127], v[68:71], 0
  buffer_load_dwordx4 v5, s[12:15], s59 offen lds
  v_max3_f32 v0, v0, v102, v103
  v_max_f32 v0, v0, v31
  v_mfma_f32_16x16x32_bf16 v[132:135], a[128:131], v[68:71], 0
  ds_read_b128 a[108:111], v11 offset:16384
  v_mov_b32 v31, v0
  v_mfma_f32_16x16x32_bf16 v[148:151], a[132:135], v[68:71], 0
  s_nop 0
  v_permlane32_swap_b32 v0, v31
  v_max_f32 v0, v0, v31
  v_mov_b32 v31, v0
  v_mfma_f32_16x16x32_bf16 v[164:167], a[136:139], v[68:71], 0
  s_nop 0
  v_permlane16_swap_b32 v0, v31
  v_max_f32 v0, v0, v31
  v_mfma_f32_16x16x32_bf16 v[180:183], a[140:143], v[68:71], 0
  v_sub_f32 v96, v96, v0
  v_sub_f32 v97, v97, v0
  ds_read_b128 a[112:115], v8 offset:24576
  ds_read_b128 a[116:119], v9 offset:24576
  ds_read_b128 a[120:123], v10 offset:24576
  ds_read_b128 a[124:127], v11 offset:24576
  v_mfma_f32_16x16x32_bf16 v[196:199], a[144:147], v[68:71], 0
  ds_read_b64_tr_b16 a[160:161], v12 offset:16384
  v_sub_f32 v98, v98, v0
  v_sub_f32 v99, v99, v0
  v_mfma_f32_16x16x32_bf16 v[212:215], a[148:151], v[68:71], 0
  v_sub_f32 v100, v100, v0
  v_sub_f32 v101, v101, v0
  v_mfma_f32_16x16x32_bf16 v[228:231], a[152:155], v[68:71], 0
  ds_read_b64_tr_b16 a[162:163], v12 offset:24576
  v_sub_f32 v102, v102, v0
  v_mfma_f32_16x16x32_bf16 v[244:247], a[156:159], v[68:71], 0
  s_waitcnt lgkmcnt(2)
  v_sub_f32 v103, v103, v0
  v_sub_f32 v88, 0, v0
  v_mfma_f32_16x16x32_bf16 v[40:43], a[96:99], a[0:3], v[80:83]
  ds_read_b64_tr_b16 a[164:165], v13 offset:16384
  v_sub_f32 v89, 0, v0
  v_sub_f32 v90, 0, v0
  v_mfma_f32_16x16x32_bf16 v[40:43], a[100:103], a[4:7], v[40:43]
  v_sub_f32 v91, 0, v0
  v_exp_f32 v96, v96
  v_mfma_f32_16x16x32_bf16 v[40:43], a[104:107], a[8:11], v[40:43]
  v_exp_f32 v97, v97
  v_exp_f32 v98, v98
  v_mfma_f32_16x16x32_bf16 v[40:43], a[108:111], a[12:15], v[40:43]
  ds_read_b64_tr_b16 a[166:167], v13 offset:24576
  v_cvt_pk_bf16_f32 v72, v96, v97
  v_exp_f32 v99, v99
  v_mfma_f32_16x16x32_bf16 v[44:47], a[112:115], a[0:3], v[80:83]
  v_exp_f32 v100, v100
  v_cvt_pk_bf16_f32 v73, v98, v99
  v_mfma_f32_16x16x32_bf16 v[44:47], a[116:119], a[4:7], v[44:47]
  v_exp_f32 v101, v101
  v_exp_f32 v102, v102
  v_mfma_f32_16x16x32_bf16 v[44:47], a[120:123], a[8:11], v[44:47]
  ds_read_b64_tr_b16 a[168:169], v14 offset:16384
  v_cvt_pk_bf16_f32 v74, v100, v101
  v_exp_f32 v103, v103
  v_mfma_f32_16x16x32_bf16 v[44:47], a[124:127], a[12:15], v[44:47]
  v_cvt_pk_bf16_f32 v75, v102, v103
  v_max3_f32 v0, v32, v33, v34
  v_max3_f32 v31, v35, v36, v37
  v_mfma_f32_16x16x32_bf16 v[56:59], v[124:127], v[72:75], 0
  ds_read_b64_tr_b16 a[170:171], v14 offset:24576
  v_max3_f32 v0, v0, v38, v39
  v_max_f32 v0, v0, v31
  v_mfma_f32_16x16x32_bf16 v[136:139], a[128:131], v[72:75], 0
  v_mov_b32 v31, v0
  v_mfma_f32_16x16x32_bf16 v[152:155], a[132:135], v[72:75], 0
  s_nop 0
  v_permlane32_swap_b32 v0, v31
  v_max_f32 v0, v0, v31
  v_mov_b32 v31, v0
  v_mfma_f32_16x16x32_bf16 v[168:171], a[136:139], v[72:75], 0
  ds_read_b64_tr_b16 a[172:173], v15 offset:16384
  buffer_load_dwordx4 v[104:107], v28, s[8:11], s50 offen sc1
  v_permlane16_swap_b32 v0, v31
  v_max_f32 v0, v0, v31
  v_mfma_f32_16x16x32_bf16 v[184:187], a[140:143], v[72:75], 0
  ds_read_b64_tr_b16 a[174:175], v15 offset:24576
  v_sub_f32 v32, v32, v0
  v_sub_f32 v33, v33, v0
  v_mfma_f32_16x16x32_bf16 v[200:203], a[144:147], v[72:75], 0
  v_sub_f32 v34, v34, v0
  v_sub_f32 v35, v35, v0
  v_mfma_f32_16x16x32_bf16 v[216:219], a[148:151], v[72:75], 0
  v_sub_f32 v36, v36, v0
  v_sub_f32 v37, v37, v0
  v_mfma_f32_16x16x32_bf16 v[232:235], a[152:155], v[72:75], 0
  ds_read_b64_tr_b16 a[176:177], v16 offset:16384
  v_sub_f32 v38, v38, v0
  v_mfma_f32_16x16x32_bf16 v[248:251], a[156:159], v[72:75], 0
  v_sub_f32 v39, v39, v0
  v_sub_f32 v92, 0, v0
  v_mfma_f32_16x16x32_bf16 v[96:99], a[96:99], a[16:19], v[84:87]
  buffer_load_dwordx4 v[108:111], v28, s[8:11], s50 offen offset:1024 sc1
  v_sub_f32 v93, 0, v0
  v_sub_f32 v94, 0, v0
  v_mfma_f32_16x16x32_bf16 v[96:99], a[100:103], a[20:23], v[96:99]
  ds_read_b64_tr_b16 a[178:179], v16 offset:24576
  v_sub_f32 v95, 0, v0
  v_exp_f32 v32, v32
  v_mfma_f32_16x16x32_bf16 v[96:99], a[104:107], a[24:27], v[96:99]
  v_exp_f32 v33, v33
  v_exp_f32 v34, v34
  v_mfma_f32_16x16x32_bf16 v[96:99], a[108:111], a[28:31], v[96:99]
  ds_read_b64_tr_b16 a[180:181], v17 offset:16384
  v_cvt_pk_bf16_f32 v76, v32, v33
  v_exp_f32 v35, v35
  v_mfma_f32_16x16x32_bf16 v[100:103], a[112:115], a[16:19], v[84:87]
  v_exp_f32 v36, v36
  v_cvt_pk_bf16_f32 v77, v34, v35
  v_mfma_f32_16x16x32_bf16 v[100:103], a[116:119], a[20:23], v[100:103]
  v_exp_f32 v37, v37
  v_exp_f32 v38, v38
  v_mfma_f32_16x16x32_bf16 v[100:103], a[120:123], a[24:27], v[100:103]
  ds_read_b64_tr_b16 a[182:183], v17 offset:24576
  buffer_load_dwordx4 v[112:115], v28, s[8:11], s50 offen offset:2048 sc1
  v_cvt_pk_bf16_f32 v78, v36, v37
  v_exp_f32 v39, v39
  v_mfma_f32_16x16x32_bf16 v[100:103], a[124:127], a[28:31], v[100:103]
  v_cvt_pk_bf16_f32 v79, v38, v39
  v_exp_f32 v40, v40
  v_exp_f32 v41, v41
  v_mfma_f32_16x16x32_bf16 v[60:63], v[124:127], v[76:79], 0
  v_exp_f32 v42, v42
  v_mfma_f32_16x16x32_bf16 v[140:143], a[128:131], v[76:79], 0
  ds_read_b64_tr_b16 a[184:185], v18 offset:16384
  v_cvt_pk_bf16_f32 v64, v40, v41
  v_mfma_f32_16x16x32_bf16 v[156:159], a[132:135], v[76:79], 0
  s_add_u32 s59, s56, 32768
  v_exp_f32 v43, v43
  v_mfma_f32_16x16x32_bf16 v[172:175], a[136:139], v[76:79], 0
  s_add_u32 s61, s54, 176128
  v_exp_f32 v44, v44
  v_mfma_f32_16x16x32_bf16 v[188:191], a[140:143], v[76:79], 0
  s_min_u32 s59, s59, s61
  ds_read_b64_tr_b16 a[186:187], v18 offset:24576
  buffer_load_dwordx4 v[116:119], v28, s[8:11], s50 offen offset:3072 sc1
  v_cvt_pk_bf16_f32 v65, v42, v43
  v_mfma_f32_16x16x32_bf16 v[204:207], a[144:147], v[76:79], 0
  s_add_u32 m0, s51, 132096
  ds_read_b64_tr_b16 a[188:189], v19 offset:16384
  v_exp_f32 v45, v45
  v_mfma_f32_16x16x32_bf16 v[220:223], a[148:151], v[76:79], 0
  v_exp_f32 v46, v46
  v_mfma_f32_16x16x32_bf16 v[236:239], a[152:155], v[76:79], 0
  buffer_load_dwordx4 v5, s[12:15], s59 offen lds
  v_cvt_pk_bf16_f32 v66, v44, v45
  v_mfma_f32_16x16x32_bf16 v[252:255], a[156:159], v[76:79], 0
  ds_read_b64_tr_b16 a[190:191], v19 offset:24576
  v_exp_f32 v47, v47
  v_mfma_f32_16x16x32_bf16 v[32:35], a[96:99], a[32:35], v[88:91]
  v_cvt_pk_bf16_f32 v67, v46, v47
  v_exp_f32 v96, v96
  v_exp_f32 v97, v97
  v_mfma_f32_16x16x32_bf16 v[32:35], a[100:103], a[36:39], v[32:35]
  v_exp_f32 v98, v98
  v_mfma_f32_16x16x32_bf16 v[32:35], a[104:107], a[40:43], v[32:35]
  v_cvt_pk_bf16_f32 v68, v96, v97
  v_mfma_f32_16x16x32_bf16 v[32:35], a[108:111], a[44:47], v[32:35]
  v_exp_f32 v99, v99
  v_mfma_f32_16x16x32_bf16 v[36:39], a[112:115], a[32:35], v[88:91]
  v_exp_f32 v100, v100
  v_mfma_f32_16x16x32_bf16 v[36:39], a[116:119], a[36:39], v[36:39]
  v_cvt_pk_bf16_f32 v69, v98, v99
  v_mfma_f32_16x16x32_bf16 v[36:39], a[120:123], a[40:43], v[36:39]
  s_waitcnt vmcnt(22) lgkmcnt(0)
  v_exp_f32 v101, v101
  v_mfma_f32_16x16x32_bf16 v[36:39], a[124:127], a[44:47], v[36:39]
  s_barrier
  v_exp_f32 v102, v102
  v_mfma_f32_16x16x32_bf16 v[48:51], v[124:127], v[64:67], v[48:51]
  v_cvt_pk_bf16_f32 v70, v100, v101
  v_mfma_f32_16x16x32_bf16 v[128:131], a[160:163], v[64:67], v[128:131]
  s_lshl_b32 s3, s44, 2
  v_exp_f32 v103, v103
  v_add_u32 v27, s3, v27
  v_mfma_f32_16x16x32_bf16 v[144:147], a[164:167], v[64:67], v[144:147]
  v_cvt_pk_bf16_f32 v71, v102, v103
  v_exp_f32 v32, v32
  v_mfma_f32_16x16x32_bf16 v[160:163], a[168:171], v[64:67], v[160:163]
  v_exp_f32 v33, v33
  v_mfma_f32_16x16x32_bf16 v[176:179], a[172:175], v[64:67], v[176:179]
  v_exp_f32 v34, v34
  v_mfma_f32_16x16x32_bf16 v[192:195], a[176:179], v[64:67], v[192:195]
  v_mfma_f32_16x16x32_bf16 v[208:211], a[180:183], v[64:67], v[208:211]
  v_cvt_pk_bf16_f32 v72, v32, v33
  v_mfma_f32_16x16x32_bf16 v[224:227], a[184:187], v[64:67], v[224:227]
  v_exp_f32 v35, v35
  v_mfma_f32_16x16x32_bf16 v[240:243], a[188:191], v[64:67], v[240:243]
  v_exp_f32 v36, v36
  v_mfma_f32_16x16x32_bf16 v[40:43], a[96:99], a[48:51], v[92:95]
  v_mfma_f32_16x16x32_bf16 v[40:43], a[100:103], a[52:55], v[40:43]
  v_cvt_pk_bf16_f32 v73, v34, v35
  v_mfma_f32_16x16x32_bf16 v[40:43], a[104:107], a[56:59], v[40:43]
  v_exp_f32 v37, v37
  v_mfma_f32_16x16x32_bf16 v[40:43], a[108:111], a[60:63], v[40:43]
  v_exp_f32 v38, v38
  v_mfma_f32_16x16x32_bf16 v[44:47], a[112:115], a[48:51], v[92:95]
  v_mfma_f32_16x16x32_bf16 v[44:47], a[116:119], a[52:55], v[44:47]
  v_cvt_pk_bf16_f32 v74, v36, v37
  v_mfma_f32_16x16x32_bf16 v[44:47], a[120:123], a[56:59], v[44:47]
  v_exp_f32 v39, v39
  v_mfma_f32_16x16x32_bf16 v[44:47], a[124:127], a[60:63], v[44:47]
  v_cvt_pk_bf16_f32 v75, v38, v39
  v_mfma_f32_16x16x32_bf16 v[52:55], v[124:127], v[68:71], v[52:55]
  v_mfma_f32_16x16x32_bf16 v[132:135], a[160:163], v[68:71], v[132:135]
  v_mfma_f32_16x16x32_bf16 v[148:151], a[164:167], v[68:71], v[148:151]
  v_exp_f32 v40, v40
  v_mfma_f32_16x16x32_bf16 v[164:167], a[168:171], v[68:71], v[164:167]
  v_exp_f32 v41, v41
  v_mfma_f32_16x16x32_bf16 v[180:183], a[172:175], v[68:71], v[180:183]
  ds_read_b128 a[64:67], v8 offset:32768
  ds_read_b128 a[68:71], v9 offset:32768
  ds_read_b128 a[72:75], v10 offset:32768
  ds_read_b128 a[76:79], v11 offset:32768
  ds_read_b128 a[80:83], v8 offset:40960
  ds_read_b128 a[84:87], v9 offset:40960
  ds_read_b128 a[88:91], v10 offset:40960
  ds_read_b128 a[92:95], v11 offset:40960
  v_mfma_f32_16x16x32_bf16 v[196:199], a[176:179], v[68:71], v[196:199]
  v_exp_f32 v42, v42
  v_mfma_f32_16x16x32_bf16 v[212:215], a[180:183], v[68:71], v[212:215]
  ds_read_b64_tr_b16 a[128:129], v12 offset:32768
  v_cvt_pk_bf16_f32 v76, v40, v41
  v_mfma_f32_16x16x32_bf16 v[228:231], a[184:187], v[68:71], v[228:231]
  v_exp_f32 v43, v43
  v_mfma_f32_16x16x32_bf16 v[244:247], a[188:191], v[68:71], v[244:247]
  s_waitcnt lgkmcnt(1)
  v_mfma_f32_16x16x32_bf16 v[96:99], a[64:67], a[0:3], v[80:83]
  v_exp_f32 v44, v44
  v_mfma_f32_16x16x32_bf16 v[96:99], a[68:71], a[4:7], v[96:99]
  ds_read_b64_tr_b16 a[130:131], v12 offset:40960
  v_cvt_pk_bf16_f32 v77, v42, v43
  v_mfma_f32_16x16x32_bf16 v[96:99], a[72:75], a[8:11], v[96:99]
  v_exp_f32 v45, v45
  v_mfma_f32_16x16x32_bf16 v[96:99], a[76:79], a[12:15], v[96:99]
  s_waitcnt vmcnt(1)
  ds_read_b64_tr_b16 a[132:133], v13 offset:32768
  v_min3_u32 v0, v105, v107, v109
  v_max3_u32 v31, v105, v107, v109
  v_mfma_f32_16x16x32_bf16 v[100:103], a[80:83], a[0:3], v[80:83]
  v_exp_f32 v46, v46
  v_min3_u32 v0, v0, v111, v113
  v_mfma_f32_16x16x32_bf16 v[100:103], a[84:87], a[4:7], v[100:103]
  ds_read_b64_tr_b16 a[134:135], v13 offset:40960
  v_cvt_pk_bf16_f32 v78, v44, v45
  v_max3_u32 v31, v31, v111, v113
  v_mfma_f32_16x16x32_bf16 v[100:103], a[88:91], a[8:11], v[100:103]
  v_exp_f32 v47, v47
  v_min3_u32 v0, v0, v115, v117
  v_mfma_f32_16x16x32_bf16 v[100:103], a[92:95], a[12:15], v[100:103]
  ds_read_b64_tr_b16 a[136:137], v14 offset:32768
  v_max3_u32 v31, v31, v115, v117
  v_min3_u32 v0, v0, v119, s43
  v_mfma_f32_16x16x32_bf16 v[56:59], v[124:127], v[72:75], v[56:59]
  ds_read_b64_tr_b16 a[138:139], v14 offset:40960
  v_cvt_pk_bf16_f32 v79, v46, v47
  v_max3_u32 v31, v31, v119, s43
  v_mfma_f32_16x16x32_bf16 v[136:139], a[160:163], v[72:75], v[136:139]
  v_cmp_ne_u32 vcc, v0, v31
  v_mfma_f32_16x16x32_bf16 v[152:155], a[164:167], v[72:75], v[152:155]
  s_cbranch_vccnz L_spin9
L_back11:
  v_exp_f32 v96, v96
  v_mfma_f32_16x16x32_bf16 v[168:171], a[168:171], v[72:75], v[168:171]
  v_exp_f32 v97, v97
  v_mfma_f32_16x16x32_bf16 v[184:187], a[172:175], v[72:75], v[184:187]
  ds_read_b64_tr_b16 a[140:141], v15 offset:32768
  v_max_u32 v0, v104, v106
  v_mfma_f32_16x16x32_bf16 v[200:203], a[176:179], v[72:75], v[200:203]
  v_exp_f32 v98, v98
  v_mfma_f32_16x16x32_bf16 v[216:219], a[180:183], v[72:75], v[216:219]
  s_cmp_lt_u32 s52, 64
  s_cselect_b64 s[12:13], s[32:33], s[30:31]
  ds_read_b64_tr_b16 a[142:143], v15 offset:40960
  v_cvt_pk_bf16_f32 v64, v96, v97
  v_mfma_f32_16x16x32_bf16 v[232:235], a[184:187], v[72:75], v[232:235]
  s_add_u32 s59, s56, 65536
  v_exp_f32 v99, v99
  v_mfma_f32_16x16x32_bf16 v[248:251], a[188:191], v[72:75], v[248:251]
  s_add_u32 s61, s54, 0
  v_min_u32 v31, v104, v106
  v_med3_u32 v31, v0, v31, v108
  v_mfma_f32_16x16x32_bf16 v[32:35], a[64:67], a[16:19], v[84:87]
  s_min_u32 s59, s59, s61
  v_exp_f32 v100, v100
  v_mfma_f32_16x16x32_bf16 v[32:35], a[68:71], a[20:23], v[32:35]
  s_add_u32 m0, s51, 133120
  ds_read_b64_tr_b16 a[144:145], v16 offset:32768
  v_cvt_pk_bf16_f32 v65, v98, v99
  v_mfma_f32_16x16x32_bf16 v[32:35], a[72:75], a[24:27], v[32:35]
  buffer_load_dwordx4 v5, s[12:15], s59 offen lds
  v_exp_f32 v101, v101
  v_mfma_f32_16x16x32_bf16 v[32:35], a[76:79], a[28:31], v[32:35]
  ds_read_b64_tr_b16 a[146:147], v16 offset:40960
  v_max_u32 v0, v0, v108
  v_med3_u32 v31, v0, v31, v110
  v_mfma_f32_16x16x32_bf16 v[36:39], a[80:83], a[16:19], v[84:87]
  v_exp_f32 v102, v102
  v_mfma_f32_16x16x32_bf16 v[36:39], a[84:87], a[20:23], v[36:39]
  ds_read_b64_tr_b16 a[148:149], v17 offset:32768
  v_cvt_pk_bf16_f32 v66, v100, v101
  v_mfma_f32_16x16x32_bf16 v[36:39], a[88:91], a[24:27], v[36:39]
  v_exp_f32 v103, v103
  v_mfma_f32_16x16x32_bf16 v[36:39], a[92:95], a[28:31], v[36:39]
  ds_read_b64_tr_b16 a[150:151], v17 offset:40960
  v_max_u32 v0, v0, v110
  v_mfma_f32_16x16x32_bf16 v[60:63], v[124:127], v[76:79], v[60:63]
  ds_read_b64_tr_b16 a[152:153], v18 offset:32768
  v_cvt_pk_bf16_f32 v67, v102, v103
  v_mfma_f32_16x16x32_bf16 v[140:143], a[160:163], v[76:79], v[140:143]
  v_med3_u32 v31, v0, v31, v112
  v_mfma_f32_16x16x32_bf16 v[156:159], a[164:167], v[76:79], v[156:159]
  v_exp_f32 v32, v32
  v_mfma_f32_16x16x32_bf16 v[172:175], a[168:171], v[76:79], v[172:175]
  v_exp_f32 v33, v33
  v_mfma_f32_16x16x32_bf16 v[188:191], a[172:175], v[76:79], v[188:191]
  ds_read_b64_tr_b16 a[154:155], v18 offset:40960
  v_max_u32 v0, v0, v112
  v_med3_u32 v31, v0, v31, v114
  v_mfma_f32_16x16x32_bf16 v[204:207], a[176:179], v[76:79], v[204:207]
  v_exp_f32 v34, v34
  v_mfma_f32_16x16x32_bf16 v[220:223], a[180:183], v[76:79], v[220:223]
  ds_read_b64_tr_b16 a[156:157], v19 offset:32768
  v_cvt_pk_bf16_f32 v68, v32, v33
  v_mfma_f32_16x16x32_bf16 v[236:239], a[184:187], v[76:79], v[236:239]
  v_exp_f32 v35, v35
  v_mfma_f32_16x16x32_bf16 v[252:255], a[188:191], v[76:79], v[252:255]
  s_add_u32 s59, s58, 4
  v_max_u32 v0, v0, v114
  v_mfma_f32_16x16x32_bf16 v[40:43], a[64:67], a[32:35], v[88:91]
  s_and_b32 s59, s59, 7
  v_exp_f32 v36, v36
  v_mfma_f32_16x16x32_bf16 v[40:43], a[68:71], a[36:39], v[40:43]
  s_lshl_b32 s61, s59, 14
  ds_read_b64_tr_b16 a[158:159], v19 offset:40960
  v_cvt_pk_bf16_f32 v69, v34, v35
  v_mfma_f32_16x16x32_bf16 v[40:43], a[72:75], a[40:43], v[40:43]
  s_add_u32 s61, s61, s60
  v_exp_f32 v37, v37
  v_mfma_f32_16x16x32_bf16 v[40:43], a[76:79], a[44:47], v[40:43]
  s_add_u32 m0, s51, 65536
  ds_read_b128 a[96:99], v8 offset:49152
  v_med3_u32 v31, v0, v31, v116
  v_max_u32 v0, v0, v116
  v_mfma_f32_16x16x32_bf16 v[44:47], a[80:83], a[32:35], v[88:91]
  v_exp_f32 v38, v38
  v_mfma_f32_16x16x32_bf16 v[44:47], a[84:87], a[36:39], v[44:47]
  ds_read_b128 a[100:103], v9 offset:49152
  v_cvt_pk_bf16_f32 v70, v36, v37
  v_mfma_f32_16x16x32_bf16 v[44:47], a[88:91], a[40:43], v[44:47]
  v_exp_f32 v39, v39
  v_mfma_f32_16x16x32_bf16 v[44:47], a[92:95], a[44:47], v[44:47]
  s_waitcnt lgkmcnt(2)
  ds_read_b128 a[104:107], v10 offset:49152
  v_med3_u32 v31, v0, v31, v118
  v_max_u32 v0, v0, v118
  v_mfma_f32_16x16x32_bf16 v[48:51], v[124:127], v[64:67], v[48:51]
  ds_read_b128 a[108:111], v11 offset:49152
  v_cvt_pk_bf16_f32 v71, v38, v39
  v_mfma_f32_16x16x32_bf16 v[128:131], a[128:131], v[64:67], v[128:131]
  buffer_load_dwordx4 v20, s[16:19], s61 offen lds
  v_mfma_f32_16x16x32_bf16 v[144:147], a[132:135], v[64:67], v[144:147]
  v_exp_f32 v40, v40
  v_mfma_f32_16x16x32_bf16 v[160:163], a[136:139], v[64:67], v[160:163]
  v_exp_f32 v41, v41
  v_mfma_f32_16x16x32_bf16 v[176:179], a[140:143], v[64:67], v[176:179]
  ds_read_b128 a[112:115], v8 offset:57344
  v_mov_b32 v104, v0
  v_mfma_f32_16x16x32_bf16 v[192:195], a[144:147], v[64:67], v[192:195]
  v_exp_f32 v42, v42
  v_max_u32_dpp v104, v104, v104 quad_perm:[1,0,3,2] row_mask:0xf bank_mask:0xf
  v_mfma_f32_16x16x32_bf16 v[208:211], a[148:151], v[64:67], v[208:211]
  ds_read_b128 a[116:119], v9 offset:57344
  v_cvt_pk_bf16_f32 v72, v40, v41
  v_max_u32_dpp v104, v104, v104 quad_perm:[2,3,0,1] row_mask:0xf bank_mask:0xf
  v_mfma_f32_16x16x32_bf16 v[224:227], a[152:155], v[64:67], v[224:227]
  v_exp_f32 v43, v43
  v_mfma_f32_16x16x32_bf16 v[240:243], a[156:159], v[64:67], v[240:243]
  buffer_load_dwordx4 v21, s[16:19], s61 offen offset:1024 lds
  v_max_u32_dpp v104, v104, v104 row_half_mirror row_mask:0xf bank_mask:0xf
  v_mfma_f32_16x16x32_bf16 v[96:99], a[64:67], a[48:51], v[92:95]
  v_exp_f32 v44, v44
  v_mfma_f32_16x16x32_bf16 v[96:99], a[68:71], a[52:55], v[96:99]
  ds_read_b128 a[120:123], v10 offset:57344
  v_cvt_pk_bf16_f32 v73, v42, v43
  v_mfma_f32_16x16x32_bf16 v[96:99], a[72:75], a[56:59], v[96:99]
  v_exp_f32 v45, v45
  v_mfma_f32_16x16x32_bf16 v[96:99], a[76:79], a[60:63], v[96:99]
  ds_read_b128 a[124:127], v11 offset:57344
  v_max_u32_dpp v104, v104, v104 row_mirror row_mask:0xf bank_mask:0xf
  v_mfma_f32_16x16x32_bf16 v[100:103], a[80:83], a[48:51], v[92:95]
  v_exp_f32 v46, v46
  v_mfma_f32_16x16x32_bf16 v[100:103], a[84:87], a[52:55], v[100:103]
  ds_read_b64_tr_b16 a[160:161], v12 offset:49152
  v_cvt_pk_bf16_f32 v74, v44, v45
  v_mfma_f32_16x16x32_bf16 v[100:103], a[88:91], a[56:59], v[100:103]
  v_exp_f32 v47, v47
  v_mfma_f32_16x16x32_bf16 v[100:103], a[92:95], a[60:63], v[100:103]
  ds_read_b64_tr_b16 a[162:163], v12 offset:57344
  v_mov_b32 v7, v104
  v_mfma_f32_16x16x32_bf16 v[52:55], v[124:127], v[68:71], v[52:55]
  ds_read_b64_tr_b16 a[164:165], v13 offset:49152
  v_cvt_pk_bf16_f32 v75, v46, v47
  v_permlane16_swap_b32 v104, v7
  v_mfma_f32_16x16x32_bf16 v[132:135], a[128:131], v[68:71], v[132:135]
  buffer_load_dwordx4 v22, s[16:19], s61 offen offset:2048 lds
  v_max_u32 v104, v104, v7
  v_mfma_f32_16x16x32_bf16 v[148:151], a[132:135], v[68:71], v[148:151]
  v_exp_f32 v96, v96
  v_mfma_f32_16x16x32_bf16 v[164:167], a[136:139], v[68:71], v[164:167]
  v_exp_f32 v97, v97
  v_mfma_f32_16x16x32_bf16 v[180:183], a[140:143], v[68:71], v[180:183]
  ds_read_b64_tr_b16 a[166:167], v13 offset:57344
  v_mov_b32 v7, v104
  v_mfma_f32_16x16x32_bf16 v[196:199], a[144:147], v[68:71], v[196:199]
  v_exp_f32 v98, v98
  v_permlane32_swap_b32 v104, v7
  v_mfma_f32_16x16x32_bf16 v[212:215], a[148:151], v[68:71], v[212:215]
  ds_read_b64_tr_b16 a[168:169], v14 offset:49152
  v_cvt_pk_bf16_f32 v76, v96, v97
  v_mfma_f32_16x16x32_bf16 v[228:231], a[152:155], v[68:71], v[228:231]
  v_exp_f32 v99, v99
  v_max_u32 v104, v104, v7
  v_mfma_f32_16x16x32_bf16 v[244:247], a[156:159], v[68:71], v[244:247]
  s_waitcnt lgkmcnt(5)
  buffer_load_dwordx4 v23, s[16:19], s61 offen offset:3072 lds
  v_mfma_f32_16x16x32_bf16 v[32:35], a[96:99], a[0:3], v[80:83]
  s_add_u32 m0, s51, 69632
  v_exp_f32 v100, v100
  v_mfma_f32_16x16x32_bf16 v[32:35], a[100:103], a[4:7], v[32:35]
  ds_read_b64_tr_b16 a[170:171], v14 offset:57344
  v_cvt_pk_bf16_f32 v77, v98, v99
  v_mfma_f32_16x16x32_bf16 v[32:35], a[104:107], a[8:11], v[32:35]
  v_exp_f32 v101, v101
  v_mfma_f32_16x16x32_bf16 v[32:35], a[108:111], a[12:15], v[32:35]
  ds_read_b64_tr_b16 a[172:173], v15 offset:49152
  v_cmp_eq_u32 vcc, v104, v0
  v_mfma_f32_16x16x32_bf16 v[36:39], a[112:115], a[0:3], v[80:83]
  v_exp_f32 v102, v102
  v_mfma_f32_16x16x32_bf16 v[36:39], a[116:119], a[4:7], v[36:39]
  ds_read_b64_tr_b16 a[174:175], v15 offset:57344
  v_cvt_pk_bf16_f32 v78, v100, v101
  v_mfma_f32_16x16x32_bf16 v[36:39], a[120:123], a[8:11], v[36:39]
  v_exp_f32 v103, v103
  v_mfma_f32_16x16x32_bf16 v[36:39], a[124:127], a[12:15], v[36:39]
  ds_read_b64_tr_b16 a[176:177], v16 offset:49152
  v_cndmask_b32 v105, v0, v31, vcc
  v_mfma_f32_16x16x32_bf16 v[56:59], v[124:127], v[72:75], v[56:59]
  ds_read_b64_tr_b16 a[178:179], v16 offset:57344
  v_cvt_pk_bf16_f32 v79, v102, v103
  v_max_u32_dpp v105, v105, v105 quad_perm:[1,0,3,2] row_mask:0xf bank_mask:0xf
  v_mfma_f32_16x16x32_bf16 v[136:139], a[128:131], v[72:75], v[136:139]
  buffer_load_dwordx4 v24, s[20:23], s61 offen lds
  v_mfma_f32_16x16x32_bf16 v[152:155], a[132:135], v[72:75], v[152:155]
  v_exp_f32 v32, v32
  v_mfma_f32_16x16x32_bf16 v[168:171], a[136:139], v[72:75], v[168:171]
  v_exp_f32 v33, v33
  v_mfma_f32_16x16x32_bf16 v[184:187], a[140:143], v[72:75], v[184:187]
  ds_read_b64_tr_b16 a[180:181], v17 offset:49152
  v_max_u32_dpp v105, v105, v105 quad_perm:[2,3,0,1] row_mask:0xf bank_mask:0xf
  v_mfma_f32_16x16x32_bf16 v[200:203], a[144:147], v[72:75], v[200:203]
  v_exp_f32 v34, v34
  v_max_u32_dpp v105, v105, v105 row_half_mirror row_mask:0xf bank_mask:0xf
  v_mfma_f32_16x16x32_bf16 v[216:219], a[148:151], v[72:75], v[216:219]
  ds_read_b64_tr_b16 a[182:183], v17 offset:57344
  v_cvt_pk_bf16_f32 v64, v32, v33
  v_max_u32_dpp v105, v105, v105 row_mirror row_mask:0xf bank_mask:0xf
  v_mfma_f32_16x16x32_bf16 v[232:235], a[152:155], v[72:75], v[232:235]
  v_exp_f32 v35, v35
  v_mov_b32 v7, v105
  v_mfma_f32_16x16x32_bf16 v[248:251], a[156:159], v[72:75], v[248:251]
  buffer_load_dwordx4 v25, s[20:23], s61 offen offset:1024 lds
  v_mfma_f32_16x16x32_bf16 v[40:43], a[96:99], a[16:19], v[84:87]
  v_exp_f32 v36, v36
  v_mfma_f32_16x16x32_bf16 v[40:43], a[100:103], a[20:23], v[40:43]
  ds_read_b64_tr_b16 a[184:185], v18 offset:49152
  v_cvt_pk_bf16_f32 v65, v34, v35
  v_mfma_f32_16x16x32_bf16 v[40:43], a[104:107], a[24:27], v[40:43]
  v_exp_f32 v37, v37
  v_mfma_f32_16x16x32_bf16 v[40:43], a[108:111], a[28:31], v[40:43]
  ds_read_b64_tr_b16 a[186:187], v18 offset:57344
  v_permlane16_swap_b32 v105, v7
  v_max_u32 v105, v105, v7
  v_mfma_f32_16x16x32_bf16 v[44:47], a[112:115], a[16:19], v[84:87]
  v_exp_f32 v38, v38
  v_mfma_f32_16x16x32_bf16 v[44:47], a[116:119], a[20:23], v[44:47]
  ds_read_b64_tr_b16 a[188:189], v19 offset:49152
  v_cvt_pk_bf16_f32 v66, v36, v37
  v_mfma_f32_16x16x32_bf16 v[44:47], a[120:123], a[24:27], v[44:47]
  v_exp_f32 v39, v39
  v_mfma_f32_16x16x32_bf16 v[44:47], a[124:127], a[28:31], v[44:47]
  ds_read_b64_tr_b16 a[190:191], v19 offset:57344
  v_mov_b32 v7, v105
  v_mfma_f32_16x16x32_bf16 v[60:63], v[124:127], v[76:79], v[60:63]
  v_cvt_pk_bf16_f32 v67, v38, v39
  v_permlane32_swap_b32 v105, v7
  v_mfma_f32_16x16x32_bf16 v[140:143], a[128:131], v[76:79], v[140:143]
  buffer_load_dwordx4 v24, s[20:23], s61 offen offset:2048 lds
  v_mfma_f32_16x16x32_bf16 v[156:159], a[132:135], v[76:79], v[156:159]
  v_exp_f32 v40, v40
  v_mfma_f32_16x16x32_bf16 v[172:175], a[136:139], v[76:79], v[172:175]
  v_exp_f32 v41, v41
  v_mfma_f32_16x16x32_bf16 v[188:191], a[140:143], v[76:79], v[188:191]
  v_xor_b32 v8, 0x10000, v8
  v_max_u32 v105, v105, v7
  v_mfma_f32_16x16x32_bf16 v[204:207], a[144:147], v[76:79], v[204:207]
  v_exp_f32 v42, v42
  v_mfma_f32_16x16x32_bf16 v[220:223], a[148:151], v[76:79], v[220:223]
  v_cvt_pk_bf16_f32 v68, v40, v41
  v_mov_b32 v7, s51
  v_mfma_f32_16x16x32_bf16 v[236:239], a[152:155], v[76:79], v[236:239]
  v_exp_f32 v43, v43
  v_mfma_f32_16x16x32_bf16 v[252:255], a[156:159], v[76:79], v[252:255]
  v_xor_b32 v9, 0x10000, v9
  v_add_u32 v7, 137216, v7
  v_mfma_f32_16x16x32_bf16 v[96:99], a[96:99], a[32:35], v[88:91]
  v_exp_f32 v44, v44
  v_xor_b32 v12, 0x10000, v12
  v_mfma_f32_16x16x32_bf16 v[96:99], a[100:103], a[36:39], v[96:99]
  ds_write_b64 v7, v[104:105]
  v_cvt_pk_bf16_f32 v69, v42, v43
  v_xor_b32 v10, 0x10000, v10
  v_mfma_f32_16x16x32_bf16 v[96:99], a[104:107], a[40:43], v[96:99]
  v_exp_f32 v45, v45
  v_mfma_f32_16x16x32_bf16 v[96:99], a[108:111], a[44:47], v[96:99]
  v_xor_b32 v13, 0x10000, v13
  v_mfma_f32_16x16x32_bf16 v[100:103], a[112:115], a[32:35], v[88:91]
  v_exp_f32 v46, v46
  v_mfma_f32_16x16x32_bf16 v[100:103], a[116:119], a[36:39], v[100:103]
  v_cvt_pk_bf16_f32 v70, v44, v45
  v_xor_b32 v11, 0x10000, v11
  buffer_load_dwordx4 v25, s[20:23], s61 offen offset:3072 lds
  v_mfma_f32_16x16x32_bf16 v[100:103], a[120:123], a[40:43], v[100:103]
  s_waitcnt vmcnt(23) lgkmcnt(0)
  v_exp_f32 v47, v47
  v_mfma_f32_16x16x32_bf16 v[100:103], a[124:127], a[44:47], v[100:103]
  s_barrier
  ds_read_b128 a[64:67], v8 offset:0
  v_xor_b32 v14, 0x10000, v14
  v_mov_b32 v7, 137216
  v_mfma_f32_16x16x32_bf16 v[48:51], v[124:127], v[64:67], v[48:51]
  s_add_u32 s59, s56, 98304
  ds_read_b128 a[68:71], v9 offset:0
  v_cvt_pk_bf16_f32 v71, v46, v47
  v_mfma_f32_16x16x32_bf16 v[128:131], a[160:163], v[64:67], v[128:131]
  s_add_u32 s61, s54, 176128
  ds_read_b64 v[104:105], v7 offset:0
  v_xor_b32 v15, 0x10000, v15
  v_mfma_f32_16x16x32_bf16 v[144:147], a[164:167], v[64:67], v[144:147]
  s_min_u32 s59, s59, s61
  ds_read_b64 v[106:107], v7 offset:8192
  v_exp_f32 v96, v96
  v_mfma_f32_16x16x32_bf16 v[160:163], a[168:171], v[64:67], v[160:163]
  s_add_u32 m0, s51, 134144
  ds_read_b64 v[108:109], v7 offset:16384
  v_exp_f32 v97, v97
  v_mfma_f32_16x16x32_bf16 v[176:179], a[172:175], v[64:67], v[176:179]
  ds_read_b128 a[72:75], v10 offset:0
  ds_read_b64 v[110:111], v7 offset:24576
  v_xor_b32 v16, 0x10000, v16
  v_mfma_f32_16x16x32_bf16 v[192:195], a[176:179], v[64:67], v[192:195]
  buffer_load_dwordx4 v5, s[12:15], s59 offen lds
  v_exp_f32 v98, v98
  v_mfma_f32_16x16x32_bf16 v[208:211], a[180:183], v[64:67], v[208:211]
  ds_read_b128 a[76:79], v11 offset:0
  v_cvt_pk_bf16_f32 v72, v96, v97
  v_mfma_f32_16x16x32_bf16 v[224:227], a[184:187], v[64:67], v[224:227]
  v_exp_f32 v99, v99
  v_mfma_f32_16x16x32_bf16 v[240:243], a[188:191], v[64:67], v[240:243]
  v_xor_b32 v17, 0x10000, v17
  v_lshl_add_u32 v4, v2, 3, v29
  v_lshlrev_b32 v4, 4, v4
  v_mfma_f32_16x16x32_bf16 v[32:35], a[96:99], a[48:51], v[92:95]
  v_exp_f32 v100, v100
  v_lshrrev_b32 v6, 1, v30
  v_mfma_f32_16x16x32_bf16 v[32:35], a[100:103], a[52:55], v[32:35]
  ds_read_b128 a[80:83], v8 offset:8192
  v_cvt_pk_bf16_f32 v73, v98, v99
  v_xor_b32 v18, 0x10000, v18
  v_mfma_f32_16x16x32_bf16 v[32:35], a[104:107], a[56:59], v[32:35]
  v_exp_f32 v101, v101
  v_mfma_f32_16x16x32_bf16 v[32:35], a[108:111], a[60:63], v[32:35]
  ds_read_b128 a[84:87], v9 offset:8192
  v_lshl_add_u32 v4, v6, 11, v4
  v_and_b32 v6, 1, v30
  v_mfma_f32_16x16x32_bf16 v[36:39], a[112:115], a[48:51], v[92:95]
  v_exp_f32 v102, v102
  v_xor_b32 v19, 0x10000, v19
  v_mfma_f32_16x16x32_bf16 v[36:39], a[116:119], a[52:55], v[36:39]
  ds_read_b128 a[88:91], v10 offset:8192
  v_cvt_pk_bf16_f32 v74, v100, v101
  v_lshl_add_u32 v4, v6, 3, v4
  v_mfma_f32_16x16x32_bf16 v[36:39], a[120:123], a[56:59], v[36:39]
  v_exp_f32 v103, v103
  v_mfma_f32_16x16x32_bf16 v[36:39], a[124:127], a[60:63], v[36:39]
  ds_read_b128 a[92:95], v11 offset:8192
  v_add_u32 v4, s51, v4
  v_mfma_f32_16x16x32_bf16 v[52:55], v[124:127], v[68:71], v[52:55]
  ds_read_b64_tr_b16 a[128:129], v12 offset:0
  v_cvt_pk_bf16_f32 v75, v102, v103
  v_mfma_f32_16x16x32_bf16 v[132:135], a[160:163], v[68:71], v[132:135]
  v_add_u32 v4, 131072, v4
  v_mfma_f32_16x16x32_bf16 v[148:151], a[164:167], v[68:71], v[148:151]
  s_waitcnt lgkmcnt(6)
  v_exp_f32 v32, v32
  v_mfma_f32_16x16x32_bf16 v[164:167], a[168:171], v[68:71], v[164:167]
  v_exp_f32 v33, v33
  v_mfma_f32_16x16x32_bf16 v[180:183], a[172:175], v[68:71], v[180:183]
  ds_read_b64_tr_b16 a[130:131], v12 offset:8192
  v_max_u32 v0, v104, v105
  v_min_u32 v31, v104, v105
  v_mfma_f32_16x16x32_bf16 v[196:199], a[176:179], v[68:71], v[196:199]
  v_exp_f32 v34, v34
  v_med3_u32 v31, v0, v31, v106
  v_mfma_f32_16x16x32_bf16 v[212:215], a[180:183], v[68:71], v[212:215]
  ds_read_b64_tr_b16 a[132:133], v13 offset:0
  v_cvt_pk_bf16_f32 v76, v32, v33
  v_mfma_f32_16x16x32_bf16 v[228:231], a[184:187], v[68:71], v[228:231]
  v_exp_f32 v35, v35
  v_mfma_f32_16x16x32_bf16 v[244:247], a[188:191], v[68:71], v[244:247]
  s_waitcnt lgkmcnt(3)
  v_max_u32 v0, v0, v106
  v_med3_u32 v31, v0, v31, v107
  v_max_u32 v0, v0, v107
  v_mfma_f32_16x16x32_bf16 v[40:43], a[64:67], a[0:3], v[80:83]
  v_exp_f32 v36, v36
  v_med3_u32 v31, v0, v31, v108
  v_mfma_f32_16x16x32_bf16 v[40:43], a[68:71], a[4:7], v[40:43]
  ds_read_b64_tr_b16 a[134:135], v13 offset:8192
  v_cvt_pk_bf16_f32 v77, v34, v35
  v_mfma_f32_16x16x32_bf16 v[40:43], a[72:75], a[8:11], v[40:43]
  v_exp_f32 v37, v37
  v_mfma_f32_16x16x32_bf16 v[40:43], a[76:79], a[12:15], v[40:43]
  ds_read_b64_tr_b16 a[136:137], v14 offset:0
  v_max_u32 v0, v0, v108
  v_med3_u32 v31, v0, v31, v109
  v_mfma_f32_16x16x32_bf16 v[44:47], a[80:83], a[0:3], v[80:83]
  v_exp_f32 v38, v38
  v_max_u32 v0, v0, v109
  v_mfma_f32_16x16x32_bf16 v[44:47], a[84:87], a[4:7], v[44:47]
  ds_read_b64_tr_b16 a[138:139], v14 offset:8192
  v_cvt_pk_bf16_f32 v78, v36, v37
  v_mfma_f32_16x16x32_bf16 v[44:47], a[88:91], a[8:11], v[44:47]
  v_exp_f32 v39, v39
  v_mfma_f32_16x16x32_bf16 v[44:47], a[92:95], a[12:15], v[44:47]
  ds_read_b64_tr_b16 a[140:141], v15 offset:0
  v_med3_u32 v31, v0, v31, v110
  v_mfma_f32_16x16x32_bf16 v[56:59], v[124:127], v[72:75], v[56:59]
  ds_read_b64_tr_b16 a[142:143], v15 offset:8192
  v_cvt_pk_bf16_f32 v79, v38, v39
  v_mfma_f32_16x16x32_bf16 v[136:139], a[160:163], v[72:75], v[136:139]
  v_max_u32 v0, v0, v110
  v_med3_u32 v31, v0, v31, v111
  v_mfma_f32_16x16x32_bf16 v[152:155], a[164:167], v[72:75], v[152:155]
  v_exp_f32 v40, v40
  v_mfma_f32_16x16x32_bf16 v[168:171], a[168:171], v[72:75], v[168:171]
  v_exp_f32 v41, v41
  v_mfma_f32_16x16x32_bf16 v[184:187], a[172:175], v[72:75], v[184:187]
  ds_read_b64_tr_b16 a[144:145], v16 offset:0
  v_max_u32 v0, v0, v111
  v_mfma_f32_16x16x32_bf16 v[200:203], a[176:179], v[72:75], v[200:203]
  v_exp_f32 v42, v42
  v_readfirstlane_b32 s67, v0
  v_mfma_f32_16x16x32_bf16 v[216:219], a[180:183], v[72:75], v[216:219]
  ds_read_b64_tr_b16 a[146:147], v16 offset:8192
  v_cvt_pk_bf16_f32 v64, v40, v41
  v_readfirstlane_b32 s68, v31
  v_cmp_lt_u32 vcc, 31, v1
  s_nop 1
  v_cndmask_b32 v104, v0, v31, vcc
  v_and_b32 v104, 0xffff, v104
  v_sub_u32 v104, 0xffff, v104
  v_and_b32 v7, 31, v1
  v_lshlrev_b32 v7, 3, v7
  v_lshl_add_u32 v105, v104, 10, v7
  v_lshlrev_b32 v104, 4, v104
  s_lshl_b32 s69, s44, 8
  buffer_load_dwordx2 v[106:107], v105, s[4:7], s69 offen
  s_mov_b32 s69, 0x8000
  buffer_load_dword v108, v104, s[8:11], s69 offen sc1
  v_mfma_f32_16x16x32_bf16 v[232:235], a[184:187], v[72:75], v[232:235]
  v_exp_f32 v43, v43
  v_mfma_f32_16x16x32_bf16 v[248:251], a[188:191], v[72:75], v[248:251]
  v_lshlrev_b32 v114, 3, v1
  v_add_u32 v114, s51, v114
  v_add_u32 v114, 137728, v114
  v_mfma_f32_16x16x32_bf16 v[96:99], a[64:67], a[16:19], v[84:87]
  v_exp_f32 v44, v44
  v_and_b32 v115, 1, v1
  v_mfma_f32_16x16x32_bf16 v[96:99], a[68:71], a[20:23], v[96:99]
  ds_read_b64_tr_b16 a[148:149], v17 offset:0
  v_cvt_pk_bf16_f32 v65, v42, v43
  v_mfma_f32_16x16x32_bf16 v[96:99], a[72:75], a[24:27], v[96:99]
  v_exp_f32 v45, v45
  v_mfma_f32_16x16x32_bf16 v[96:99], a[76:79], a[28:31], v[96:99]
  ds_read_b64_tr_b16 a[150:151], v17 offset:8192
  v_lshlrev_b32 v115, 8, v115
  v_lshl_add_u32 v115, v2, 4, v115
  v_mfma_f32_16x16x32_bf16 v[100:103], a[80:83], a[16:19], v[84:87]
  v_exp_f32 v46, v46
  v_add_u32 v115, s51, v115
  v_mfma_f32_16x16x32_bf16 v[100:103], a[84:87], a[20:23], v[100:103]
  ds_read_b64_tr_b16 a[152:153], v18 offset:0
  v_cvt_pk_bf16_f32 v66, v44, v45
  v_mfma_f32_16x16x32_bf16 v[100:103], a[88:91], a[24:27], v[100:103]
  v_exp_f32 v47, v47
  v_mfma_f32_16x16x32_bf16 v[100:103], a[92:95], a[28:31], v[100:103]
  ds_read_b64_tr_b16 a[154:155], v18 offset:8192
  v_add_u32 v115, 137728, v115
  v_mfma_f32_16x16x32_bf16 v[60:63], v[124:127], v[76:79], v[60:63]
  ds_read_b64_tr_b16 a[156:157], v19 offset:0
  v_cvt_pk_bf16_f32 v67, v46, v47
  v_mfma_f32_16x16x32_bf16 v[140:143], a[160:163], v[76:79], v[140:143]
  v_mfma_f32_16x16x32_bf16 v[156:159], a[164:167], v[76:79], v[156:159]
  v_exp_f32 v96, v96
  v_mfma_f32_16x16x32_bf16 v[172:175], a[168:171], v[76:79], v[172:175]
  v_exp_f32 v97, v97
  v_mfma_f32_16x16x32_bf16 v[188:191], a[172:175], v[76:79], v[188:191]
  ds_read_b64_tr_b16 a[158:159], v19 offset:8192
  v_mfma_f32_16x16x32_bf16 v[204:207], a[176:179], v[76:79], v[204:207]
  v_exp_f32 v98, v98
  v_mfma_f32_16x16x32_bf16 v[220:223], a[180:183], v[76:79], v[220:223]
  ds_read_b128 a[96:99], v8 offset:16384
  v_cvt_pk_bf16_f32 v68, v96, v97
  v_mfma_f32_16x16x32_bf16 v[236:239], a[184:187], v[76:79], v[236:239]
  v_exp_f32 v99, v99
  v_mfma_f32_16x16x32_bf16 v[252:255], a[188:191], v[76:79], v[252:255]
  s_add_u32 s59, s58, 5
  v_mfma_f32_16x16x32_bf16 v[32:35], a[64:67], a[32:35], v[88:91]
  s_and_b32 s59, s59, 7
  v_exp_f32 v100, v100
  v_mfma_f32_16x16x32_bf16 v[32:35], a[68:71], a[36:39], v[32:35]
  s_lshl_b32 s61, s59, 14
  ds_read_b128 a[100:103], v9 offset:16384
  v_cvt_pk_bf16_f32 v69, v98, v99
  v_mfma_f32_16x16x32_bf16 v[32:35], a[72:75], a[40:43], v[32:35]
  s_add_u32 s61, s61, s60
  v_exp_f32 v101, v101
  v_mfma_f32_16x16x32_bf16 v[32:35], a[76:79], a[44:47], v[32:35]
  s_add_u32 m0, s51, 98304
  ds_read_b128 a[104:107], v10 offset:16384
  v_mfma_f32_16x16x32_bf16 v[36:39], a[80:83], a[32:35], v[88:91]
  v_exp_f32 v102, v102
  v_mfma_f32_16x16x32_bf16 v[36:39], a[84:87], a[36:39], v[36:39]
  ds_read_b128 a[108:111], v11 offset:16384
  v_cvt_pk_bf16_f32 v70, v100, v101
  v_mfma_f32_16x16x32_bf16 v[36:39], a[88:91], a[40:43], v[36:39]
  v_exp_f32 v103, v103
  v_mfma_f32_16x16x32_bf16 v[36:39], a[92:95], a[44:47], v[36:39]
  s_waitcnt lgkmcnt(4)
  ds_read_b128 a[112:115], v8 offset:24576
  v_mfma_f32_16x16x32_bf16 v[48:51], v[124:127], v[64:67], v[48:51]
  ds_read_b128 a[116:119], v9 offset:24576
  v_cvt_pk_bf16_f32 v71, v102, v103
  v_mfma_f32_16x16x32_bf16 v[128:131], a[128:131], v[64:67], v[128:131]
  buffer_load_dwordx4 v20, s[16:19], s61 offen lds
  v_mfma_f32_16x16x32_bf16 v[144:147], a[132:135], v[64:67], v[144:147]
  v_exp_f32 v32, v32
  v_mfma_f32_16x16x32_bf16 v[160:163], a[136:139], v[64:67], v[160:163]
  v_exp_f32 v33, v33
  v_mfma_f32_16x16x32_bf16 v[176:179], a[140:143], v[64:67], v[176:179]
  ds_read_b128 a[120:123], v10 offset:24576
  v_mfma_f32_16x16x32_bf16 v[192:195], a[144:147], v[64:67], v[192:195]
  v_exp_f32 v34, v34
  v_mfma_f32_16x16x32_bf16 v[208:211], a[148:151], v[64:67], v[208:211]
  ds_read_b128 a[124:127], v11 offset:24576
  v_cvt_pk_bf16_f32 v72, v32, v33
  v_mfma_f32_16x16x32_bf16 v[224:227], a[152:155], v[64:67], v[224:227]
  v_exp_f32 v35, v35
  v_mfma_f32_16x16x32_bf16 v[240:243], a[156:159], v[64:67], v[240:243]
  buffer_load_dwordx4 v21, s[16:19], s61 offen offset:1024 lds
  v_mfma_f32_16x16x32_bf16 v[40:43], a[64:67], a[48:51], v[92:95]
  v_exp_f32 v36, v36
  v_mfma_f32_16x16x32_bf16 v[40:43], a[68:71], a[52:55], v[40:43]
  ds_read_b64_tr_b16 a[160:161], v12 offset:16384
  v_cvt_pk_bf16_f32 v73, v34, v35
  v_mfma_f32_16x16x32_bf16 v[40:43], a[72:75], a[56:59], v[40:43]
  v_exp_f32 v37, v37
  v_mfma_f32_16x16x32_bf16 v[40:43], a[76:79], a[60:63], v[40:43]
  ds_read_b64_tr_b16 a[162:163], v12 offset:24576
  v_mfma_f32_16x16x32_bf16 v[44:47], a[80:83], a[48:51], v[92:95]
  v_exp_f32 v38, v38
  v_mfma_f32_16x16x32_bf16 v[44:47], a[84:87], a[52:55], v[44:47]
  ds_read_b64_tr_b16 a[164:165], v13 offset:16384
  v_cvt_pk_bf16_f32 v74, v36, v37
  v_mfma_f32_16x16x32_bf16 v[44:47], a[88:91], a[56:59], v[44:47]
  v_exp_f32 v39, v39
  v_mfma_f32_16x16x32_bf16 v[44:47], a[92:95], a[60:63], v[44:47]
  ds_read_b64_tr_b16 a[166:167], v13 offset:24576
  v_mfma_f32_16x16x32_bf16 v[52:55], v[124:127], v[68:71], v[52:55]
  ds_read_b64_tr_b16 a[168:169], v14 offset:16384
  v_cvt_pk_bf16_f32 v75, v38, v39
  v_mfma_f32_16x16x32_bf16 v[132:135], a[128:131], v[68:71], v[132:135]
  buffer_load_dwordx4 v22, s[16:19], s61 offen offset:2048 lds
  v_mfma_f32_16x16x32_bf16 v[148:151], a[132:135], v[68:71], v[148:151]
  v_exp_f32 v40, v40
  v_mfma_f32_16x16x32_bf16 v[164:167], a[136:139], v[68:71], v[164:167]
  v_exp_f32 v41, v41
  v_mfma_f32_16x16x32_bf16 v[180:183], a[140:143], v[68:71], v[180:183]
  ds_read_b64_tr_b16 a[170:171], v14 offset:24576
  v_mfma_f32_16x16x32_bf16 v[196:199], a[144:147], v[68:71], v[196:199]
  v_exp_f32 v42, v42
  v_mfma_f32_16x16x32_bf16 v[212:215], a[148:151], v[68:71], v[212:215]
  ds_read_b64_tr_b16 a[172:173], v15 offset:16384
  v_cvt_pk_bf16_f32 v76, v40, v41
  v_mfma_f32_16x16x32_bf16 v[228:231], a[152:155], v[68:71], v[228:231]
  v_exp_f32 v43, v43
  v_mfma_f32_16x16x32_bf16 v[244:247], a[156:159], v[68:71], v[244:247]
  s_waitcnt lgkmcnt(7)
  buffer_load_dwordx4 v23, s[16:19], s61 offen offset:3072 lds
  v_mfma_f32_16x16x32_bf16 v[96:99], a[96:99], a[0:3], v[80:83]
  s_add_u32 m0, s51, 102400
  v_exp_f32 v44, v44
  v_mfma_f32_16x16x32_bf16 v[96:99], a[100:103], a[4:7], v[96:99]
  ds_read_b64_tr_b16 a[174:175], v15 offset:24576
  v_cvt_pk_bf16_f32 v77, v42, v43
  v_mfma_f32_16x16x32_bf16 v[96:99], a[104:107], a[8:11], v[96:99]
  v_exp_f32 v45, v45
  v_mfma_f32_16x16x32_bf16 v[96:99], a[108:111], a[12:15], v[96:99]
  ds_read_b64_tr_b16 a[176:177], v16 offset:16384
  v_mfma_f32_16x16x32_bf16 v[100:103], a[112:115], a[0:3], v[80:83]
  v_exp_f32 v46, v46
  v_mfma_f32_16x16x32_bf16 v[100:103], a[116:119], a[4:7], v[100:103]
  s_waitcnt vmcnt(6)
  ds_read_b64_tr_b16 a[178:179], v16 offset:24576
  v_cvt_pk_bf16_f32 v78, v44, v45
  v_mfma_f32_16x16x32_bf16 v[100:103], a[120:123], a[8:11], v[100:103]
  v_exp_f32 v47, v47
  v_mfma_f32_16x16x32_bf16 v[100:103], a[124:127], a[12:15], v[100:103]
  ds_read_b64_tr_b16 a[180:181], v17 offset:16384
  ds_read_b64_tr_b16 a[208:209], v4 offset:0
  v_mfma_f32_16x16x32_bf16 v[56:59], v[124:127], v[72:75], v[56:59]
  ds_read_b64_tr_b16 a[182:183], v17 offset:24576
  v_cvt_pk_bf16_f32 v79, v46, v47
  v_mfma_f32_16x16x32_bf16 v[136:139], a[128:131], v[72:75], v[136:139]
  buffer_load_dwordx4 v24, s[20:23], s61 offen lds
  v_mfma_f32_16x16x32_bf16 v[152:155], a[132:135], v[72:75], v[152:155]
  ds_read_b64_tr_b16 a[210:211], v4 offset:64
  v_exp_f32 v96, v96
  v_mfma_f32_16x16x32_bf16 v[168:171], a[136:139], v[72:75], v[168:171]
  v_exp_f32 v97, v97
  v_mfma_f32_16x16x32_bf16 v[184:187], a[140:143], v[72:75], v[184:187]
  ds_read_b64_tr_b16 a[184:185], v18 offset:16384
  v_mfma_f32_16x16x32_bf16 v[200:203], a[144:147], v[72:75], v[200:203]
  ds_read_b64_tr_b16 a[212:213], v4 offset:512
  v_exp_f32 v98, v98
  v_mfma_f32_16x16x32_bf16 v[216:219], a[148:151], v[72:75], v[216:219]
  ds_read_b64_tr_b16 a[186:187], v18 offset:24576
  v_cvt_pk_bf16_f32 v64, v96, v97
  v_mfma_f32_16x16x32_bf16 v[232:235], a[152:155], v[72:75], v[232:235]
  v_exp_f32 v99, v99
  v_mfma_f32_16x16x32_bf16 v[248:251], a[156:159], v[72:75], v[248:251]
  buffer_load_dwordx4 v25, s[20:23], s61 offen offset:1024 lds
  v_mfma_f32_16x16x32_bf16 v[32:35], a[96:99], a[16:19], v[84:87]
  ds_read_b64_tr_b16 a[214:215], v4 offset:576
  v_exp_f32 v100, v100
  v_mfma_f32_16x16x32_bf16 v[32:35], a[100:103], a[20:23], v[32:35]
  ds_read_b64_tr_b16 a[188:189], v19 offset:16384
  v_cvt_pk_bf16_f32 v65, v98, v99
  v_mfma_f32_16x16x32_bf16 v[32:35], a[104:107], a[24:27], v[32:35]
  ds_read_b64_tr_b16 a[216:217], v4 offset:1024
  v_exp_f32 v101, v101
  v_mfma_f32_16x16x32_bf16 v[32:35], a[108:111], a[28:31], v[32:35]
  ds_read_b64_tr_b16 a[190:191], v19 offset:24576
  v_mfma_f32_16x16x32_bf16 v[36:39], a[112:115], a[16:19], v[84:87]
  v_exp_f32 v102, v102
  v_mfma_f32_16x16x32_bf16 v[36:39], a[116:119], a[20:23], v[36:39]
  ds_read_b64_tr_b16 a[218:219], v4 offset:1088
  v_cvt_pk_bf16_f32 v66, v100, v101
  v_mfma_f32_16x16x32_bf16 v[36:39], a[120:123], a[24:27], v[36:39]
  v_exp_f32 v103, v103
  v_mfma_f32_16x16x32_bf16 v[36:39], a[124:127], a[28:31], v[36:39]
  buffer_load_dwordx4 v24, s[20:23], s61 offen offset:2048 lds
  v_mfma_f32_16x16x32_bf16 v[60:63], v[124:127], v[76:79], v[60:63]
  ds_read_b64_tr_b16 a[220:221], v4 offset:1536
  v_cvt_pk_bf16_f32 v67, v102, v103
  v_mfma_f32_16x16x32_bf16 v[140:143], a[128:131], v[76:79], v[140:143]
  buffer_load_dwordx4 v25, s[20:23], s61 offen offset:3072 lds
  v_mfma_f32_16x16x32_bf16 v[156:159], a[132:135], v[76:79], v[156:159]
  v_exp_f32 v32, v32
  v_mfma_f32_16x16x32_bf16 v[172:175], a[136:139], v[76:79], v[172:175]
  v_exp_f32 v33, v33
  v_mfma_f32_16x16x32_bf16 v[188:191], a[140:143], v[76:79], v[188:191]
  ds_read_b64_tr_b16 a[222:223], v4 offset:1600
  v_mfma_f32_16x16x32_bf16 v[204:207], a[144:147], v[76:79], v[204:207]
  s_waitcnt vmcnt(8)
  v_exp_f32 v34, v34
  v_mfma_f32_16x16x32_bf16 v[220:223], a[148:151], v[76:79], v[220:223]
  v_cvt_pk_bf16_f32 v68, v32, v33
  v_mfma_f32_16x16x32_bf16 v[236:239], a[152:155], v[76:79], v[236:239]
  v_exp_f32 v35, v35
  v_mfma_f32_16x16x32_bf16 v[252:255], a[156:159], v[76:79], v[252:255]
  v_and_b32 v109, 0xffff0000, v108
  v_rcp_f32 v109, v109
  v_mfma_f32_16x16x32_bf16 v[40:43], a[96:99], a[32:35], v[88:91]
  v_exp_f32 v36, v36
  v_mfma_f32_16x16x32_bf16 v[40:43], a[100:103], a[36:39], v[40:43]
  v_cvt_pk_bf16_f32 v69, v34, v35
  v_mfma_f32_16x16x32_bf16 v[40:43], a[104:107], a[40:43], v[40:43]
  v_exp_f32 v37, v37
  v_mfma_f32_16x16x32_bf16 v[40:43], a[108:111], a[44:47], v[40:43]
  v_lshlrev_b32 v108, 16, v108
  v_lshlrev_b32 v110, 16, v106
  v_mfma_f32_16x16x32_bf16 v[44:47], a[112:115], a[32:35], v[88:91]
  v_exp_f32 v38, v38
  v_mfma_f32_16x16x32_bf16 v[44:47], a[116:119], a[36:39], v[44:47]
  v_cvt_pk_bf16_f32 v70, v36, v37
  v_mfma_f32_16x16x32_bf16 v[44:47], a[120:123], a[40:43], v[44:47]
  s_waitcnt vmcnt(26) lgkmcnt(0)
  v_exp_f32 v39, v39
  v_mfma_f32_16x16x32_bf16 v[44:47], a[124:127], a[44:47], v[44:47]
  s_barrier
  ds_read_b128 a[64:67], v8 offset:32768
  v_and_b32 v111, 0xffff0000, v106
  v_mfma_f32_16x16x32_bf16 v[48:51], v[124:127], v[64:67], v[48:51]
  ds_read_b128 a[68:71], v9 offset:32768
  v_cvt_pk_bf16_f32 v71, v38, v39
  v_mfma_f32_16x16x32_bf16 v[128:131], a[160:163], v[64:67], v[128:131]
  v_lshlrev_b32 v112, 16, v107
  v_and_b32 v113, 0xffff0000, v107
  v_mfma_f32_16x16x32_bf16 v[144:147], a[164:167], v[64:67], v[144:147]
  v_exp_f32 v40, v40
  v_mfma_f32_16x16x32_bf16 v[160:163], a[168:171], v[64:67], v[160:163]
  s_add_u32 s59, s56, 131072
  v_exp_f32 v41, v41
  v_mfma_f32_16x16x32_bf16 v[176:179], a[172:175], v[64:67], v[176:179]
  s_add_u32 m0, s51, 135168
  ds_read_b128 a[72:75], v10 offset:32768
  v_sub_f32 v110, v110, v108
  v_sub_f32 v111, v111, v108
  v_mfma_f32_16x16x32_bf16 v[192:195], a[176:179], v[64:67], v[192:195]
  buffer_load_dwordx4 v5, s[12:15], s59 offen lds
  v_exp_f32 v42, v42
  v_mfma_f32_16x16x32_bf16 v[208:211], a[180:183], v[64:67], v[208:211]
  ds_read_b128 a[76:79], v11 offset:32768
  v_cvt_pk_bf16_f32 v72, v40, v41
  v_mfma_f32_16x16x32_bf16 v[224:227], a[184:187], v[64:67], v[224:227]
  v_exp_f32 v43, v43
  v_mfma_f32_16x16x32_bf16 v[240:243], a[188:191], v[64:67], v[240:243]
  v_sub_f32 v112, v112, v108
  v_sub_f32 v113, v113, v108
  v_cvt_pk_bf16_f32 v106, v110, v111
  v_mfma_f32_16x16x32_bf16 v[96:99], a[96:99], a[48:51], v[92:95]
  v_exp_f32 v44, v44
  v_mfma_f32_16x16x32_bf16 v[96:99], a[100:103], a[52:55], v[96:99]
  ds_read_b128 a[80:83], v8 offset:40960
  v_cvt_pk_bf16_f32 v73, v42, v43
  v_mfma_f32_16x16x32_bf16 v[96:99], a[104:107], a[56:59], v[96:99]
  v_exp_f32 v45, v45
  v_mfma_f32_16x16x32_bf16 v[96:99], a[108:111], a[60:63], v[96:99]
  ds_read_b128 a[84:87], v9 offset:40960
  v_cvt_pk_bf16_f32 v107, v112, v113
  v_lshlrev_b32 v110, 16, v106
  v_mfma_f32_16x16x32_bf16 v[100:103], a[112:115], a[48:51], v[92:95]
  v_exp_f32 v46, v46
  v_mfma_f32_16x16x32_bf16 v[100:103], a[116:119], a[52:55], v[100:103]
  ds_read_b128 a[88:91], v10 offset:40960
  v_cvt_pk_bf16_f32 v74, v44, v45
  v_mfma_f32_16x16x32_bf16 v[100:103], a[120:123], a[56:59], v[100:103]
  v_exp_f32 v47, v47
  v_mfma_f32_16x16x32_bf16 v[100:103], a[124:127], a[60:63], v[100:103]
  ds_read_b128 a[92:95], v11 offset:40960
  v_and_b32 v111, 0xffff0000, v106
  v_mfma_f32_16x16x32_bf16 v[52:55], v[124:127], v[68:71], v[52:55]
  ds_read_b64_tr_b16 a[128:129], v12 offset:32768
  v_cvt_pk_bf16_f32 v75, v46, v47
  v_mfma_f32_16x16x32_bf16 v[132:135], a[160:163], v[68:71], v[132:135]
  v_lshlrev_b32 v112, 16, v107
  v_and_b32 v113, 0xffff0000, v107
  v_mfma_f32_16x16x32_bf16 v[148:151], a[164:167], v[68:71], v[148:151]
  v_exp_f32 v96, v96
  v_mfma_f32_16x16x32_bf16 v[164:167], a[168:171], v[68:71], v[164:167]
  v_exp_f32 v97, v97
  v_mfma_f32_16x16x32_bf16 v[180:183], a[172:175], v[68:71], v[180:183]
  ds_read_b64_tr_b16 a[130:131], v12 offset:40960
  v_mul_f32 v110, v110, v109
  v_mul_f32 v111, v111, v109
  v_mfma_f32_16x16x32_bf16 v[196:199], a[176:179], v[68:71], v[196:199]
  v_exp_f32 v98, v98
  v_mfma_f32_16x16x32_bf16 v[212:215], a[180:183], v[68:71], v[212:215]
  ds_read_b64_tr_b16 a[132:133], v13 offset:32768
  v_cvt_pk_bf16_f32 v76, v96, v97
  v_mfma_f32_16x16x32_bf16 v[228:231], a[184:187], v[68:71], v[228:231]
  v_exp_f32 v99, v99
  v_mfma_f32_16x16x32_bf16 v[244:247], a[188:191], v[68:71], v[244:247]
  s_waitcnt lgkmcnt(3)
  v_mul_f32 v112, v112, v109
  v_mul_f32 v113, v113, v109
  v_cvt_pk_bf16_f32 v106, v110, v111
  v_mfma_f32_16x16x32_bf16 v[32:35], a[64:67], a[0:3], v[80:83]
  v_exp_f32 v100, v100
  v_mfma_f32_16x16x32_bf16 v[32:35], a[68:71], a[4:7], v[32:35]
  ds_read_b64_tr_b16 a[134:135], v13 offset:40960
  v_cvt_pk_bf16_f32 v77, v98, v99
  v_mfma_f32_16x16x32_bf16 v[32:35], a[72:75], a[8:11], v[32:35]
  v_exp_f32 v101, v101
  v_mfma_f32_16x16x32_bf16 v[32:35], a[76:79], a[12:15], v[32:35]
  ds_read_b64_tr_b16 a[136:137], v14 offset:32768
  v_cvt_pk_bf16_f32 v107, v112, v113
  v_mfma_f32_16x16x32_bf16 v[36:39], a[80:83], a[0:3], v[80:83]
  ds_write_b64 v114, v[106:107]
  v_exp_f32 v102, v102
  v_mfma_f32_16x16x32_bf16 v[36:39], a[84:87], a[4:7], v[36:39]
  ds_read_b64_tr_b16 a[138:139], v14 offset:40960
  v_cvt_pk_bf16_f32 v78, v100, v101
  v_mfma_f32_16x16x32_bf16 v[36:39], a[88:91], a[8:11], v[36:39]
  ds_read_b128 a[192:195], v115 offset:0
  v_exp_f32 v103, v103
  v_mfma_f32_16x16x32_bf16 v[36:39], a[92:95], a[12:15], v[36:39]
  ds_read_b64_tr_b16 a[140:141], v15 offset:32768
  v_mfma_f32_16x16x32_bf16 v[56:59], v[124:127], v[72:75], v[56:59]
  ds_read_b64_tr_b16 a[142:143], v15 offset:40960
  v_cvt_pk_bf16_f32 v79, v102, v103
  v_mfma_f32_16x16x32_bf16 v[136:139], a[160:163], v[72:75], v[136:139]
  ds_read_b128 a[196:199], v115 offset:64
  ds_read_b128 a[200:203], v115 offset:128
  v_mfma_f32_16x16x32_bf16 v[152:155], a[164:167], v[72:75], v[152:155]
  ds_read_b128 a[204:207], v115 offset:192
  v_exp_f32 v32, v32
  v_mfma_f32_16x16x32_bf16 v[168:171], a[168:171], v[72:75], v[168:171]
  v_exp_f32 v33, v33
  v_mfma_f32_16x16x32_bf16 v[184:187], a[172:175], v[72:75], v[184:187]
  ds_read_b64_tr_b16 a[144:145], v16 offset:32768
  v_mfma_f32_16x16x32_bf16 v[200:203], a[176:179], v[72:75], v[200:203]
  v_exp_f32 v34, v34
  v_mfma_f32_16x16x32_bf16 v[216:219], a[180:183], v[72:75], v[216:219]
  ds_read_b64_tr_b16 a[146:147], v16 offset:40960
  v_cvt_pk_bf16_f32 v64, v32, v33
  v_mfma_f32_16x16x32_bf16 v[232:235], a[184:187], v[72:75], v[232:235]
  v_exp_f32 v35, v35
  v_mfma_f32_16x16x32_bf16 v[248:251], a[188:191], v[72:75], v[248:251]
  s_waitcnt lgkmcnt(2)
  v_mfma_f32_16x16x32_bf16 v[116:119], a[208:211], a[192:195], 0
  v_exp_f32 v36, v36
  v_mfma_f32_16x16x32_bf16 v[116:119], a[212:215], a[196:199], v[116:119]
  ds_read_b64_tr_b16 a[148:149], v17 offset:32768
  v_cvt_pk_bf16_f32 v65, v34, v35
  v_mfma_f32_16x16x32_bf16 v[116:119], a[216:219], a[200:203], v[116:119]
  v_exp_f32 v37, v37
  v_mfma_f32_16x16x32_bf16 v[116:119], a[220:223], a[204:207], v[116:119]
  ds_read_b64_tr_b16 a[150:151], v17 offset:40960
  v_mfma_f32_16x16x32_bf16 v[40:43], a[64:67], a[16:19], v[84:87]
  v_exp_f32 v38, v38
  v_mfma_f32_16x16x32_bf16 v[40:43], a[68:71], a[20:23], v[40:43]
  ds_read_b64_tr_b16 a[152:153], v18 offset:32768
  v_cvt_pk_bf16_f32 v66, v36, v37
  v_mfma_f32_16x16x32_bf16 v[40:43], a[72:75], a[24:27], v[40:43]
  s_add_u32 s59, s56, 163840
  v_exp_f32 v39, v39
  v_mfma_f32_16x16x32_bf16 v[40:43], a[76:79], a[28:31], v[40:43]
  s_add_u32 m0, s51, 136192
  ds_read_b64_tr_b16 a[154:155], v18 offset:40960
  ds_write_b128 v26, v[116:119] offset:1024
  v_mfma_f32_16x16x32_bf16 v[44:47], a[80:83], a[16:19], v[84:87]
  ds_read_b64_tr_b16 a[156:157], v19 offset:32768
  v_cvt_pk_bf16_f32 v67, v38, v39
  v_mfma_f32_16x16x32_bf16 v[44:47], a[84:87], a[20:23], v[44:47]
  buffer_load_dwordx4 v5, s[12:15], s59 offen lds
  v_mfma_f32_16x16x32_bf16 v[44:47], a[88:91], a[24:27], v[44:47]
  v_mfma_f32_16x16x32_bf16 v[44:47], a[92:95], a[28:31], v[44:47]
  v_mfma_f32_16x16x32_bf16 v[60:63], v[124:127], v[76:79], v[60:63]
  v_mfma_f32_16x16x32_bf16 v[140:143], a[160:163], v[76:79], v[140:143]
  v_mfma_f32_16x16x32_bf16 v[156:159], a[164:167], v[76:79], v[156:159]
  s_waitcnt lgkmcnt(1)
  v_exp_f32 v40, v40
  v_mfma_f32_16x16x32_bf16 v[172:175], a[168:171], v[76:79], v[172:175]
  s_barrier
  ds_read_b32 v104, v27 offset:1024
  v_exp_f32 v41, v41
  v_mfma_f32_16x16x32_bf16 v[188:191], a[172:175], v[76:79], v[188:191]
  s_add_u32 s59, s58, 6
  ds_read_b64_tr_b16 a[158:159], v19 offset:40960
  ds_read_b32 v105, v27 offset:9216
  v_mfma_f32_16x16x32_bf16 v[204:207], a[176:179], v[76:79], v[204:207]
  s_and_b32 s59, s59, 7
  ds_read_b32 v106, v27 offset:17408
  v_exp_f32 v42, v42
  v_mfma_f32_16x16x32_bf16 v[220:223], a[180:183], v[76:79], v[220:223]
  s_lshl_b32 s61, s59, 14
  ds_read_b128 a[96:99], v8 offset:49152
  v_cvt_pk_bf16_f32 v68, v40, v41
  v_mfma_f32_16x16x32_bf16 v[236:239], a[184:187], v[76:79], v[236:239]
  s_add_u32 s61, s61, s60
  ds_read_b32 v107, v27 offset:25600
  v_exp_f32 v43, v43
  v_mfma_f32_16x16x32_bf16 v[252:255], a[188:191], v[76:79], v[252:255]
  s_add_u32 m0, s51, 0
  v_and_b32 v110, 1, v1
  v_lshlrev_b32 v110, 4, v110
  v_and_b32 v111, 1, v2
  v_mfma_f32_16x16x32_bf16 v[96:99], a[64:67], a[32:35], v[88:91]
  s_lshl_b32 s69, s53, 7
  v_exp_f32 v44, v44
  v_lshl_add_u32 v111, v111, 3, v110
  v_mfma_f32_16x16x32_bf16 v[96:99], a[68:71], a[36:39], v[96:99]
  s_lshl_b32 s3, s44, 1
  ds_read_b128 a[100:103], v9 offset:49152
  v_cvt_pk_bf16_f32 v69, v42, v43
  v_mfma_f32_16x16x32_bf16 v[96:99], a[72:75], a[40:43], v[96:99]
  s_add_u32 s69, s69, s3
  v_exp_f32 v45, v45
  v_mfma_f32_16x16x32_bf16 v[96:99], a[76:79], a[44:47], v[96:99]
  s_add_u32 s69, s69, 0x18000
  s_waitcnt lgkmcnt(1)
  ds_read_b128 a[104:107], v10 offset:49152
  v_add_f32 v104, v104, v105
  v_mfma_f32_16x16x32_bf16 v[100:103], a[80:83], a[32:35], v[88:91]
  s_cmp_lt_u32 s53, 172
  s_cselect_b32 s69, s69, 0x40000000
  v_exp_f32 v46, v46
  v_mfma_f32_16x16x32_bf16 v[100:103], a[84:87], a[36:39], v[100:103]
  ds_read_b128 a[108:111], v11 offset:49152
  v_cvt_pk_bf16_f32 v70, v44, v45
  v_add_f32 v106, v106, v107
  v_mfma_f32_16x16x32_bf16 v[100:103], a[88:91], a[40:43], v[100:103]
  v_exp_f32 v47, v47
  v_mfma_f32_16x16x32_bf16 v[100:103], a[92:95], a[44:47], v[100:103]
  s_waitcnt lgkmcnt(7)
  ds_read_b128 a[112:115], v8 offset:57344
  v_add_f32 v104, v104, v106
  v_cvt_pk_bf16_f32 v104, v104, v104
  v_mfma_f32_16x16x32_bf16 v[48:51], v[124:127], v[64:67], v[48:51]
  ds_read_b128 a[116:119], v9 offset:57344
  v_cvt_pk_bf16_f32 v71, v46, v47
  v_lshlrev_b32 v104, 16, v104
  v_mfma_f32_16x16x32_bf16 v[128:131], a[128:131], v[64:67], v[128:131]
  buffer_load_dwordx4 v20, s[16:19], s61 offen lds
  v_mov_b32 v105, v104
  v_mfma_f32_16x16x32_bf16 v[144:147], a[132:135], v[64:67], v[144:147]
  v_exp_f32 v96, v96
  v_mfma_f32_16x16x32_bf16 v[160:163], a[136:139], v[64:67], v[160:163]
  v_exp_f32 v97, v97
  v_mfma_f32_16x16x32_bf16 v[176:179], a[140:143], v[64:67], v[176:179]
  ds_read_b128 a[120:123], v10 offset:57344
  v_permlane32_swap_b32 v104, v105
  v_mul_f32 v106, 0xbfb8aa3b, v104
  v_mfma_f32_16x16x32_bf16 v[192:195], a[144:147], v[64:67], v[192:195]
  v_exp_f32 v98, v98
  v_exp_f32 v106, v106
  v_mfma_f32_16x16x32_bf16 v[208:211], a[148:151], v[64:67], v[208:211]
  ds_read_b128 a[124:127], v11 offset:57344
  v_cvt_pk_bf16_f32 v72, v96, v97
  v_add_f32 v106, 1.0, v106
  v_mfma_f32_16x16x32_bf16 v[224:227], a[152:155], v[64:67], v[224:227]
  v_exp_f32 v99, v99
  v_rcp_f32 v106, v106
  v_mfma_f32_16x16x32_bf16 v[240:243], a[156:159], v[64:67], v[240:243]
  buffer_load_dwordx4 v21, s[16:19], s61 offen offset:1024 lds
  v_mul_f32 v104, v104, v106
  v_mfma_f32_16x16x32_bf16 v[32:35], a[64:67], a[48:51], v[92:95]
  v_exp_f32 v100, v100
  v_cvt_pk_bf16_f32 v104, v104, v104
  v_mfma_f32_16x16x32_bf16 v[32:35], a[68:71], a[52:55], v[32:35]
  ds_read_b64_tr_b16 a[160:161], v12 offset:49152
  v_cvt_pk_bf16_f32 v73, v98, v99
  v_mfma_f32_16x16x32_bf16 v[32:35], a[72:75], a[56:59], v[32:35]
  v_exp_f32 v101, v101
  v_mfma_f32_16x16x32_bf16 v[32:35], a[76:79], a[60:63], v[32:35]
  ds_read_b64_tr_b16 a[162:163], v12 offset:57344
  v_lshlrev_b32 v104, 16, v104
  v_mul_f32 v104, v104, v105
  v_mfma_f32_16x16x32_bf16 v[36:39], a[80:83], a[48:51], v[92:95]
  v_exp_f32 v102, v102
  v_cvt_pk_bf16_f32 v108, v104, v104
  v_mfma_f32_16x16x32_bf16 v[36:39], a[84:87], a[52:55], v[36:39]
  ds_read_b64_tr_b16 a[164:165], v13 offset:49152
  v_cvt_pk_bf16_f32 v74, v100, v101
  v_mfma_f32_16x16x32_bf16 v[36:39], a[88:91], a[56:59], v[36:39]
  buffer_store_short v108, v111, s[8:11], s69 offen sc1
  v_exp_f32 v103, v103
  v_mfma_f32_16x16x32_bf16 v[36:39], a[92:95], a[60:63], v[36:39]
  ds_read_b64_tr_b16 a[166:167], v13 offset:57344
  v_mov_b32 v104, s43
  v_mov_b32 v105, 64
  v_mfma_f32_16x16x32_bf16 v[52:55], v[124:127], v[68:71], v[52:55]
  ds_read_b64_tr_b16 a[168:169], v14 offset:49152
  v_cvt_pk_bf16_f32 v75, v102, v103
  v_mfma_f32_16x16x32_bf16 v[132:135], a[128:131], v[68:71], v[132:135]
  s_cmp_eq_u32 s44, 0
  s_cselect_b32 s69, s69, 0x40000000
  buffer_load_dwordx4 v22, s[16:19], s61 offen offset:2048 lds
  v_mfma_f32_16x16x32_bf16 v[148:151], a[132:135], v[68:71], v[148:151]
  v_exp_f32 v32, v32
  v_mfma_f32_16x16x32_bf16 v[164:167], a[136:139], v[68:71], v[164:167]
  v_exp_f32 v33, v33
  v_mfma_f32_16x16x32_bf16 v[180:183], a[140:143], v[68:71], v[180:183]
  ds_read_b64_tr_b16 a[170:171], v14 offset:57344
  v_mfma_f32_16x16x32_bf16 v[196:199], a[144:147], v[68:71], v[196:199]
  v_exp_f32 v34, v34
  v_mfma_f32_16x16x32_bf16 v[212:215], a[148:151], v[68:71], v[212:215]
  ds_read_b64_tr_b16 a[172:173], v15 offset:49152
  v_cvt_pk_bf16_f32 v76, v32, v33
  v_mfma_f32_16x16x32_bf16 v[228:231], a[152:155], v[68:71], v[228:231]
  v_exp_f32 v35, v35
  v_mfma_f32_16x16x32_bf16 v[244:247], a[156:159], v[68:71], v[244:247]
  s_waitcnt lgkmcnt(7)
  buffer_load_dwordx4 v23, s[16:19], s61 offen offset:3072 lds
  v_mfma_f32_16x16x32_bf16 v[40:43], a[96:99], a[0:3], v[80:83]
  s_add_u32 m0, s51, 4096
  v_exp_f32 v36, v36
  v_mfma_f32_16x16x32_bf16 v[40:43], a[100:103], a[4:7], v[40:43]
  ds_read_b64_tr_b16 a[174:175], v15 offset:57344
  v_cvt_pk_bf16_f32 v77, v34, v35
  v_mfma_f32_16x16x32_bf16 v[40:43], a[104:107], a[8:11], v[40:43]
  v_exp_f32 v37, v37
  v_mfma_f32_16x16x32_bf16 v[40:43], a[108:111], a[12:15], v[40:43]
  ds_read_b64_tr_b16 a[176:177], v16 offset:49152
  v_mfma_f32_16x16x32_bf16 v[44:47], a[112:115], a[0:3], v[80:83]
  v_exp_f32 v38, v38
  v_mfma_f32_16x16x32_bf16 v[44:47], a[116:119], a[4:7], v[44:47]
  ds_read_b64_tr_b16 a[178:179], v16 offset:57344
  v_cvt_pk_bf16_f32 v78, v36, v37
  v_mfma_f32_16x16x32_bf16 v[44:47], a[120:123], a[8:11], v[44:47]
  v_exp_f32 v39, v39
  v_mfma_f32_16x16x32_bf16 v[44:47], a[124:127], a[12:15], v[44:47]
  ds_read_b64_tr_b16 a[180:181], v17 offset:49152
  v_mfma_f32_16x16x32_bf16 v[56:59], v[124:127], v[72:75], v[56:59]
  ds_read_b64_tr_b16 a[182:183], v17 offset:57344
  v_cvt_pk_bf16_f32 v79, v38, v39
  v_mfma_f32_16x16x32_bf16 v[136:139], a[128:131], v[72:75], v[136:139]
  buffer_load_dwordx4 v24, s[20:23], s61 offen lds
  v_mfma_f32_16x16x32_bf16 v[152:155], a[132:135], v[72:75], v[152:155]
  v_exp_f32 v40, v40
  v_mfma_f32_16x16x32_bf16 v[168:171], a[136:139], v[72:75], v[168:171]
  v_exp_f32 v41, v41
  v_mfma_f32_16x16x32_bf16 v[184:187], a[140:143], v[72:75], v[184:187]
  ds_read_b64_tr_b16 a[184:185], v18 offset:49152
  v_mfma_f32_16x16x32_bf16 v[200:203], a[144:147], v[72:75], v[200:203]
  v_exp_f32 v42, v42
  v_mfma_f32_16x16x32_bf16 v[216:219], a[148:151], v[72:75], v[216:219]
  ds_read_b64_tr_b16 a[186:187], v18 offset:57344
  v_cvt_pk_bf16_f32 v64, v40, v41
  v_mfma_f32_16x16x32_bf16 v[232:235], a[152:155], v[72:75], v[232:235]
  v_exp_f32 v43, v43
  v_mfma_f32_16x16x32_bf16 v[248:251], a[156:159], v[72:75], v[248:251]
  buffer_load_dwordx4 v25, s[20:23], s61 offen offset:1024 lds
  v_mfma_f32_16x16x32_bf16 v[96:99], a[96:99], a[16:19], v[84:87]
  v_exp_f32 v44, v44
  v_mfma_f32_16x16x32_bf16 v[96:99], a[100:103], a[20:23], v[96:99]
  ds_read_b64_tr_b16 a[188:189], v19 offset:49152
  v_cvt_pk_bf16_f32 v65, v42, v43
  v_mfma_f32_16x16x32_bf16 v[96:99], a[104:107], a[24:27], v[96:99]
  v_exp_f32 v45, v45
  v_mfma_f32_16x16x32_bf16 v[96:99], a[108:111], a[28:31], v[96:99]
  ds_read_b64_tr_b16 a[190:191], v19 offset:57344
  v_mfma_f32_16x16x32_bf16 v[100:103], a[112:115], a[16:19], v[84:87]
  v_exp_f32 v46, v46
  v_mfma_f32_16x16x32_bf16 v[100:103], a[116:119], a[20:23], v[100:103]
  v_cvt_pk_bf16_f32 v66, v44, v45
  v_mfma_f32_16x16x32_bf16 v[100:103], a[120:123], a[24:27], v[100:103]
  v_exp_f32 v47, v47
  v_mfma_f32_16x16x32_bf16 v[100:103], a[124:127], a[28:31], v[100:103]
  buffer_load_dwordx4 v24, s[20:23], s61 offen offset:2048 lds
  v_mfma_f32_16x16x32_bf16 v[60:63], v[124:127], v[76:79], v[60:63]
  v_cvt_pk_bf16_f32 v67, v46, v47
  v_mfma_f32_16x16x32_bf16 v[140:143], a[128:131], v[76:79], v[140:143]
  buffer_load_dwordx4 v25, s[20:23], s61 offen offset:3072 lds
  v_mfma_f32_16x16x32_bf16 v[156:159], a[132:135], v[76:79], v[156:159]
  v_exp_f32 v96, v96
  v_mfma_f32_16x16x32_bf16 v[172:175], a[136:139], v[76:79], v[172:175]
  v_exp_f32 v97, v97
  v_mfma_f32_16x16x32_bf16 v[188:191], a[140:143], v[76:79], v[188:191]
  v_xor_b32 v8, 0x10000, v8
  v_mfma_f32_16x16x32_bf16 v[204:207], a[144:147], v[76:79], v[204:207]
  v_exp_f32 v98, v98
  v_mfma_f32_16x16x32_bf16 v[220:223], a[148:151], v[76:79], v[220:223]
  v_cvt_pk_bf16_f32 v68, v96, v97
  v_mfma_f32_16x16x32_bf16 v[236:239], a[152:155], v[76:79], v[236:239]
  v_exp_f32 v99, v99
  v_mfma_f32_16x16x32_bf16 v[252:255], a[156:159], v[76:79], v[252:255]
  v_xor_b32 v9, 0x10000, v9
  v_mfma_f32_16x16x32_bf16 v[32:35], a[96:99], a[32:35], v[88:91]
  v_exp_f32 v100, v100
  v_xor_b32 v12, 0x10000, v12
  v_mfma_f32_16x16x32_bf16 v[32:35], a[100:103], a[36:39], v[32:35]
  v_cvt_pk_bf16_f32 v69, v98, v99
  v_xor_b32 v10, 0x10000, v10
  v_mfma_f32_16x16x32_bf16 v[32:35], a[104:107], a[40:43], v[32:35]
  v_exp_f32 v101, v101
  v_mfma_f32_16x16x32_bf16 v[32:35], a[108:111], a[44:47], v[32:35]
  v_xor_b32 v13, 0x10000, v13
  v_mfma_f32_16x16x32_bf16 v[36:39], a[112:115], a[32:35], v[88:91]
  v_exp_f32 v102, v102
  v_mfma_f32_16x16x32_bf16 v[36:39], a[116:119], a[36:39], v[36:39]
  s_waitcnt vmcnt(6)
  v_cvt_pk_bf16_f32 v70, v100, v101
  v_xor_b32 v11, 0x10000, v11
  v_mfma_f32_16x16x32_bf16 v[36:39], a[120:123], a[40:43], v[36:39]
  s_waitcnt vmcnt(22) lgkmcnt(0)
  v_exp_f32 v103, v103
  v_mfma_f32_16x16x32_bf16 v[36:39], a[124:127], a[44:47], v[36:39]
  s_barrier
  ds_read_b128 a[64:67], v8 offset:0
  v_xor_b32 v14, 0x10000, v14
  v_mfma_f32_16x16x32_bf16 v[48:51], v[124:127], v[64:67], v[48:51]
  ds_read_b128 a[68:71], v9 offset:0
  v_cvt_pk_bf16_f32 v71, v102, v103
  v_mfma_f32_16x16x32_bf16 v[128:131], a[160:163], v[64:67], v[128:131]
  buffer_store_dword v104, v105, s[8:11], s69 offen sc1
  v_xor_b32 v15, 0x10000, v15
  v_mfma_f32_16x16x32_bf16 v[144:147], a[164:167], v[64:67], v[144:147]
  v_exp_f32 v32, v32
  v_mfma_f32_16x16x32_bf16 v[160:163], a[168:171], v[64:67], v[160:163]
  v_exp_f32 v33, v33
  v_mfma_f32_16x16x32_bf16 v[176:179], a[172:175], v[64:67], v[176:179]
  ds_read_b128 a[72:75], v10 offset:0
  v_xor_b32 v16, 0x10000, v16
  v_mfma_f32_16x16x32_bf16 v[192:195], a[176:179], v[64:67], v[192:195]
  v_exp_f32 v34, v34
  v_mfma_f32_16x16x32_bf16 v[208:211], a[180:183], v[64:67], v[208:211]
  ds_read_b128 a[76:79], v11 offset:0
  v_cvt_pk_bf16_f32 v72, v32, v33
  v_mfma_f32_16x16x32_bf16 v[224:227], a[184:187], v[64:67], v[224:227]
  v_exp_f32 v35, v35
  v_mfma_f32_16x16x32_bf16 v[240:243], a[188:191], v[64:67], v[240:243]
  v_xor_b32 v17, 0x10000, v17
  v_mfma_f32_16x16x32_bf16 v[40:43], a[96:99], a[48:51], v[92:95]
  v_exp_f32 v36, v36
  v_mfma_f32_16x16x32_bf16 v[40:43], a[100:103], a[52:55], v[40:43]
  ds_read_b128 a[80:83], v8 offset:8192
  v_cvt_pk_bf16_f32 v73, v34, v35
  v_xor_b32 v18, 0x10000, v18
  v_mfma_f32_16x16x32_bf16 v[40:43], a[104:107], a[56:59], v[40:43]
  s_mov_b32 s12, s8
  v_exp_f32 v37, v37
  v_mfma_f32_16x16x32_bf16 v[40:43], a[108:111], a[60:63], v[40:43]
  s_mov_b32 s13, s9
  ds_read_b128 a[84:87], v9 offset:8192
  v_mfma_f32_16x16x32_bf16 v[44:47], a[112:115], a[48:51], v[92:95]
  s_mov_b32 s14, 0x1d600
  v_exp_f32 v38, v38
  v_xor_b32 v19, 0x10000, v19
  v_mfma_f32_16x16x32_bf16 v[44:47], a[116:119], a[52:55], v[44:47]
  s_mov_b32 s15, 0x00020000
  ds_read_b128 a[88:91], v10 offset:8192
  v_cvt_pk_bf16_f32 v74, v36, v37
  v_mfma_f32_16x16x32_bf16 v[44:47], a[120:123], a[56:59], v[44:47]
  s_lshl_b32 s56, s57, 9
  v_exp_f32 v39, v39
  v_mfma_f32_16x16x32_bf16 v[44:47], a[124:127], a[60:63], v[44:47]
  s_add_u32 s56, s56, 0x18000
  ds_read_b128 a[92:95], v11 offset:8192
  v_lshl_add_u32 v111, v2, 7, v110
  v_mfma_f32_16x16x32_bf16 v[52:55], v[124:127], v[68:71], v[52:55]
  ds_read_b64_tr_b16 a[128:129], v12 offset:0
  v_cvt_pk_bf16_f32 v75, v38, v39
  v_mfma_f32_16x16x32_bf16 v[132:135], a[160:163], v[68:71], v[132:135]
  v_mfma_f32_16x16x32_bf16 v[148:151], a[164:167], v[68:71], v[148:151]
  v_exp_f32 v40, v40
  v_mfma_f32_16x16x32_bf16 v[164:167], a[168:171], v[68:71], v[164:167]
  v_exp_f32 v41, v41
  v_mfma_f32_16x16x32_bf16 v[180:183], a[172:175], v[68:71], v[180:183]
  ds_read_b64_tr_b16 a[130:131], v12 offset:8192
  v_mfma_f32_16x16x32_bf16 v[196:199], a[176:179], v[68:71], v[196:199]
  v_exp_f32 v42, v42
  v_mfma_f32_16x16x32_bf16 v[212:215], a[180:183], v[68:71], v[212:215]
  ds_read_b64_tr_b16 a[132:133], v13 offset:0
  v_cvt_pk_bf16_f32 v76, v40, v41
  v_mfma_f32_16x16x32_bf16 v[228:231], a[184:187], v[68:71], v[228:231]
  v_exp_f32 v43, v43
  v_mfma_f32_16x16x32_bf16 v[244:247], a[188:191], v[68:71], v[244:247]
  s_waitcnt lgkmcnt(3)
  v_mfma_f32_16x16x32_bf16 v[96:99], a[64:67], a[0:3], v[80:83]
  v_exp_f32 v44, v44
  v_mfma_f32_16x16x32_bf16 v[96:99], a[68:71], a[4:7], v[96:99]
  ds_read_b64_tr_b16 a[134:135], v13 offset:8192
  v_cvt_pk_bf16_f32 v77, v42, v43
  v_mfma_f32_16x16x32_bf16 v[96:99], a[72:75], a[8:11], v[96:99]
  v_exp_f32 v45, v45
  v_mfma_f32_16x16x32_bf16 v[96:99], a[76:79], a[12:15], v[96:99]
  ds_read_b64_tr_b16 a[136:137], v14 offset:0
  v_lshl_add_u32 v4, v2, 3, v29
  v_mfma_f32_16x16x32_bf16 v[100:103], a[80:83], a[0:3], v[80:83]
  v_exp_f32 v46, v46
  v_mfma_f32_16x16x32_bf16 v[100:103], a[84:87], a[4:7], v[100:103]
  ds_read_b64_tr_b16 a[138:139], v14 offset:8192
  v_cvt_pk_bf16_f32 v78, v44, v45
  v_mfma_f32_16x16x32_bf16 v[100:103], a[88:91], a[8:11], v[100:103]
  v_exp_f32 v47, v47
  v_mfma_f32_16x16x32_bf16 v[100:103], a[92:95], a[12:15], v[100:103]
  ds_read_b64_tr_b16 a[140:141], v15 offset:0
  v_lshlrev_b32 v4, 5, v4
  v_mfma_f32_16x16x32_bf16 v[56:59], v[124:127], v[72:75], v[56:59]
  ds_read_b64_tr_b16 a[142:143], v15 offset:8192
  v_cvt_pk_bf16_f32 v79, v46, v47
  v_mfma_f32_16x16x32_bf16 v[136:139], a[160:163], v[72:75], v[136:139]
  v_mfma_f32_16x16x32_bf16 v[152:155], a[164:167], v[72:75], v[152:155]
  v_exp_f32 v96, v96
  v_mfma_f32_16x16x32_bf16 v[168:171], a[168:171], v[72:75], v[168:171]
  v_exp_f32 v97, v97
  v_mfma_f32_16x16x32_bf16 v[184:187], a[172:175], v[72:75], v[184:187]
  ds_read_b64_tr_b16 a[144:145], v16 offset:0
  v_lshl_add_u32 v4, v30, 3, v4
  v_mfma_f32_16x16x32_bf16 v[200:203], a[176:179], v[72:75], v[200:203]
  v_exp_f32 v98, v98
  v_mfma_f32_16x16x32_bf16 v[216:219], a[180:183], v[72:75], v[216:219]
  ds_read_b64_tr_b16 a[146:147], v16 offset:8192
  v_cvt_pk_bf16_f32 v64, v96, v97
  v_mfma_f32_16x16x32_bf16 v[232:235], a[184:187], v[72:75], v[232:235]
  v_exp_f32 v99, v99
  v_mfma_f32_16x16x32_bf16 v[248:251], a[188:191], v[72:75], v[248:251]
  v_mfma_f32_16x16x32_bf16 v[32:35], a[64:67], a[16:19], v[84:87]
  v_exp_f32 v100, v100
  v_add_u32 v4, s51, v4
  v_mfma_f32_16x16x32_bf16 v[32:35], a[68:71], a[20:23], v[32:35]
  ds_read_b64_tr_b16 a[148:149], v17 offset:0
  v_cvt_pk_bf16_f32 v65, v98, v99
  v_mfma_f32_16x16x32_bf16 v[32:35], a[72:75], a[24:27], v[32:35]
  v_exp_f32 v101, v101
  v_mfma_f32_16x16x32_bf16 v[32:35], a[76:79], a[28:31], v[32:35]
  ds_read_b64_tr_b16 a[150:151], v17 offset:8192
  v_mfma_f32_16x16x32_bf16 v[36:39], a[80:83], a[16:19], v[84:87]
  v_exp_f32 v102, v102
  v_mfma_f32_16x16x32_bf16 v[36:39], a[84:87], a[20:23], v[36:39]
  ds_read_b64_tr_b16 a[152:153], v18 offset:0
  v_cvt_pk_bf16_f32 v66, v100, v101
  v_mfma_f32_16x16x32_bf16 v[36:39], a[88:91], a[24:27], v[36:39]
  v_exp_f32 v103, v103
  v_mfma_f32_16x16x32_bf16 v[36:39], a[92:95], a[28:31], v[36:39]
  ds_read_b64_tr_b16 a[154:155], v18 offset:8192
  v_add_u32 v4, 131072, v4
  v_mfma_f32_16x16x32_bf16 v[60:63], v[124:127], v[76:79], v[60:63]
  ds_read_b64_tr_b16 a[156:157], v19 offset:0
  v_cvt_pk_bf16_f32 v67, v102, v103
  v_mfma_f32_16x16x32_bf16 v[140:143], a[160:163], v[76:79], v[140:143]
  v_mfma_f32_16x16x32_bf16 v[156:159], a[164:167], v[76:79], v[156:159]
  s_waitcnt vmcnt(10)
  v_exp_f32 v32, v32
  v_mfma_f32_16x16x32_bf16 v[172:175], a[168:171], v[76:79], v[172:175]
  v_exp_f32 v33, v33
  v_mfma_f32_16x16x32_bf16 v[188:191], a[172:175], v[76:79], v[188:191]
  ds_read_b64_tr_b16 a[158:159], v19 offset:8192
  v_mfma_f32_16x16x32_bf16 v[204:207], a[176:179], v[76:79], v[204:207]
  v_exp_f32 v34, v34
  v_mfma_f32_16x16x32_bf16 v[220:223], a[180:183], v[76:79], v[220:223]
  ds_read_b128 a[96:99], v8 offset:16384
  v_cvt_pk_bf16_f32 v68, v32, v33
  v_mfma_f32_16x16x32_bf16 v[236:239], a[184:187], v[76:79], v[236:239]
  v_exp_f32 v35, v35
  v_mfma_f32_16x16x32_bf16 v[252:255], a[188:191], v[76:79], v[252:255]
  s_add_u32 s59, s58, 7
  ds_read_b64_tr_b16 a[216:217], v4 offset:0
  v_mfma_f32_16x16x32_bf16 v[40:43], a[64:67], a[32:35], v[88:91]
  s_and_b32 s59, s59, 7
  v_exp_f32 v36, v36
  v_mfma_f32_16x16x32_bf16 v[40:43], a[68:71], a[36:39], v[40:43]
  s_lshl_b32 s61, s59, 14
  ds_read_b128 a[100:103], v9 offset:16384
  v_cvt_pk_bf16_f32 v69, v34, v35
  v_mfma_f32_16x16x32_bf16 v[40:43], a[72:75], a[40:43], v[40:43]
  s_add_u32 s61, s61, s60
  ds_read_b64_tr_b16 a[218:219], v4 offset:128
  v_exp_f32 v37, v37
  v_mfma_f32_16x16x32_bf16 v[40:43], a[76:79], a[44:47], v[40:43]
  s_add_u32 m0, s51, 32768
  ds_read_b128 a[104:107], v10 offset:16384
  v_mfma_f32_16x16x32_bf16 v[44:47], a[80:83], a[32:35], v[88:91]
  v_exp_f32 v38, v38
  v_mfma_f32_16x16x32_bf16 v[44:47], a[84:87], a[36:39], v[44:47]
  ds_read_b128 a[108:111], v11 offset:16384
  v_cvt_pk_bf16_f32 v70, v36, v37
  v_mfma_f32_16x16x32_bf16 v[44:47], a[88:91], a[40:43], v[44:47]
  v_exp_f32 v39, v39
  v_mfma_f32_16x16x32_bf16 v[44:47], a[92:95], a[44:47], v[44:47]
  s_waitcnt lgkmcnt(6)
  ds_read_b128 a[112:115], v8 offset:24576
  ds_read_b64_tr_b16 a[220:221], v4 offset:1024
  v_mfma_f32_16x16x32_bf16 v[48:51], v[124:127], v[64:67], v[48:51]
  ds_read_b128 a[116:119], v9 offset:24576
  v_cvt_pk_bf16_f32 v71, v38, v39
  v_mfma_f32_16x16x32_bf16 v[128:131], a[128:131], v[64:67], v[128:131]
  buffer_load_dwordx4 v20, s[16:19], s61 offen lds
  v_mfma_f32_16x16x32_bf16 v[144:147], a[132:135], v[64:67], v[144:147]
  v_exp_f32 v40, v40
  v_mfma_f32_16x16x32_bf16 v[160:163], a[136:139], v[64:67], v[160:163]
  v_exp_f32 v41, v41
  v_mfma_f32_16x16x32_bf16 v[176:179], a[140:143], v[64:67], v[176:179]
  ds_read_b128 a[120:123], v10 offset:24576
  ds_read_b64_tr_b16 a[222:223], v4 offset:1152
  v_mfma_f32_16x16x32_bf16 v[192:195], a[144:147], v[64:67], v[192:195]
  v_exp_f32 v42, v42
  v_mfma_f32_16x16x32_bf16 v[208:211], a[148:151], v[64:67], v[208:211]
  ds_read_b128 a[124:127], v11 offset:24576
  v_cvt_pk_bf16_f32 v72, v40, v41
  v_mfma_f32_16x16x32_bf16 v[224:227], a[152:155], v[64:67], v[224:227]
  v_exp_f32 v43, v43
  v_mfma_f32_16x16x32_bf16 v[240:243], a[156:159], v[64:67], v[240:243]
  buffer_load_dwordx4 v21, s[16:19], s61 offen offset:1024 lds
  v_mfma_f32_16x16x32_bf16 v[96:99], a[64:67], a[48:51], v[92:95]
  ds_read_b64_tr_b16 a[224:225], v4 offset:2048
  v_exp_f32 v44, v44
  v_mfma_f32_16x16x32_bf16 v[96:99], a[68:71], a[52:55], v[96:99]
  ds_read_b64_tr_b16 a[160:161], v12 offset:16384
  v_cvt_pk_bf16_f32 v73, v42, v43
  v_mfma_f32_16x16x32_bf16 v[96:99], a[72:75], a[56:59], v[96:99]
  v_exp_f32 v45, v45
  v_mfma_f32_16x16x32_bf16 v[96:99], a[76:79], a[60:63], v[96:99]
  ds_read_b64_tr_b16 a[162:163], v12 offset:24576
  v_mfma_f32_16x16x32_bf16 v[100:103], a[80:83], a[48:51], v[92:95]
  v_exp_f32 v46, v46
  v_mfma_f32_16x16x32_bf16 v[100:103], a[84:87], a[52:55], v[100:103]
  ds_read_b64_tr_b16 a[164:165], v13 offset:16384
  v_cvt_pk_bf16_f32 v74, v44, v45
  v_mfma_f32_16x16x32_bf16 v[100:103], a[88:91], a[56:59], v[100:103]
  ds_read_b64_tr_b16 a[226:227], v4 offset:2176
  v_exp_f32 v47, v47
  v_mfma_f32_16x16x32_bf16 v[100:103], a[92:95], a[60:63], v[100:103]
  ds_read_b64_tr_b16 a[166:167], v13 offset:24576
  v_mfma_f32_16x16x32_bf16 v[52:55], v[124:127], v[68:71], v[52:55]
  ds_read_b64_tr_b16 a[168:169], v14 offset:16384
  v_cvt_pk_bf16_f32 v75, v46, v47
  v_mfma_f32_16x16x32_bf16 v[132:135], a[128:131], v[68:71], v[132:135]
  buffer_load_dwordx4 v22, s[16:19], s61 offen offset:2048 lds
  v_mfma_f32_16x16x32_bf16 v[148:151], a[132:135], v[68:71], v[148:151]
  ds_read_b64_tr_b16 a[228:229], v4 offset:3072
  v_exp_f32 v96, v96
  v_mfma_f32_16x16x32_bf16 v[164:167], a[136:139], v[68:71], v[164:167]
  v_exp_f32 v97, v97
  v_mfma_f32_16x16x32_bf16 v[180:183], a[140:143], v[68:71], v[180:183]
  ds_read_b64_tr_b16 a[170:171], v14 offset:24576
  v_mfma_f32_16x16x32_bf16 v[196:199], a[144:147], v[68:71], v[196:199]
  v_exp_f32 v98, v98
  v_mfma_f32_16x16x32_bf16 v[212:215], a[148:151], v[68:71], v[212:215]
  ds_read_b64_tr_b16 a[172:173], v15 offset:16384
  v_cvt_pk_bf16_f32 v76, v96, v97
  v_mfma_f32_16x16x32_bf16 v[228:231], a[152:155], v[68:71], v[228:231]
  ds_read_b64_tr_b16 a[230:231], v4 offset:3200
  v_exp_f32 v99, v99
  v_mfma_f32_16x16x32_bf16 v[244:247], a[156:159], v[68:71], v[244:247]
  s_waitcnt lgkmcnt(11)
  buffer_load_dwordx4 v23, s[16:19], s61 offen offset:3072 lds
  v_mfma_f32_16x16x32_bf16 v[32:35], a[96:99], a[0:3], v[80:83]
  s_add_u32 m0, s51, 36864
  v_exp_f32 v100, v100
  v_mfma_f32_16x16x32_bf16 v[32:35], a[100:103], a[4:7], v[32:35]
  ds_read_b64_tr_b16 a[174:175], v15 offset:24576
  v_cvt_pk_bf16_f32 v77, v98, v99
  v_mfma_f32_16x16x32_bf16 v[32:35], a[104:107], a[8:11], v[32:35]
  ds_read_b64_tr_b16 a[232:233], v4 offset:4096
  v_exp_f32 v101, v101
  v_mfma_f32_16x16x32_bf16 v[32:35], a[108:111], a[12:15], v[32:35]
  ds_read_b64_tr_b16 a[176:177], v16 offset:16384
  v_mfma_f32_16x16x32_bf16 v[36:39], a[112:115], a[0:3], v[80:83]
  v_exp_f32 v102, v102
  v_mfma_f32_16x16x32_bf16 v[36:39], a[116:119], a[4:7], v[36:39]
  ds_read_b64_tr_b16 a[178:179], v16 offset:24576
  v_cvt_pk_bf16_f32 v78, v100, v101
  v_mfma_f32_16x16x32_bf16 v[36:39], a[120:123], a[8:11], v[36:39]
  v_exp_f32 v103, v103
  v_mfma_f32_16x16x32_bf16 v[36:39], a[124:127], a[12:15], v[36:39]
  ds_read_b64_tr_b16 a[180:181], v17 offset:16384
  ds_read_b64_tr_b16 a[234:235], v4 offset:4224
  v_mfma_f32_16x16x32_bf16 v[56:59], v[124:127], v[72:75], v[56:59]
  ds_read_b64_tr_b16 a[182:183], v17 offset:24576
  v_cvt_pk_bf16_f32 v79, v102, v103
  v_mfma_f32_16x16x32_bf16 v[136:139], a[128:131], v[72:75], v[136:139]
  buffer_load_dwordx4 v24, s[20:23], s61 offen lds
  v_mfma_f32_16x16x32_bf16 v[152:155], a[132:135], v[72:75], v[152:155]
  v_exp_f32 v32, v32
  v_mfma_f32_16x16x32_bf16 v[168:171], a[136:139], v[72:75], v[168:171]
  v_exp_f32 v33, v33
  v_mfma_f32_16x16x32_bf16 v[184:187], a[140:143], v[72:75], v[184:187]
  ds_read_b64_tr_b16 a[184:185], v18 offset:16384
  ds_read_b64_tr_b16 a[236:237], v4 offset:5120
  v_mfma_f32_16x16x32_bf16 v[200:203], a[144:147], v[72:75], v[200:203]
  v_exp_f32 v34, v34
  v_mfma_f32_16x16x32_bf16 v[216:219], a[148:151], v[72:75], v[216:219]
  ds_read_b64_tr_b16 a[186:187], v18 offset:24576
  v_cvt_pk_bf16_f32 v64, v32, v33
  v_mfma_f32_16x16x32_bf16 v[232:235], a[152:155], v[72:75], v[232:235]
  v_exp_f32 v35, v35
  v_mfma_f32_16x16x32_bf16 v[248:251], a[156:159], v[72:75], v[248:251]
  buffer_load_dwordx4 v25, s[20:23], s61 offen offset:1024 lds
  v_mfma_f32_16x16x32_bf16 v[40:43], a[96:99], a[16:19], v[84:87]
  ds_read_b64_tr_b16 a[238:239], v4 offset:5248
  v_exp_f32 v36, v36
  v_mfma_f32_16x16x32_bf16 v[40:43], a[100:103], a[20:23], v[40:43]
  ds_read_b64_tr_b16 a[188:189], v19 offset:16384
  v_cvt_pk_bf16_f32 v65, v34, v35
  v_mfma_f32_16x16x32_bf16 v[40:43], a[104:107], a[24:27], v[40:43]
  v_exp_f32 v37, v37
  v_mfma_f32_16x16x32_bf16 v[40:43], a[108:111], a[28:31], v[40:43]
  ds_read_b64_tr_b16 a[190:191], v19 offset:24576
  v_mfma_f32_16x16x32_bf16 v[44:47], a[112:115], a[16:19], v[84:87]
  v_exp_f32 v38, v38
  v_mfma_f32_16x16x32_bf16 v[44:47], a[116:119], a[20:23], v[44:47]
  v_cvt_pk_bf16_f32 v66, v36, v37
  v_mfma_f32_16x16x32_bf16 v[44:47], a[120:123], a[24:27], v[44:47]
  v_exp_f32 v39, v39
  v_mfma_f32_16x16x32_bf16 v[44:47], a[124:127], a[28:31], v[44:47]
  buffer_load_dwordx4 v24, s[20:23], s61 offen offset:2048 lds
  v_mfma_f32_16x16x32_bf16 v[60:63], v[124:127], v[76:79], v[60:63]
  v_cvt_pk_bf16_f32 v67, v38, v39
  v_mfma_f32_16x16x32_bf16 v[140:143], a[128:131], v[76:79], v[140:143]
  s_lshl_b32 s69, s57, 2
  buffer_load_dwordx4 v25, s[20:23], s61 offen offset:3072 lds
  v_min_u32 v105, 23, v1
  v_mfma_f32_16x16x32_bf16 v[156:159], a[132:135], v[76:79], v[156:159]
  v_exp_f32 v40, v40
  v_add_u32 v105, s69, v105
  v_mfma_f32_16x16x32_bf16 v[172:175], a[136:139], v[76:79], v[172:175]
  v_exp_f32 v41, v41
  v_mfma_f32_16x16x32_bf16 v[188:191], a[140:143], v[76:79], v[188:191]
  v_min_u32 v105, 171, v105
  v_lshlrev_b32 v105, 7, v105
  v_mfma_f32_16x16x32_bf16 v[204:207], a[144:147], v[76:79], v[204:207]
  s_mov_b32 s69, 0x40000000
  v_exp_f32 v42, v42
  v_mfma_f32_16x16x32_bf16 v[220:223], a[148:151], v[76:79], v[220:223]
  s_cmp_lt_u32 s52, 64
  s_cselect_b32 s69, 0x18040, s69
  v_cvt_pk_bf16_f32 v68, v40, v41
  v_mfma_f32_16x16x32_bf16 v[236:239], a[152:155], v[76:79], v[236:239]
  s_cmp_lt_u32 s52, 64
  s_cselect_b32 s3, s43, 0
  v_exp_f32 v43, v43
  v_mfma_f32_16x16x32_bf16 v[252:255], a[156:159], v[76:79], v[252:255]
  buffer_load_dword v104, v105, s[8:11], s69 offen sc1
  v_mfma_f32_16x16x32_bf16 v[96:99], a[96:99], a[32:35], v[88:91]
  v_exp_f32 v44, v44
  v_mfma_f32_16x16x32_bf16 v[96:99], a[100:103], a[36:39], v[96:99]
  v_cvt_pk_bf16_f32 v69, v42, v43
  v_mfma_f32_16x16x32_bf16 v[96:99], a[104:107], a[40:43], v[96:99]
  v_exp_f32 v45, v45
  v_mfma_f32_16x16x32_bf16 v[96:99], a[108:111], a[44:47], v[96:99]
  v_mfma_f32_16x16x32_bf16 v[100:103], a[112:115], a[32:35], v[88:91]
  v_exp_f32 v46, v46
  v_mfma_f32_16x16x32_bf16 v[100:103], a[116:119], a[36:39], v[100:103]
  v_cvt_pk_bf16_f32 v70, v44, v45
  v_mfma_f32_16x16x32_bf16 v[100:103], a[120:123], a[40:43], v[100:103]
  s_waitcnt vmcnt(21) lgkmcnt(0)
  v_exp_f32 v47, v47
  v_mfma_f32_16x16x32_bf16 v[100:103], a[124:127], a[44:47], v[100:103]
  s_barrier
  ds_read_b128 a[64:67], v8 offset:32768
  v_mfma_f32_16x16x32_bf16 v[48:51], v[124:127], v[64:67], v[48:51]
  s_add_u32 m0, s51, 65536
  ds_read_b128 a[68:71], v9 offset:32768
  v_cvt_pk_bf16_f32 v71, v46, v47
  v_mfma_f32_16x16x32_bf16 v[128:131], a[160:163], v[64:67], v[128:131]
  buffer_load_dwordx4 v120, s[24:27], s64 offen lds
  v_mfma_f32_16x16x32_bf16 v[144:147], a[164:167], v[64:67], v[144:147]
  v_exp_f32 v96, v96
  v_mfma_f32_16x16x32_bf16 v[160:163], a[168:171], v[64:67], v[160:163]
  v_exp_f32 v97, v97
  v_mfma_f32_16x16x32_bf16 v[176:179], a[172:175], v[64:67], v[176:179]
  ds_read_b128 a[72:75], v10 offset:32768
  v_mfma_f32_16x16x32_bf16 v[192:195], a[176:179], v[64:67], v[192:195]
  v_exp_f32 v98, v98
  v_mfma_f32_16x16x32_bf16 v[208:211], a[180:183], v[64:67], v[208:211]
  ds_read_b128 a[76:79], v11 offset:32768
  v_cvt_pk_bf16_f32 v72, v96, v97
  v_mfma_f32_16x16x32_bf16 v[224:227], a[184:187], v[64:67], v[224:227]
  v_exp_f32 v99, v99
  v_mfma_f32_16x16x32_bf16 v[240:243], a[188:191], v[64:67], v[240:243]
  buffer_load_dwordx4 v121, s[24:27], s64 offen offset:1024 lds
  v_mfma_f32_16x16x32_bf16 v[32:35], a[96:99], a[48:51], v[92:95]
  v_exp_f32 v100, v100
  v_mfma_f32_16x16x32_bf16 v[32:35], a[100:103], a[52:55], v[32:35]
  ds_read_b128 a[80:83], v8 offset:40960
  v_cvt_pk_bf16_f32 v73, v98, v99
  v_mfma_f32_16x16x32_bf16 v[32:35], a[104:107], a[56:59], v[32:35]
  v_exp_f32 v101, v101
  v_mfma_f32_16x16x32_bf16 v[32:35], a[108:111], a[60:63], v[32:35]
  ds_read_b128 a[84:87], v9 offset:40960
  v_mfma_f32_16x16x32_bf16 v[36:39], a[112:115], a[48:51], v[92:95]
  v_exp_f32 v102, v102
  v_mfma_f32_16x16x32_bf16 v[36:39], a[116:119], a[52:55], v[36:39]
  ds_read_b128 a[88:91], v10 offset:40960
  v_cvt_pk_bf16_f32 v74, v100, v101
  v_mfma_f32_16x16x32_bf16 v[36:39], a[120:123], a[56:59], v[36:39]
  v_exp_f32 v103, v103
  v_mfma_f32_16x16x32_bf16 v[36:39], a[124:127], a[60:63], v[36:39]
  ds_read_b128 a[92:95], v11 offset:40960
  v_mfma_f32_16x16x32_bf16 v[52:55], v[124:127], v[68:71], v[52:55]
  ds_read_b64_tr_b16 a[128:129], v12 offset:32768
  v_cvt_pk_bf16_f32 v75, v102, v103
  v_mfma_f32_16x16x32_bf16 v[132:135], a[160:163], v[68:71], v[132:135]
  buffer_load_dwordx4 v122, s[24:27], s64 offen offset:2048 lds
  v_mfma_f32_16x16x32_bf16 v[148:151], a[164:167], v[68:71], v[148:151]
  v_exp_f32 v32, v32
  v_mfma_f32_16x16x32_bf16 v[164:167], a[168:171], v[68:71], v[164:167]
  v_exp_f32 v33, v33
  v_mfma_f32_16x16x32_bf16 v[180:183], a[172:175], v[68:71], v[180:183]
  ds_read_b64_tr_b16 a[130:131], v12 offset:40960
  v_mfma_f32_16x16x32_bf16 v[196:199], a[176:179], v[68:71], v[196:199]
  v_exp_f32 v34, v34
  v_mfma_f32_16x16x32_bf16 v[212:215], a[180:183], v[68:71], v[212:215]
  ds_read_b64_tr_b16 a[132:133], v13 offset:32768
  v_cvt_pk_bf16_f32 v76, v32, v33
  v_mfma_f32_16x16x32_bf16 v[228:231], a[184:187], v[68:71], v[228:231]
  v_exp_f32 v35, v35
  v_mfma_f32_16x16x32_bf16 v[244:247], a[188:191], v[68:71], v[244:247]
  s_waitcnt lgkmcnt(3)
  buffer_load_dwordx4 v123, s[24:27], s64 offen offset:3072 lds
  v_mfma_f32_16x16x32_bf16 v[40:43], a[64:67], a[0:3], v[80:83]
  s_add_u32 s62, s62, 32768
  v_exp_f32 v36, v36
  v_mfma_f32_16x16x32_bf16 v[40:43], a[68:71], a[4:7], v[40:43]
  s_and_b32 s62, s62, 0xf8000
  ds_read_b64_tr_b16 a[134:135], v13 offset:40960
  v_cvt_pk_bf16_f32 v77, v34, v35
  v_mfma_f32_16x16x32_bf16 v[40:43], a[72:75], a[8:11], v[40:43]
  s_or_b32 s64, s62, s63
  v_exp_f32 v37, v37
  v_mfma_f32_16x16x32_bf16 v[40:43], a[76:79], a[12:15], v[40:43]
  s_add_u32 m0, s51, 69632
  ds_read_b64_tr_b16 a[136:137], v14 offset:32768
  v_mfma_f32_16x16x32_bf16 v[44:47], a[80:83], a[0:3], v[80:83]
  v_exp_f32 v38, v38
  v_mfma_f32_16x16x32_bf16 v[44:47], a[84:87], a[4:7], v[44:47]
  ds_read_b64_tr_b16 a[138:139], v14 offset:40960
  v_cvt_pk_bf16_f32 v78, v36, v37
  v_mfma_f32_16x16x32_bf16 v[44:47], a[88:91], a[8:11], v[44:47]
  v_exp_f32 v39, v39
  v_mfma_f32_16x16x32_bf16 v[44:47], a[92:95], a[12:15], v[44:47]
  ds_read_b64_tr_b16 a[140:141], v15 offset:32768
  v_mfma_f32_16x16x32_bf16 v[56:59], v[124:127], v[72:75], v[56:59]
  ds_read_b64_tr_b16 a[142:143], v15 offset:40960
  v_cvt_pk_bf16_f32 v79, v38, v39
  v_mfma_f32_16x16x32_bf16 v[136:139], a[160:163], v[72:75], v[136:139]
  buffer_load_dwordx4 v120, s[24:27], s64 offen lds
  v_mfma_f32_16x16x32_bf16 v[152:155], a[164:167], v[72:75], v[152:155]
  v_exp_f32 v40, v40
  v_mfma_f32_16x16x32_bf16 v[168:171], a[168:171], v[72:75], v[168:171]
  v_exp_f32 v41, v41
  v_mfma_f32_16x16x32_bf16 v[184:187], a[172:175], v[72:75], v[184:187]
  ds_read_b64_tr_b16 a[144:145], v16 offset:32768
  v_mfma_f32_16x16x32_bf16 v[200:203], a[176:179], v[72:75], v[200:203]
  s_waitcnt vmcnt(5)
  v_exp_f32 v42, v42
  v_cmp_ne_u32 vcc, s3, v104
  v_mfma_f32_16x16x32_bf16 v[216:219], a[180:183], v[72:75], v[216:219]
  s_cbranch_vccnz L_spin12
L_back14:
  ds_read_b64_tr_b16 a[146:147], v16 offset:40960
  v_cvt_pk_bf16_f32 v64, v40, v41
  v_mfma_f32_16x16x32_bf16 v[232:235], a[184:187], v[72:75], v[232:235]
  buffer_load_dwordx4 a[192:195], v111, s[12:15], s56 offen sc1
  v_exp_f32 v43, v43
  v_mfma_f32_16x16x32_bf16 v[248:251], a[188:191], v[72:75], v[248:251]
  buffer_load_dwordx4 v121, s[24:27], s64 offen offset:1024 lds
  v_mfma_f32_16x16x32_bf16 v[96:99], a[64:67], a[16:19], v[84:87]
  buffer_load_dwordx4 a[196:199], v111, s[12:15], s56 offen offset:512 sc1
  v_exp_f32 v44, v44
  v_mfma_f32_16x16x32_bf16 v[96:99], a[68:71], a[20:23], v[96:99]
  ds_read_b64_tr_b16 a[148:149], v17 offset:32768
  v_cvt_pk_bf16_f32 v65, v42, v43
  v_mfma_f32_16x16x32_bf16 v[96:99], a[72:75], a[24:27], v[96:99]
  buffer_load_dwordx4 a[200:203], v111, s[12:15], s56 offen offset:1024 sc1
  v_exp_f32 v45, v45
  v_mfma_f32_16x16x32_bf16 v[96:99], a[76:79], a[28:31], v[96:99]
  ds_read_b64_tr_b16 a[150:151], v17 offset:40960
  buffer_load_dwordx4 a[204:207], v111, s[12:15], s56 offen offset:1536 sc1
  v_mfma_f32_16x16x32_bf16 v[100:103], a[80:83], a[16:19], v[84:87]
  buffer_load_dwordx4 a[208:211], v111, s[12:15], s56 offen offset:2048 sc1
  v_exp_f32 v46, v46
  v_mfma_f32_16x16x32_bf16 v[100:103], a[84:87], a[20:23], v[100:103]
  ds_read_b64_tr_b16 a[152:153], v18 offset:32768
  v_cvt_pk_bf16_f32 v66, v44, v45
  v_mfma_f32_16x16x32_bf16 v[100:103], a[88:91], a[24:27], v[100:103]
  buffer_load_dwordx4 a[212:215], v111, s[12:15], s56 offen offset:2560 sc1
  v_exp_f32 v47, v47
  v_mfma_f32_16x16x32_bf16 v[100:103], a[92:95], a[28:31], v[100:103]
  ds_read_b64_tr_b16 a[154:155], v18 offset:40960
  v_mfma_f32_16x16x32_bf16 v[60:63], v[124:127], v[76:79], v[60:63]
  ds_read_b64_tr_b16 a[156:157], v19 offset:32768
  v_cvt_pk_bf16_f32 v67, v46, v47
  v_mfma_f32_16x16x32_bf16 v[140:143], a[160:163], v[76:79], v[140:143]
  buffer_load_dwordx4 v122, s[24:27], s64 offen offset:2048 lds
  v_mfma_f32_16x16x32_bf16 v[156:159], a[164:167], v[76:79], v[156:159]
  v_exp_f32 v96, v96
  v_mfma_f32_16x16x32_bf16 v[172:175], a[168:171], v[76:79], v[172:175]
  v_exp_f32 v97, v97
  v_mfma_f32_16x16x32_bf16 v[188:191], a[172:175], v[76:79], v[188:191]
  ds_read_b64_tr_b16 a[158:159], v19 offset:40960
  v_mfma_f32_16x16x32_bf16 v[204:207], a[176:179], v[76:79], v[204:207]
  v_exp_f32 v98, v98
  v_mfma_f32_16x16x32_bf16 v[220:223], a[180:183], v[76:79], v[220:223]
  ds_read_b128 a[96:99], v8 offset:49152
  v_cvt_pk_bf16_f32 v68, v96, v97
  v_mfma_f32_16x16x32_bf16 v[236:239], a[184:187], v[76:79], v[236:239]
  v_exp_f32 v99, v99
  v_mfma_f32_16x16x32_bf16 v[252:255], a[188:191], v[76:79], v[252:255]
  buffer_load_dwordx4 v123, s[24:27], s64 offen offset:3072 lds
  v_mfma_f32_16x16x32_bf16 v[32:35], a[64:67], a[32:35], v[88:91]
  s_add_u32 s62, s62, 32768
  v_exp_f32 v100, v100
  v_mfma_f32_16x16x32_bf16 v[32:35], a[68:71], a[36:39], v[32:35]
  s_and_b32 s62, s62, 0xf8000
  ds_read_b128 a[100:103], v9 offset:49152
  v_cvt_pk_bf16_f32 v69, v98, v99
  v_mfma_f32_16x16x32_bf16 v[32:35], a[72:75], a[40:43], v[32:35]
  s_or_b32 s64, s62, s63
  v_exp_f32 v101, v101
  v_mfma_f32_16x16x32_bf16 v[32:35], a[76:79], a[44:47], v[32:35]
  ds_read_b128 a[104:107], v10 offset:49152
  v_mfma_f32_16x16x32_bf16 v[36:39], a[80:83], a[32:35], v[88:91]
  v_exp_f32 v102, v102
  v_mfma_f32_16x16x32_bf16 v[36:39], a[84:87], a[36:39], v[36:39]
  ds_read_b128 a[108:111], v11 offset:49152
  v_cvt_pk_bf16_f32 v70, v100, v101
  v_mfma_f32_16x16x32_bf16 v[36:39], a[88:91], a[40:43], v[36:39]
  v_exp_f32 v103, v103
  v_mfma_f32_16x16x32_bf16 v[36:39], a[92:95], a[44:47], v[36:39]
  s_waitcnt lgkmcnt(4)
  ds_read_b128 a[112:115], v8 offset:57344
  v_mfma_f32_16x16x32_bf16 v[48:51], v[124:127], v[64:67], v[48:51]
  ds_read_b128 a[116:119], v9 offset:57344
  v_cvt_pk_bf16_f32 v71, v102, v103
  v_mfma_f32_16x16x32_bf16 v[128:131], a[128:131], v[64:67], v[128:131]
  v_mfma_f32_16x16x32_bf16 v[144:147], a[132:135], v[64:67], v[144:147]
  v_exp_f32 v32, v32
  v_mfma_f32_16x16x32_bf16 v[160:163], a[136:139], v[64:67], v[160:163]
  v_exp_f32 v33, v33
  v_mfma_f32_16x16x32_bf16 v[176:179], a[140:143], v[64:67], v[176:179]
  ds_read_b128 a[120:123], v10 offset:57344
  v_mfma_f32_16x16x32_bf16 v[192:195], a[144:147], v[64:67], v[192:195]
  v_exp_f32 v34, v34
  v_mfma_f32_16x16x32_bf16 v[208:211], a[148:151], v[64:67], v[208:211]
  ds_read_b128 a[124:127], v11 offset:57344
  v_cvt_pk_bf16_f32 v72, v32, v33
  v_mfma_f32_16x16x32_bf16 v[224:227], a[152:155], v[64:67], v[224:227]
  v_exp_f32 v35, v35
  v_mfma_f32_16x16x32_bf16 v[240:243], a[156:159], v[64:67], v[240:243]
  v_mfma_f32_16x16x32_bf16 v[40:43], a[64:67], a[48:51], v[92:95]
  v_exp_f32 v36, v36
  v_mfma_f32_16x16x32_bf16 v[40:43], a[68:71], a[52:55], v[40:43]
  ds_read_b64_tr_b16 a[160:161], v12 offset:49152
  v_cvt_pk_bf16_f32 v73, v34, v35
  v_mfma_f32_16x16x32_bf16 v[40:43], a[72:75], a[56:59], v[40:43]
  v_exp_f32 v37, v37
  v_mfma_f32_16x16x32_bf16 v[40:43], a[76:79], a[60:63], v[40:43]
  ds_read_b64_tr_b16 a[162:163], v12 offset:57344
  v_mfma_f32_16x16x32_bf16 v[44:47], a[80:83], a[48:51], v[92:95]
  v_exp_f32 v38, v38
  v_mfma_f32_16x16x32_bf16 v[44:47], a[84:87], a[52:55], v[44:47]
  ds_read_b64_tr_b16 a[164:165], v13 offset:49152
  v_cvt_pk_bf16_f32 v74, v36, v37
  v_mfma_f32_16x16x32_bf16 v[44:47], a[88:91], a[56:59], v[44:47]
  v_exp_f32 v39, v39
  v_mfma_f32_16x16x32_bf16 v[44:47], a[92:95], a[60:63], v[44:47]
  ds_read_b64_tr_b16 a[166:167], v13 offset:57344
  v_mfma_f32_16x16x32_bf16 v[52:55], v[124:127], v[68:71], v[52:55]
  ds_read_b64_tr_b16 a[168:169], v14 offset:49152
  v_cvt_pk_bf16_f32 v75, v38, v39
  v_mfma_f32_16x16x32_bf16 v[132:135], a[128:131], v[68:71], v[132:135]
  v_mfma_f32_16x16x32_bf16 v[148:151], a[132:135], v[68:71], v[148:151]
  v_exp_f32 v40, v40
  v_mfma_f32_16x16x32_bf16 v[164:167], a[136:139], v[68:71], v[164:167]
  v_exp_f32 v41, v41
  v_mfma_f32_16x16x32_bf16 v[180:183], a[140:143], v[68:71], v[180:183]
  ds_read_b64_tr_b16 a[170:171], v14 offset:57344
  v_mfma_f32_16x16x32_bf16 v[196:199], a[144:147], v[68:71], v[196:199]
  v_exp_f32 v42, v42
  v_mfma_f32_16x16x32_bf16 v[212:215], a[148:151], v[68:71], v[212:215]
  ds_read_b64_tr_b16 a[172:173], v15 offset:49152
  v_cvt_pk_bf16_f32 v76, v40, v41
  v_mfma_f32_16x16x32_bf16 v[228:231], a[152:155], v[68:71], v[228:231]
  v_exp_f32 v43, v43
  v_mfma_f32_16x16x32_bf16 v[244:247], a[156:159], v[68:71], v[244:247]
  s_waitcnt lgkmcnt(7)
  v_mfma_f32_16x16x32_bf16 v[96:99], a[96:99], a[0:3], v[80:83]
  v_exp_f32 v44, v44
  v_mfma_f32_16x16x32_bf16 v[96:99], a[100:103], a[4:7], v[96:99]
  ds_read_b64_tr_b16 a[174:175], v15 offset:57344
  v_cvt_pk_bf16_f32 v77, v42, v43
  v_mfma_f32_16x16x32_bf16 v[96:99], a[104:107], a[8:11], v[96:99]
  v_exp_f32 v45, v45
  v_mfma_f32_16x16x32_bf16 v[96:99], a[108:111], a[12:15], v[96:99]
  ds_read_b64_tr_b16 a[176:177], v16 offset:49152
  v_mfma_f32_16x16x32_bf16 v[100:103], a[112:115], a[0:3], v[80:83]
  v_exp_f32 v46, v46
  v_mfma_f32_16x16x32_bf16 v[100:103], a[116:119], a[4:7], v[100:103]
  ds_read_b64_tr_b16 a[178:179], v16 offset:57344
  v_cvt_pk_bf16_f32 v78, v44, v45
  v_mfma_f32_16x16x32_bf16 v[100:103], a[120:123], a[8:11], v[100:103]
  v_exp_f32 v47, v47
  v_mfma_f32_16x16x32_bf16 v[100:103], a[124:127], a[12:15], v[100:103]
  ds_read_b64_tr_b16 a[180:181], v17 offset:49152
  v_mfma_f32_16x16x32_bf16 v[56:59], v[124:127], v[72:75], v[56:59]
  ds_read_b64_tr_b16 a[182:183], v17 offset:57344
  v_cvt_pk_bf16_f32 v79, v46, v47
  v_mfma_f32_16x16x32_bf16 v[136:139], a[128:131], v[72:75], v[136:139]
  v_mfma_f32_16x16x32_bf16 v[152:155], a[132:135], v[72:75], v[152:155]
  v_exp_f32 v96, v96
  v_mfma_f32_16x16x32_bf16 v[168:171], a[136:139], v[72:75], v[168:171]
  v_exp_f32 v97, v97
  v_mfma_f32_16x16x32_bf16 v[184:187], a[140:143], v[72:75], v[184:187]
  ds_read_b64_tr_b16 a[184:185], v18 offset:49152
  v_mfma_f32_16x16x32_bf16 v[200:203], a[144:147], v[72:75], v[200:203]
  v_exp_f32 v98, v98
  v_mfma_f32_16x16x32_bf16 v[216:219], a[148:151], v[72:75], v[216:219]
  ds_read_b64_tr_b16 a[186:187], v18 offset:57344
  v_cvt_pk_bf16_f32 v64, v96, v97
  v_mfma_f32_16x16x32_bf16 v[232:235], a[152:155], v[72:75], v[232:235]
  v_exp_f32 v99, v99
  v_mfma_f32_16x16x32_bf16 v[248:251], a[156:159], v[72:75], v[248:251]
  v_mfma_f32_16x16x32_bf16 v[32:35], a[96:99], a[16:19], v[84:87]
  v_exp_f32 v100, v100
  v_mfma_f32_16x16x32_bf16 v[32:35], a[100:103], a[20:23], v[32:35]
  ds_read_b64_tr_b16 a[188:189], v19 offset:49152
  v_cvt_pk_bf16_f32 v65, v98, v99
  v_mfma_f32_16x16x32_bf16 v[32:35], a[104:107], a[24:27], v[32:35]
  v_exp_f32 v101, v101
  v_mfma_f32_16x16x32_bf16 v[32:35], a[108:111], a[28:31], v[32:35]
  ds_read_b64_tr_b16 a[190:191], v19 offset:57344
  v_mfma_f32_16x16x32_bf16 v[36:39], a[112:115], a[16:19], v[84:87]
  v_exp_f32 v102, v102
  v_mfma_f32_16x16x32_bf16 v[36:39], a[116:119], a[20:23], v[36:39]
  v_cvt_pk_bf16_f32 v66, v100, v101
  v_mfma_f32_16x16x32_bf16 v[36:39], a[120:123], a[24:27], v[36:39]
  v_exp_f32 v103, v103
  v_mfma_f32_16x16x32_bf16 v[36:39], a[124:127], a[28:31], v[36:39]
  v_mfma_f32_16x16x32_bf16 v[60:63], v[124:127], v[76:79], v[60:63]
  v_cvt_pk_bf16_f32 v67, v102, v103
  v_mfma_f32_16x16x32_bf16 v[140:143], a[128:131], v[76:79], v[140:143]
  v_mfma_f32_16x16x32_bf16 v[156:159], a[132:135], v[76:79], v[156:159]
  v_exp_f32 v32, v32
  v_mfma_f32_16x16x32_bf16 v[172:175], a[136:139], v[76:79], v[172:175]
  v_exp_f32 v33, v33
  v_mfma_f32_16x16x32_bf16 v[188:191], a[140:143], v[76:79], v[188:191]
  v_mfma_f32_16x16x32_bf16 v[204:207], a[144:147], v[76:79], v[204:207]
  v_exp_f32 v34, v34
  v_mfma_f32_16x16x32_bf16 v[220:223], a[148:151], v[76:79], v[220:223]
  v_cvt_pk_bf16_f32 v68, v32, v33
  v_mfma_f32_16x16x32_bf16 v[236:239], a[152:155], v[76:79], v[236:239]
  v_exp_f32 v35, v35
  v_mfma_f32_16x16x32_bf16 v[252:255], a[156:159], v[76:79], v[252:255]
  s_waitcnt vmcnt(2) lgkmcnt(15)
  v_mfma_f32_16x16x32_bf16 v[116:119], a[216:219], a[192:195], 0
  v_exp_f32 v36, v36
  v_mfma_f32_16x16x32_bf16 v[116:119], a[220:223], a[196:199], v[116:119]
  v_cvt_pk_bf16_f32 v69, v34, v35
  v_xor_b32 v8, 0x10000, v8
  v_mfma_f32_16x16x32_bf16 v[116:119], a[224:227], a[200:203], v[116:119]
  v_exp_f32 v37, v37
  v_mfma_f32_16x16x32_bf16 v[116:119], a[228:231], a[204:207], v[116:119]
  v_xor_b32 v12, 0x10000, v12
  v_mfma_f32_16x16x32_bf16 v[116:119], a[232:235], a[208:211], v[116:119]
  v_exp_f32 v38, v38
  v_mfma_f32_16x16x32_bf16 v[116:119], a[236:239], a[212:215], v[116:119]
  v_cvt_pk_bf16_f32 v70, v36, v37
  v_xor_b32 v9, 0x10000, v9
  v_xor_b32 v13, 0x10000, v13
  v_mfma_f32_16x16x32_bf16 v[40:43], a[96:99], a[32:35], v[88:91]
  v_exp_f32 v39, v39
  v_mfma_f32_16x16x32_bf16 v[40:43], a[100:103], a[36:39], v[40:43]
  v_xor_b32 v10, 0x10000, v10
  v_mfma_f32_16x16x32_bf16 v[40:43], a[104:107], a[40:43], v[40:43]
  v_cvt_pk_bf16_f32 v71, v38, v39
  v_mfma_f32_16x16x32_bf16 v[40:43], a[108:111], a[44:47], v[40:43]
  ds_write_b128 v26, v[116:119]
  v_xor_b32 v14, 0x10000, v14
  v_mfma_f32_16x16x32_bf16 v[44:47], a[112:115], a[32:35], v[88:91]
  v_xor_b32 v11, 0x10000, v11
  v_mfma_f32_16x16x32_bf16 v[44:47], a[116:119], a[36:39], v[44:47]
  v_xor_b32 v15, 0x10000, v15
  v_mfma_f32_16x16x32_bf16 v[44:47], a[120:123], a[40:43], v[44:47]
  s_waitcnt vmcnt(15) lgkmcnt(0)
  v_mfma_f32_16x16x32_bf16 v[44:47], a[124:127], a[44:47], v[44:47]
  s_barrier
  ds_read_b128 a[64:67], v8 offset:0
  ds_read_b32 v104, v27 offset:0
  v_mfma_f32_16x16x32_bf16 v[48:51], v[124:127], v[64:67], v[48:51]
  s_add_u32 m0, s51, 98304
  ds_read_b128 a[68:71], v9 offset:0
  v_xor_b32 v16, 0x10000, v16
  v_mfma_f32_16x16x32_bf16 v[128:131], a[160:163], v[64:67], v[128:131]
  s_lshl_b32 s69, s52, 7
  ds_read_b128 a[72:75], v10 offset:0
  ds_read_b32 v105, v27 offset:8192
  v_mfma_f32_16x16x32_bf16 v[144:147], a[164:167], v[64:67], v[144:147]
  s_lshl_b32 s3, s44, 2
  ds_read_b32 v106, v27 offset:16384
  v_exp_f32 v40, v40
  v_mfma_f32_16x16x32_bf16 v[160:163], a[168:171], v[64:67], v[160:163]
  s_add_u32 s69, s69, s3
  ds_read_b32 v107, v27 offset:24576
  v_exp_f32 v41, v41
  v_mfma_f32_16x16x32_bf16 v[176:179], a[172:175], v[64:67], v[176:179]
  s_add_u32 s69, s69, 0x20000
  ds_read_b128 a[76:79], v11 offset:0
  v_xor_b32 v17, 0x10000, v17
  v_mfma_f32_16x16x32_bf16 v[192:195], a[176:179], v[64:67], v[192:195]
  s_cmp_lt_u32 s52, 64
  s_cselect_b32 s69, s69, 0x40000000
  buffer_load_dwordx4 v120, s[24:27], s64 offen lds
  v_exp_f32 v42, v42
  v_mfma_f32_16x16x32_bf16 v[208:211], a[180:183], v[64:67], v[208:211]
  ds_read_b128 a[80:83], v8 offset:8192
  v_cvt_pk_bf16_f32 v72, v40, v41
  v_xor_b32 v18, 0x10000, v18
  v_mfma_f32_16x16x32_bf16 v[224:227], a[184:187], v[64:67], v[224:227]
  v_exp_f32 v43, v43
  v_mfma_f32_16x16x32_bf16 v[240:243], a[188:191], v[64:67], v[240:243]
  ds_read_b128 a[84:87], v9 offset:8192
  v_lshlrev_b32 v108, 2, v110
  v_lshl_add_u32 v108, v2, 4, v108
  v_mfma_f32_16x16x32_bf16 v[96:99], a[96:99], a[48:51], v[92:95]
  s_waitcnt lgkmcnt(3)
  v_exp_f32 v44, v44
  v_xor_b32 v19, 0x10000, v19
  v_mfma_f32_16x16x32_bf16 v[96:99], a[100:103], a[52:55], v[96:99]
  ds_read_b128 a[88:91], v10 offset:8192
  v_cvt_pk_bf16_f32 v73, v42, v43
  v_mfma_f32_16x16x32_bf16 v[96:99], a[104:107], a[56:59], v[96:99]
  buffer_load_dwordx4 v121, s[24:27], s64 offen offset:1024 lds
  v_exp_f32 v45, v45
  v_mfma_f32_16x16x32_bf16 v[96:99], a[108:111], a[60:63], v[96:99]
  ds_read_b128 a[92:95], v11 offset:8192
  v_add_f32 v104, v104, v105
  v_add_f32 v106, v106, v107
  v_mfma_f32_16x16x32_bf16 v[100:103], a[112:115], a[48:51], v[92:95]
  v_exp_f32 v46, v46
  v_add_f32 v104, v104, v106
  v_mfma_f32_16x16x32_bf16 v[100:103], a[116:119], a[52:55], v[100:103]
  ds_read_b64_tr_b16 a[128:129], v12 offset:0
  v_cvt_pk_bf16_f32 v74, v44, v45
  v_mfma_f32_16x16x32_bf16 v[100:103], a[120:123], a[56:59], v[100:103]
  buffer_store_dword v104, v108, s[8:11], s69 offen sc1
  v_exp_f32 v47, v47
  v_mfma_f32_16x16x32_bf16 v[100:103], a[124:127], a[60:63], v[100:103]
  ds_read_b64_tr_b16 a[130:131], v12 offset:8192
  v_mov_b32 v112, s43
  v_mov_b32 v113, 16384
  v_mfma_f32_16x16x32_bf16 v[52:55], v[124:127], v[68:71], v[52:55]
  ds_read_b64_tr_b16 a[132:133], v13 offset:0
  v_cvt_pk_bf16_f32 v75, v46, v47
  v_mfma_f32_16x16x32_bf16 v[132:135], a[160:163], v[68:71], v[132:135]
  s_cmp_eq_u32 s44, 0
  s_cselect_b32 s69, s69, 0x40000000
  ds_read_b64_tr_b16 a[134:135], v13 offset:8192
  buffer_load_dwordx4 v122, s[24:27], s64 offen offset:2048 lds
  v_mfma_f32_16x16x32_bf16 v[148:151], a[164:167], v[68:71], v[148:151]
  v_exp_f32 v96, v96
  v_mfma_f32_16x16x32_bf16 v[164:167], a[168:171], v[68:71], v[164:167]
  v_exp_f32 v97, v97
  v_mfma_f32_16x16x32_bf16 v[180:183], a[172:175], v[68:71], v[180:183]
  ds_read_b64_tr_b16 a[136:137], v14 offset:0
  v_mfma_f32_16x16x32_bf16 v[196:199], a[176:179], v[68:71], v[196:199]
  v_exp_f32 v98, v98
  v_mfma_f32_16x16x32_bf16 v[212:215], a[180:183], v[68:71], v[212:215]
  ds_read_b64_tr_b16 a[138:139], v14 offset:8192
  v_cvt_pk_bf16_f32 v76, v96, v97
  v_mfma_f32_16x16x32_bf16 v[228:231], a[184:187], v[68:71], v[228:231]
  buffer_load_dwordx4 v123, s[24:27], s64 offen offset:3072 lds
  v_exp_f32 v99, v99
  v_mfma_f32_16x16x32_bf16 v[244:247], a[188:191], v[68:71], v[244:247]
  s_waitcnt lgkmcnt(6)
  ds_read_b64_tr_b16 a[140:141], v15 offset:0
  v_mfma_f32_16x16x32_bf16 v[32:35], a[64:67], a[0:3], v[80:83]
  v_exp_f32 v100, v100
  v_mfma_f32_16x16x32_bf16 v[32:35], a[68:71], a[4:7], v[32:35]
  ds_read_b64_tr_b16 a[142:143], v15 offset:8192
  v_cvt_pk_bf16_f32 v77, v98, v99
  v_mfma_f32_16x16x32_bf16 v[32:35], a[72:75], a[8:11], v[32:35]
  v_exp_f32 v101, v101
  v_mfma_f32_16x16x32_bf16 v[32:35], a[76:79], a[12:15], v[32:35]
  s_add_u32 s62, s62, 32768
  ds_read_b64_tr_b16 a[144:145], v16 offset:0
  v_mfma_f32_16x16x32_bf16 v[36:39], a[80:83], a[0:3], v[80:83]
  v_exp_f32 v102, v102
  v_mfma_f32_16x16x32_bf16 v[36:39], a[84:87], a[4:7], v[36:39]
  ds_read_b64_tr_b16 a[146:147], v16 offset:8192
  v_cvt_pk_bf16_f32 v78, v100, v101
  v_mfma_f32_16x16x32_bf16 v[36:39], a[88:91], a[8:11], v[36:39]
  v_exp_f32 v103, v103
  v_mfma_f32_16x16x32_bf16 v[36:39], a[92:95], a[12:15], v[36:39]
  ds_read_b64_tr_b16 a[148:149], v17 offset:0
  v_mfma_f32_16x16x32_bf16 v[56:59], v[124:127], v[72:75], v[56:59]
  ds_read_b64_tr_b16 a[150:151], v17 offset:8192
  v_cvt_pk_bf16_f32 v79, v102, v103
  v_mfma_f32_16x16x32_bf16 v[136:139], a[160:163], v[72:75], v[136:139]
  s_and_b32 s62, s62, 0xf8000
  ds_read_b64_tr_b16 a[152:153], v18 offset:0
  v_mfma_f32_16x16x32_bf16 v[152:155], a[164:167], v[72:75], v[152:155]
  v_exp_f32 v32, v32
  v_mfma_f32_16x16x32_bf16 v[168:171], a[168:171], v[72:75], v[168:171]
  v_exp_f32 v33, v33
  v_mfma_f32_16x16x32_bf16 v[184:187], a[172:175], v[72:75], v[184:187]
  ds_read_b64_tr_b16 a[154:155], v18 offset:8192
  v_mfma_f32_16x16x32_bf16 v[200:203], a[176:179], v[72:75], v[200:203]
  v_exp_f32 v34, v34
  v_mfma_f32_16x16x32_bf16 v[216:219], a[180:183], v[72:75], v[216:219]
  ds_read_b64_tr_b16 a[156:157], v19 offset:0
  v_cvt_pk_bf16_f32 v64, v32, v33
  v_mfma_f32_16x16x32_bf16 v[232:235], a[184:187], v[72:75], v[232:235]
  s_or_b32 s64, s62, s63
  v_exp_f32 v35, v35
  v_mfma_f32_16x16x32_bf16 v[248:251], a[188:191], v[72:75], v[248:251]
  ds_read_b64_tr_b16 a[158:159], v19 offset:8192
  ds_read_b128 a[96:99], v8 offset:16384
  v_mfma_f32_16x16x32_bf16 v[40:43], a[64:67], a[16:19], v[84:87]
  ds_read_b128 a[100:103], v9 offset:16384
  v_exp_f32 v36, v36
  v_mfma_f32_16x16x32_bf16 v[40:43], a[68:71], a[20:23], v[40:43]
  ds_read_b128 a[104:107], v10 offset:16384
  v_cvt_pk_bf16_f32 v65, v34, v35
  v_mfma_f32_16x16x32_bf16 v[40:43], a[72:75], a[24:27], v[40:43]
  ds_read_b128 a[108:111], v11 offset:16384
  v_exp_f32 v37, v37
  v_mfma_f32_16x16x32_bf16 v[40:43], a[76:79], a[28:31], v[40:43]
  ds_read_b128 a[112:115], v8 offset:24576
  ds_read_b128 a[116:119], v9 offset:24576
  v_mfma_f32_16x16x32_bf16 v[44:47], a[80:83], a[16:19], v[84:87]
  s_add_u32 m0, s51, 102400
  ds_read_b128 a[120:123], v10 offset:24576
  v_exp_f32 v38, v38
  v_mfma_f32_16x16x32_bf16 v[44:47], a[84:87], a[20:23], v[44:47]
  ds_read_b128 a[124:127], v11 offset:24576
  v_cvt_pk_bf16_f32 v66, v36, v37
  v_mfma_f32_16x16x32_bf16 v[44:47], a[88:91], a[24:27], v[44:47]
  ds_read_b128 a[192:195], v8 offset:32768
  v_exp_f32 v39, v39
  v_mfma_f32_16x16x32_bf16 v[44:47], a[92:95], a[28:31], v[44:47]
  ds_read_b128 a[196:199], v9 offset:32768
  v_mfma_f32_16x16x32_bf16 v[60:63], v[124:127], v[76:79], v[60:63]
  ds_read_b128 a[200:203], v10 offset:32768
  v_cvt_pk_bf16_f32 v67, v38, v39
  v_mfma_f32_16x16x32_bf16 v[140:143], a[160:163], v[76:79], v[140:143]
  ds_read_b128 a[204:207], v11 offset:32768
  ds_read_b128 a[208:211], v8 offset:40960
  v_mfma_f32_16x16x32_bf16 v[156:159], a[164:167], v[76:79], v[156:159]
  ds_read_b128 a[212:215], v9 offset:40960
  v_exp_f32 v40, v40
  v_mfma_f32_16x16x32_bf16 v[172:175], a[168:171], v[76:79], v[172:175]
  ds_read_b128 a[216:219], v10 offset:40960
  v_exp_f32 v41, v41
  v_mfma_f32_16x16x32_bf16 v[188:191], a[172:175], v[76:79], v[188:191]
  ds_read_b128 a[220:223], v11 offset:40960
  buffer_load_dwordx4 v120, s[24:27], s64 offen lds
  v_mfma_f32_16x16x32_bf16 v[204:207], a[176:179], v[76:79], v[204:207]
  v_exp_f32 v42, v42
  v_mfma_f32_16x16x32_bf16 v[220:223], a[180:183], v[76:79], v[220:223]
  v_cvt_pk_bf16_f32 v68, v40, v41
  v_mfma_f32_16x16x32_bf16 v[236:239], a[184:187], v[76:79], v[236:239]
  buffer_load_dwordx4 v121, s[24:27], s64 offen offset:1024 lds
  v_exp_f32 v43, v43
  v_mfma_f32_16x16x32_bf16 v[252:255], a[188:191], v[76:79], v[252:255]
  ds_read_b64_tr_b16 a[160:161], v12 offset:16384
  ds_read_b64_tr_b16 a[162:163], v12 offset:24576
  v_mfma_f32_16x16x32_bf16 v[96:99], a[64:67], a[32:35], v[88:91]
  ds_read_b64_tr_b16 a[164:165], v13 offset:16384
  v_exp_f32 v44, v44
  v_mfma_f32_16x16x32_bf16 v[96:99], a[68:71], a[36:39], v[96:99]
  ds_read_b64_tr_b16 a[166:167], v13 offset:24576
  v_cvt_pk_bf16_f32 v69, v42, v43
  v_mfma_f32_16x16x32_bf16 v[96:99], a[72:75], a[40:43], v[96:99]
  ds_read_b64_tr_b16 a[168:169], v14 offset:16384
  v_exp_f32 v45, v45
  v_mfma_f32_16x16x32_bf16 v[96:99], a[76:79], a[44:47], v[96:99]
  ds_read_b64_tr_b16 a[170:171], v14 offset:24576
  ds_read_b64_tr_b16 a[172:173], v15 offset:16384
  v_mfma_f32_16x16x32_bf16 v[100:103], a[80:83], a[32:35], v[88:91]
  ds_read_b64_tr_b16 a[174:175], v15 offset:24576
  v_exp_f32 v46, v46
  v_mfma_f32_16x16x32_bf16 v[100:103], a[84:87], a[36:39], v[100:103]
  ds_read_b64_tr_b16 a[176:177], v16 offset:16384
  v_cvt_pk_bf16_f32 v70, v44, v45
  v_mfma_f32_16x16x32_bf16 v[100:103], a[88:91], a[40:43], v[100:103]
  ds_read_b64_tr_b16 a[178:179], v16 offset:24576
  v_exp_f32 v47, v47
  v_mfma_f32_16x16x32_bf16 v[100:103], a[92:95], a[44:47], v[100:103]
  s_waitcnt lgkmcnt(15)
  ds_read_b64_tr_b16 a[180:181], v17 offset:16384
  buffer_load_dwordx4 v122, s[24:27], s64 offen offset:2048 lds
  v_mfma_f32_16x16x32_bf16 v[48:51], v[124:127], v[64:67], v[48:51]
  ds_read_b64_tr_b16 a[182:183], v17 offset:24576
  v_cvt_pk_bf16_f32 v71, v46, v47
  v_mfma_f32_16x16x32_bf16 v[128:131], a[128:131], v[64:67], v[128:131]
  ds_read_b64_tr_b16 a[184:185], v18 offset:16384
  ds_read_b64_tr_b16 a[186:187], v18 offset:24576
  v_mfma_f32_16x16x32_bf16 v[144:147], a[132:135], v[64:67], v[144:147]
  ds_read_b64_tr_b16 a[188:189], v19 offset:16384
  v_exp_f32 v96, v96
  v_mfma_f32_16x16x32_bf16 v[160:163], a[136:139], v[64:67], v[160:163]
  ds_read_b64_tr_b16 a[190:191], v19 offset:24576
  v_exp_f32 v97, v97
  v_mfma_f32_16x16x32_bf16 v[176:179], a[140:143], v[64:67], v[176:179]
  buffer_load_dwordx4 v123, s[24:27], s64 offen offset:3072 lds
  v_mfma_f32_16x16x32_bf16 v[192:195], a[144:147], v[64:67], v[192:195]
  v_exp_f32 v98, v98
  v_mfma_f32_16x16x32_bf16 v[208:211], a[148:151], v[64:67], v[208:211]
  v_cvt_pk_bf16_f32 v72, v96, v97
  v_mfma_f32_16x16x32_bf16 v[224:227], a[152:155], v[64:67], v[224:227]
  v_exp_f32 v99, v99
  v_mfma_f32_16x16x32_bf16 v[240:243], a[156:159], v[64:67], v[240:243]
  s_add_u32 s62, s62, 32768
  v_mfma_f32_16x16x32_bf16 v[32:35], a[64:67], a[48:51], v[92:95]
  v_exp_f32 v100, v100
  v_mfma_f32_16x16x32_bf16 v[32:35], a[68:71], a[52:55], v[32:35]
  v_cvt_pk_bf16_f32 v73, v98, v99
  v_mfma_f32_16x16x32_bf16 v[32:35], a[72:75], a[56:59], v[32:35]
  v_exp_f32 v101, v101
  v_mfma_f32_16x16x32_bf16 v[32:35], a[76:79], a[60:63], v[32:35]
  v_mfma_f32_16x16x32_bf16 v[36:39], a[80:83], a[48:51], v[92:95]
  v_exp_f32 v102, v102
  v_mfma_f32_16x16x32_bf16 v[36:39], a[84:87], a[52:55], v[36:39]
  s_and_b32 s62, s62, 0xf8000
  v_cvt_pk_bf16_f32 v74, v100, v101
  v_mfma_f32_16x16x32_bf16 v[36:39], a[88:91], a[56:59], v[36:39]
  v_exp_f32 v103, v103
  v_mfma_f32_16x16x32_bf16 v[36:39], a[92:95], a[60:63], v[36:39]
  ds_read_b128 a[64:67], v8 offset:49152
  v_mfma_f32_16x16x32_bf16 v[52:55], v[124:127], v[68:71], v[52:55]
  ds_read_b128 a[68:71], v9 offset:49152
  v_cvt_pk_bf16_f32 v75, v102, v103
  v_mfma_f32_16x16x32_bf16 v[132:135], a[128:131], v[68:71], v[132:135]
  ds_read_b128 a[72:75], v10 offset:49152
  ds_read_b128 a[76:79], v11 offset:49152
  v_mfma_f32_16x16x32_bf16 v[148:151], a[132:135], v[68:71], v[148:151]
  ds_read_b128 a[80:83], v8 offset:57344
  v_exp_f32 v32, v32
  v_mfma_f32_16x16x32_bf16 v[164:167], a[136:139], v[68:71], v[164:167]
  s_or_b32 s64, s62, s63
  ds_read_b128 a[84:87], v9 offset:57344
  v_exp_f32 v33, v33
  v_mfma_f32_16x16x32_bf16 v[180:183], a[140:143], v[68:71], v[180:183]
  ds_read_b128 a[88:91], v10 offset:57344
  ds_read_b128 a[92:95], v11 offset:57344
  v_mfma_f32_16x16x32_bf16 v[196:199], a[144:147], v[68:71], v[196:199]
  ds_read_b64_tr_b16 a[224:225], v12 offset:32768
  v_exp_f32 v34, v34
  v_mfma_f32_16x16x32_bf16 v[212:215], a[148:151], v[68:71], v[212:215]
  ds_read_b64_tr_b16 a[226:227], v12 offset:40960
  v_cvt_pk_bf16_f32 v76, v32, v33
  v_mfma_f32_16x16x32_bf16 v[228:231], a[152:155], v[68:71], v[228:231]
  ds_read_b64_tr_b16 a[228:229], v13 offset:32768
  v_exp_f32 v35, v35
  v_mfma_f32_16x16x32_bf16 v[244:247], a[156:159], v[68:71], v[244:247]
  s_waitcnt lgkmcnt(15)
  ds_read_b64_tr_b16 a[230:231], v13 offset:40960
  ds_read_b64_tr_b16 a[232:233], v14 offset:32768
  v_mfma_f32_16x16x32_bf16 v[40:43], a[96:99], a[0:3], v[80:83]
  s_add_u32 m0, s51, 131072
  ds_read_b64_tr_b16 a[234:235], v14 offset:40960
  v_exp_f32 v36, v36
  v_mfma_f32_16x16x32_bf16 v[40:43], a[100:103], a[4:7], v[40:43]
  ds_read_b64_tr_b16 a[236:237], v15 offset:32768
  v_cvt_pk_bf16_f32 v77, v34, v35
  v_mfma_f32_16x16x32_bf16 v[40:43], a[104:107], a[8:11], v[40:43]
  ds_read_b64_tr_b16 a[238:239], v15 offset:40960
  v_exp_f32 v37, v37
  v_mfma_f32_16x16x32_bf16 v[40:43], a[108:111], a[12:15], v[40:43]
  ds_read_b64_tr_b16 a[240:241], v16 offset:32768
  ds_read_b64_tr_b16 a[242:243], v16 offset:40960
  v_mfma_f32_16x16x32_bf16 v[44:47], a[112:115], a[0:3], v[80:83]
  ds_read_b64_tr_b16 a[244:245], v17 offset:32768
  v_exp_f32 v38, v38
  v_mfma_f32_16x16x32_bf16 v[44:47], a[116:119], a[4:7], v[44:47]
  ds_read_b64_tr_b16 a[246:247], v17 offset:40960
  v_cvt_pk_bf16_f32 v78, v36, v37
  v_mfma_f32_16x16x32_bf16 v[44:47], a[120:123], a[8:11], v[44:47]
  ds_read_b64_tr_b16 a[248:249], v18 offset:32768
  v_exp_f32 v39, v39
  v_mfma_f32_16x16x32_bf16 v[44:47], a[124:127], a[12:15], v[44:47]
  ds_read_b64_tr_b16 a[250:251], v18 offset:40960
  buffer_load_dwordx4 v120, s[24:27], s64 offen lds
  v_mfma_f32_16x16x32_bf16 v[56:59], v[124:127], v[72:75], v[56:59]
  ds_read_b64_tr_b16 a[252:253], v19 offset:32768
  v_cvt_pk_bf16_f32 v79, v38, v39
  v_mfma_f32_16x16x32_bf16 v[136:139], a[128:131], v[72:75], v[136:139]
  ds_read_b64_tr_b16 a[254:255], v19 offset:40960
  v_mfma_f32_16x16x32_bf16 v[152:155], a[132:135], v[72:75], v[152:155]
  v_exp_f32 v40, v40
  v_mfma_f32_16x16x32_bf16 v[168:171], a[136:139], v[72:75], v[168:171]
  v_exp_f32 v41, v41
  v_mfma_f32_16x16x32_bf16 v[184:187], a[140:143], v[72:75], v[184:187]
  buffer_load_dwordx4 v121, s[24:27], s64 offen offset:1024 lds
  v_mfma_f32_16x16x32_bf16 v[200:203], a[144:147], v[72:75], v[200:203]
  v_exp_f32 v42, v42
  v_mfma_f32_16x16x32_bf16 v[216:219], a[148:151], v[72:75], v[216:219]
  v_cvt_pk_bf16_f32 v64, v40, v41
  v_mfma_f32_16x16x32_bf16 v[232:235], a[152:155], v[72:75], v[232:235]
  v_exp_f32 v43, v43
  v_mfma_f32_16x16x32_bf16 v[248:251], a[156:159], v[72:75], v[248:251]
  s_waitcnt lgkmcnt(15)
  v_mfma_f32_16x16x32_bf16 v[96:99], a[192:195], a[0:3], v[80:83]
  v_exp_f32 v44, v44
  v_mfma_f32_16x16x32_bf16 v[96:99], a[196:199], a[4:7], v[96:99]
  v_cvt_pk_bf16_f32 v65, v42, v43
  v_mfma_f32_16x16x32_bf16 v[96:99], a[200:203], a[8:11], v[96:99]
  v_exp_f32 v45, v45
  v_mfma_f32_16x16x32_bf16 v[96:99], a[204:207], a[12:15], v[96:99]
  buffer_load_dwordx4 v122, s[24:27], s64 offen offset:2048 lds
  v_mfma_f32_16x16x32_bf16 v[100:103], a[208:211], a[0:3], v[80:83]
  v_exp_f32 v46, v46
  v_mfma_f32_16x16x32_bf16 v[100:103], a[212:215], a[4:7], v[100:103]
  v_cvt_pk_bf16_f32 v66, v44, v45
  v_mfma_f32_16x16x32_bf16 v[100:103], a[216:219], a[8:11], v[100:103]
  v_exp_f32 v47, v47
  v_mfma_f32_16x16x32_bf16 v[100:103], a[220:223], a[12:15], v[100:103]
  buffer_load_dwordx4 v123, s[24:27], s64 offen offset:3072 lds
  v_mfma_f32_16x16x32_bf16 v[60:63], v[124:127], v[76:79], v[60:63]
  v_cvt_pk_bf16_f32 v67, v46, v47
  v_mfma_f32_16x16x32_bf16 v[140:143], a[128:131], v[76:79], v[140:143]
  v_mfma_f32_16x16x32_bf16 v[156:159], a[132:135], v[76:79], v[156:159]
  v_exp_f32 v96, v96
  v_mfma_f32_16x16x32_bf16 v[172:175], a[136:139], v[76:79], v[172:175]
  v_exp_f32 v97, v97
  v_mfma_f32_16x16x32_bf16 v[188:191], a[140:143], v[76:79], v[188:191]
  s_add_u32 s62, s62, 32768
  v_mfma_f32_16x16x32_bf16 v[204:207], a[144:147], v[76:79], v[204:207]
  v_exp_f32 v98, v98
  v_mfma_f32_16x16x32_bf16 v[220:223], a[148:151], v[76:79], v[220:223]
  v_cvt_pk_bf16_f32 v68, v96, v97
  v_mfma_f32_16x16x32_bf16 v[236:239], a[152:155], v[76:79], v[236:239]
  v_exp_f32 v99, v99
  v_mfma_f32_16x16x32_bf16 v[252:255], a[156:159], v[76:79], v[252:255]
  s_waitcnt lgkmcnt(15)
  ds_read_b64_tr_b16 a[128:129], v12 offset:49152
  ds_read_b64_tr_b16 a[130:131], v12 offset:57344
  v_mfma_f32_16x16x32_bf16 v[32:35], a[64:67], a[0:3], v[80:83]
  ds_read_b64_tr_b16 a[132:133], v13 offset:49152
  v_exp_f32 v100, v100
  v_mfma_f32_16x16x32_bf16 v[32:35], a[68:71], a[4:7], v[32:35]
  s_and_b32 s62, s62, 0xf8000
  ds_read_b64_tr_b16 a[134:135], v13 offset:57344
  v_cvt_pk_bf16_f32 v69, v98, v99
  v_mfma_f32_16x16x32_bf16 v[32:35], a[72:75], a[8:11], v[32:35]
  ds_read_b64_tr_b16 a[136:137], v14 offset:49152
  v_exp_f32 v101, v101
  v_mfma_f32_16x16x32_bf16 v[32:35], a[76:79], a[12:15], v[32:35]
  ds_read_b64_tr_b16 a[138:139], v14 offset:57344
  ds_read_b64_tr_b16 a[140:141], v15 offset:49152
  v_mfma_f32_16x16x32_bf16 v[36:39], a[80:83], a[0:3], v[80:83]
  ds_read_b64_tr_b16 a[142:143], v15 offset:57344
  v_exp_f32 v102, v102
  v_mfma_f32_16x16x32_bf16 v[36:39], a[84:87], a[4:7], v[36:39]
  ds_read_b64_tr_b16 a[144:145], v16 offset:49152
  v_cvt_pk_bf16_f32 v70, v100, v101
  v_mfma_f32_16x16x32_bf16 v[36:39], a[88:91], a[8:11], v[36:39]
  ds_read_b64_tr_b16 a[146:147], v16 offset:57344
  v_exp_f32 v103, v103
  v_mfma_f32_16x16x32_bf16 v[36:39], a[92:95], a[12:15], v[36:39]
  s_waitcnt lgkmcnt(15)
  ds_read_b64_tr_b16 a[148:149], v17 offset:49152
  v_mfma_f32_16x16x32_bf16 v[48:51], v[124:127], v[64:67], v[48:51]
  s_or_b32 s64, s62, s63
  ds_read_b64_tr_b16 a[150:151], v17 offset:57344
  v_cvt_pk_bf16_f32 v71, v102, v103
  v_mfma_f32_16x16x32_bf16 v[128:131], a[160:163], v[64:67], v[128:131]
  ds_read_b64_tr_b16 a[152:153], v18 offset:49152
  ds_read_b64_tr_b16 a[154:155], v18 offset:57344
  v_mfma_f32_16x16x32_bf16 v[144:147], a[164:167], v[64:67], v[144:147]
  ds_read_b64_tr_b16 a[156:157], v19 offset:49152
  v_exp_f32 v32, v32
  v_mfma_f32_16x16x32_bf16 v[160:163], a[168:171], v[64:67], v[160:163]
  ds_read_b64_tr_b16 a[158:159], v19 offset:57344
  v_exp_f32 v33, v33
  v_mfma_f32_16x16x32_bf16 v[176:179], a[172:175], v[64:67], v[176:179]
  v_mfma_f32_16x16x32_bf16 v[192:195], a[176:179], v[64:67], v[192:195]
  v_exp_f32 v34, v34
  v_mfma_f32_16x16x32_bf16 v[208:211], a[180:183], v[64:67], v[208:211]
  v_cvt_pk_bf16_f32 v72, v32, v33
  v_mfma_f32_16x16x32_bf16 v[224:227], a[184:187], v[64:67], v[224:227]
  v_exp_f32 v35, v35
  v_mfma_f32_16x16x32_bf16 v[240:243], a[188:191], v[64:67], v[240:243]
  v_mfma_f32_16x16x32_bf16 v[40:43], a[96:99], a[16:19], v[84:87]
  v_exp_f32 v36, v36
  v_mfma_f32_16x16x32_bf16 v[40:43], a[100:103], a[20:23], v[40:43]
  v_cvt_pk_bf16_f32 v73, v34, v35
  v_mfma_f32_16x16x32_bf16 v[40:43], a[104:107], a[24:27], v[40:43]
  v_exp_f32 v37, v37
  v_mfma_f32_16x16x32_bf16 v[40:43], a[108:111], a[28:31], v[40:43]
  v_mfma_f32_16x16x32_bf16 v[44:47], a[112:115], a[16:19], v[84:87]
  v_exp_f32 v38, v38
  v_mfma_f32_16x16x32_bf16 v[44:47], a[116:119], a[20:23], v[44:47]
  v_cvt_pk_bf16_f32 v74, v36, v37
  v_mfma_f32_16x16x32_bf16 v[44:47], a[120:123], a[24:27], v[44:47]
  v_exp_f32 v39, v39
  v_mfma_f32_16x16x32_bf16 v[44:47], a[124:127], a[28:31], v[44:47]
  s_waitcnt lgkmcnt(15)
  v_mfma_f32_16x16x32_bf16 v[48:51], v[124:127], v[68:71], v[48:51]
  v_cvt_pk_bf16_f32 v75, v38, v39
  v_mfma_f32_16x16x32_bf16 v[128:131], a[224:227], v[68:71], v[128:131]
  v_mfma_f32_16x16x32_bf16 v[144:147], a[228:231], v[68:71], v[144:147]
  v_exp_f32 v40, v40
  v_mfma_f32_16x16x32_bf16 v[160:163], a[232:235], v[68:71], v[160:163]
  v_exp_f32 v41, v41
  v_mfma_f32_16x16x32_bf16 v[176:179], a[236:239], v[68:71], v[176:179]
  v_mfma_f32_16x16x32_bf16 v[192:195], a[240:243], v[68:71], v[192:195]
  v_exp_f32 v42, v42
  v_mfma_f32_16x16x32_bf16 v[208:211], a[244:247], v[68:71], v[208:211]
  v_cvt_pk_bf16_f32 v76, v40, v41
  v_mfma_f32_16x16x32_bf16 v[224:227], a[248:251], v[68:71], v[224:227]
  v_exp_f32 v43, v43
  v_mfma_f32_16x16x32_bf16 v[240:243], a[252:255], v[68:71], v[240:243]
  v_mfma_f32_16x16x32_bf16 v[96:99], a[192:195], a[16:19], v[84:87]
  v_exp_f32 v44, v44
  v_mov_b32 v31, 0x4b800000
  v_mfma_f32_16x16x32_bf16 v[96:99], a[196:199], a[20:23], v[96:99]
  v_cvt_pk_bf16_f32 v77, v42, v43
  v_mfma_f32_16x16x32_bf16 v[96:99], a[200:203], a[24:27], v[96:99]
  v_exp_f32 v45, v45
  v_mfma_f32_16x16x32_bf16 v[96:99], a[204:207], a[28:31], v[96:99]
  v_mfma_f32_16x16x32_bf16 v[100:103], a[208:211], a[16:19], v[84:87]
  v_exp_f32 v46, v46
  v_mfma_f32_16x16x32_bf16 v[100:103], a[212:215], a[20:23], v[100:103]
  v_cvt_pk_bf16_f32 v78, v44, v45
  v_mfma_f32_16x16x32_bf16 v[100:103], a[216:219], a[24:27], v[100:103]
  s_waitcnt vmcnt(10)
  v_exp_f32 v47, v47
  v_mfma_f32_16x16x32_bf16 v[100:103], a[220:223], a[28:31], v[100:103]
  s_waitcnt lgkmcnt(0)
  v_mfma_f32_16x16x32_bf16 v[48:51], v[124:127], v[72:75], v[48:51]
  s_barrier
  v_cvt_pk_bf16_f32 v79, v46, v47
  v_mfma_f32_16x16x32_bf16 v[128:131], a[128:131], v[72:75], v[128:131]
  s_add_u32 m0, s51, 135168
  buffer_store_dword v112, v113, s[8:11], s69 offen sc1
  v_mfma_f32_16x16x32_bf16 v[144:147], a[132:135], v[72:75], v[144:147]
  v_exp_f32 v96, v96
  v_mfma_f32_16x16x32_bf16 v[160:163], a[136:139], v[72:75], v[160:163]
  v_exp_f32 v97, v97
  v_mfma_f32_16x16x32_bf16 v[176:179], a[140:143], v[72:75], v[176:179]
  buffer_load_dwordx4 v120, s[24:27], s64 offen lds
  v_cmp_nle_f32 s[38:39], v48, v31
  v_mfma_f32_16x16x32_bf16 v[192:195], a[144:147], v[72:75], v[192:195]
  v_exp_f32 v98, v98
  v_rcp_f32 v104, v48
  v_mfma_f32_16x16x32_bf16 v[208:211], a[148:151], v[72:75], v[208:211]
  s_or_b64 s[40:41], s[40:41], s[38:39]
  v_cvt_pk_bf16_f32 v64, v96, v97
  v_mfma_f32_16x16x32_bf16 v[224:227], a[152:155], v[72:75], v[224:227]
  v_exp_f32 v99, v99
  v_mfma_f32_16x16x32_bf16 v[240:243], a[156:159], v[72:75], v[240:243]
  buffer_load_dwordx4 v121, s[24:27], s64 offen offset:1024 lds
  v_mfma_f32_16x16x32_bf16 v[32:35], a[64:67], a[16:19], v[84:87]
  v_exp_f32 v100, v100
  v_mfma_f32_16x16x32_bf16 v[32:35], a[68:71], a[20:23], v[32:35]
  v_cvt_pk_bf16_f32 v65, v98, v99
  v_mfma_f32_16x16x32_bf16 v[32:35], a[72:75], a[24:27], v[32:35]
  v_exp_f32 v101, v101
  v_mul_f32 v128, v128, v104
  v_mul_f32 v129, v129, v104
  v_mfma_f32_16x16x32_bf16 v[32:35], a[76:79], a[28:31], v[32:35]
  buffer_load_dwordx4 v122, s[24:27], s64 offen offset:2048 lds
  v_mul_f32 v130, v130, v104
  v_mfma_f32_16x16x32_bf16 v[36:39], a[80:83], a[16:19], v[84:87]
  v_exp_f32 v102, v102
  v_mul_f32 v131, v131, v104
  v_mfma_f32_16x16x32_bf16 v[36:39], a[84:87], a[20:23], v[36:39]
  v_cvt_pk_bf16_f32 v66, v100, v101
  v_mul_f32 v144, v144, v104
  v_mul_f32 v145, v145, v104
  v_mfma_f32_16x16x32_bf16 v[36:39], a[88:91], a[24:27], v[36:39]
  v_exp_f32 v103, v103
  v_mul_f32 v146, v146, v104
  v_mfma_f32_16x16x32_bf16 v[36:39], a[92:95], a[28:31], v[36:39]
  buffer_load_dwordx4 v123, s[24:27], s64 offen offset:3072 lds
  v_mul_f32 v147, v147, v104
  v_mfma_f32_16x16x32_bf16 v[52:55], v[124:127], v[76:79], v[52:55]
  s_add_u32 s62, s62, 32768
  v_cvt_pk_bf16_f32 v67, v102, v103
  v_cvt_pk_bf16_f32 v128, v128, v129
  v_cvt_pk_bf16_f32 v129, v130, v131
  v_mfma_f32_16x16x32_bf16 v[132:135], a[160:163], v[76:79], v[132:135]
  v_cvt_pk_bf16_f32 v130, v144, v145
  v_mfma_f32_16x16x32_bf16 v[148:151], a[164:167], v[76:79], v[148:151]
  v_exp_f32 v32, v32
  v_cvt_pk_bf16_f32 v131, v146, v147
  v_mfma_f32_16x16x32_bf16 v[164:167], a[168:171], v[76:79], v[164:167]
  s_add_u32 s66, s65, 0
  v_exp_f32 v33, v33
  v_mfma_f32_16x16x32_bf16 v[180:183], a[172:175], v[76:79], v[180:183]
  s_and_b32 s62, s62, 0xf8000
  buffer_store_dwordx4 v[128:131], v28, s[8:11], s66 offen sc1
  v_mul_f32 v160, v160, v104
  v_mfma_f32_16x16x32_bf16 v[196:199], a[176:179], v[76:79], v[196:199]
  v_exp_f32 v34, v34
  v_mul_f32 v161, v161, v104
  v_mfma_f32_16x16x32_bf16 v[212:215], a[180:183], v[76:79], v[212:215]
  v_cvt_pk_bf16_f32 v68, v32, v33
  v_mul_f32 v162, v162, v104
  v_mfma_f32_16x16x32_bf16 v[228:231], a[184:187], v[76:79], v[228:231]
  s_or_b32 s64, s62, s63
  v_exp_f32 v35, v35
  v_mul_f32 v163, v163, v104
  v_mul_f32 v176, v176, v104
  v_mfma_f32_16x16x32_bf16 v[244:247], a[188:191], v[76:79], v[244:247]
  v_mul_f32 v177, v177, v104
  v_mfma_f32_16x16x32_bf16 v[40:43], a[96:99], a[32:35], v[88:91]
  v_exp_f32 v36, v36
  v_mul_f32 v178, v178, v104
  v_mfma_f32_16x16x32_bf16 v[40:43], a[100:103], a[36:39], v[40:43]
  v_cvt_pk_bf16_f32 v69, v34, v35
  v_mul_f32 v179, v179, v104
  v_mfma_f32_16x16x32_bf16 v[40:43], a[104:107], a[40:43], v[40:43]
  s_add_u32 m0, s51, 0
  v_exp_f32 v37, v37
  v_cvt_pk_bf16_f32 v160, v160, v161
  v_cvt_pk_bf16_f32 v161, v162, v163
  v_mfma_f32_16x16x32_bf16 v[40:43], a[108:111], a[44:47], v[40:43]
  v_cvt_pk_bf16_f32 v162, v176, v177
  v_mfma_f32_16x16x32_bf16 v[44:47], a[112:115], a[32:35], v[88:91]
  v_exp_f32 v38, v38
  v_cvt_pk_bf16_f32 v163, v178, v179
  v_mfma_f32_16x16x32_bf16 v[44:47], a[116:119], a[36:39], v[44:47]
  buffer_store_dwordx4 v[160:163], v28, s[8:11], s66 offen offset:1024 sc1
  v_cvt_pk_bf16_f32 v70, v36, v37
  v_mul_f32 v192, v192, v104
  v_mfma_f32_16x16x32_bf16 v[44:47], a[120:123], a[40:43], v[44:47]
  v_exp_f32 v39, v39
  v_mul_f32 v193, v193, v104
  v_mfma_f32_16x16x32_bf16 v[44:47], a[124:127], a[44:47], v[44:47]
  buffer_load_dwordx4 v120, s[24:27], s64 offen lds
  v_mul_f32 v194, v194, v104
  v_mfma_f32_16x16x32_bf16 v[52:55], v[124:127], v[64:67], v[52:55]
  v_cvt_pk_bf16_f32 v71, v38, v39
  v_mul_f32 v195, v195, v104
  v_mul_f32 v208, v208, v104
  v_mfma_f32_16x16x32_bf16 v[132:135], a[224:227], v[64:67], v[132:135]
  buffer_load_dwordx4 v121, s[24:27], s64 offen offset:1024 lds
  v_mul_f32 v209, v209, v104
  v_mfma_f32_16x16x32_bf16 v[148:151], a[228:231], v[64:67], v[148:151]
  v_exp_f32 v40, v40
  v_mul_f32 v210, v210, v104
  v_mfma_f32_16x16x32_bf16 v[164:167], a[232:235], v[64:67], v[164:167]
  v_exp_f32 v41, v41
  v_mul_f32 v211, v211, v104
  v_mfma_f32_16x16x32_bf16 v[180:183], a[236:239], v[64:67], v[180:183]
  buffer_load_dwordx4 v122, s[24:27], s64 offen offset:2048 lds
  v_cvt_pk_bf16_f32 v192, v192, v193
  v_cvt_pk_bf16_f32 v193, v194, v195
  v_mfma_f32_16x16x32_bf16 v[196:199], a[240:243], v[64:67], v[196:199]
  v_exp_f32 v42, v42
  v_cvt_pk_bf16_f32 v194, v208, v209
  v_mfma_f32_16x16x32_bf16 v[212:215], a[244:247], v[64:67], v[212:215]
  v_cvt_pk_bf16_f32 v72, v40, v41
  v_cvt_pk_bf16_f32 v195, v210, v211
  v_mfma_f32_16x16x32_bf16 v[228:231], a[248:251], v[64:67], v[228:231]
  buffer_store_dwordx4 v[192:195], v28, s[8:11], s66 offen offset:2048 sc1
  v_exp_f32 v43, v43
  v_mul_f32 v224, v224, v104
  v_mfma_f32_16x16x32_bf16 v[244:247], a[252:255], v[64:67], v[244:247]
  buffer_load_dwordx4 v123, s[24:27], s64 offen offset:3072 lds
  v_mul_f32 v225, v225, v104
  v_mfma_f32_16x16x32_bf16 v[96:99], a[192:195], a[32:35], v[88:91]
  v_exp_f32 v44, v44
  v_mul_f32 v226, v226, v104
  v_mfma_f32_16x16x32_bf16 v[96:99], a[196:199], a[36:39], v[96:99]
  s_add_u32 s62, s62, 32768
  v_cvt_pk_bf16_f32 v73, v42, v43
  v_mul_f32 v227, v227, v104
  v_mfma_f32_16x16x32_bf16 v[96:99], a[200:203], a[40:43], v[96:99]
  v_exp_f32 v45, v45
  v_mul_f32 v240, v240, v104
  v_mul_f32 v241, v241, v104
  v_mfma_f32_16x16x32_bf16 v[96:99], a[204:207], a[44:47], v[96:99]
  v_mul_f32 v242, v242, v104
  v_mfma_f32_16x16x32_bf16 v[100:103], a[208:211], a[32:35], v[88:91]
  v_exp_f32 v46, v46
  v_mul_f32 v243, v243, v104
  v_mfma_f32_16x16x32_bf16 v[100:103], a[212:215], a[36:39], v[100:103]
  s_and_b32 s62, s62, 0xf8000
  v_cvt_pk_bf16_f32 v74, v44, v45
  v_cvt_pk_bf16_f32 v224, v224, v225
  v_cvt_pk_bf16_f32 v225, v226, v227
  v_mfma_f32_16x16x32_bf16 v[100:103], a[216:219], a[40:43], v[100:103]
  v_exp_f32 v47, v47
  v_cvt_pk_bf16_f32 v226, v240, v241
  v_mfma_f32_16x16x32_bf16 v[100:103], a[220:223], a[44:47], v[100:103]
  v_cvt_pk_bf16_f32 v227, v242, v243
  v_mfma_f32_16x16x32_bf16 v[52:55], v[124:127], v[68:71], v[52:55]
  s_or_b32 s64, s62, s63
  buffer_store_dwordx4 v[224:227], v28, s[8:11], s66 offen offset:3072 sc1
  v_cvt_pk_bf16_f32 v75, v46, v47
  v_mfma_f32_16x16x32_bf16 v[132:135], a[128:131], v[68:71], v[132:135]
  v_mfma_f32_16x16x32_bf16 v[148:151], a[132:135], v[68:71], v[148:151]
  v_exp_f32 v96, v96
  v_mfma_f32_16x16x32_bf16 v[164:167], a[136:139], v[68:71], v[164:167]
  v_exp_f32 v97, v97
  v_mfma_f32_16x16x32_bf16 v[180:183], a[140:143], v[68:71], v[180:183]
  s_add_u32 m0, s51, 4096
  v_cmp_nle_f32 s[38:39], v52, v31
  v_rcp_f32 v106, v52
  v_mfma_f32_16x16x32_bf16 v[196:199], a[144:147], v[68:71], v[196:199]
  s_or_b64 s[40:41], s[40:41], s[38:39]
  v_exp_f32 v98, v98
  v_mfma_f32_16x16x32_bf16 v[212:215], a[148:151], v[68:71], v[212:215]
  v_cvt_pk_bf16_f32 v76, v96, v97
  v_mfma_f32_16x16x32_bf16 v[228:231], a[152:155], v[68:71], v[228:231]
  v_exp_f32 v99, v99
  v_mfma_f32_16x16x32_bf16 v[244:247], a[156:159], v[68:71], v[244:247]
  buffer_load_dwordx4 v120, s[24:27], s64 offen lds
  v_mfma_f32_16x16x32_bf16 v[32:35], a[64:67], a[32:35], v[88:91]
  v_exp_f32 v100, v100
  v_mfma_f32_16x16x32_bf16 v[32:35], a[68:71], a[36:39], v[32:35]
  v_cvt_pk_bf16_f32 v77, v98, v99
  v_mfma_f32_16x16x32_bf16 v[32:35], a[72:75], a[40:43], v[32:35]
  v_exp_f32 v101, v101
  v_mul_f32 v132, v132, v106
  v_mul_f32 v133, v133, v106
  v_mfma_f32_16x16x32_bf16 v[32:35], a[76:79], a[44:47], v[32:35]
  buffer_load_dwordx4 v121, s[24:27], s64 offen offset:1024 lds
  v_mul_f32 v134, v134, v106
  v_mfma_f32_16x16x32_bf16 v[36:39], a[80:83], a[32:35], v[88:91]
  v_exp_f32 v102, v102
  v_mul_f32 v135, v135, v106
  v_mul_f32 v148, v148, v106
  v_mfma_f32_16x16x32_bf16 v[36:39], a[84:87], a[36:39], v[36:39]
  v_cvt_pk_bf16_f32 v78, v100, v101
  v_mul_f32 v149, v149, v106
  v_mfma_f32_16x16x32_bf16 v[36:39], a[88:91], a[40:43], v[36:39]
  v_exp_f32 v103, v103
  v_mul_f32 v150, v150, v106
  v_mul_f32 v151, v151, v106
  v_mfma_f32_16x16x32_bf16 v[36:39], a[92:95], a[44:47], v[36:39]
  buffer_load_dwordx4 v122, s[24:27], s64 offen offset:2048 lds
  v_cvt_pk_bf16_f32 v132, v132, v133
  v_mfma_f32_16x16x32_bf16 v[56:59], v[124:127], v[72:75], v[56:59]
  v_cvt_pk_bf16_f32 v79, v102, v103
  v_cvt_pk_bf16_f32 v133, v134, v135
  v_cvt_pk_bf16_f32 v134, v148, v149
  v_mfma_f32_16x16x32_bf16 v[136:139], a[160:163], v[72:75], v[136:139]
  buffer_load_dwordx4 v123, s[24:27], s64 offen offset:3072 lds
  v_cvt_pk_bf16_f32 v135, v150, v151
  v_mfma_f32_16x16x32_bf16 v[152:155], a[164:167], v[72:75], v[152:155]
  s_add_u32 s66, s65, 4096
  v_exp_f32 v32, v32
  v_mfma_f32_16x16x32_bf16 v[168:171], a[168:171], v[72:75], v[168:171]
  s_add_u32 s62, s62, 32768
  buffer_store_dwordx4 v[132:135], v28, s[8:11], s66 offen sc1
  v_exp_f32 v33, v33
  v_mul_f32 v164, v164, v106
  v_mfma_f32_16x16x32_bf16 v[184:187], a[172:175], v[72:75], v[184:187]
  v_mul_f32 v165, v165, v106
  v_mfma_f32_16x16x32_bf16 v[200:203], a[176:179], v[72:75], v[200:203]
  v_exp_f32 v34, v34
  v_mul_f32 v166, v166, v106
  v_mul_f32 v167, v167, v106
  v_mfma_f32_16x16x32_bf16 v[216:219], a[180:183], v[72:75], v[216:219]
  v_cvt_pk_bf16_f32 v64, v32, v33
  v_mul_f32 v180, v180, v106
  v_mfma_f32_16x16x32_bf16 v[232:235], a[184:187], v[72:75], v[232:235]
  s_and_b32 s62, s62, 0xf8000
  v_exp_f32 v35, v35
  v_mul_f32 v181, v181, v106
  v_mul_f32 v182, v182, v106
  v_mfma_f32_16x16x32_bf16 v[248:251], a[188:191], v[72:75], v[248:251]
  v_mul_f32 v183, v183, v106
  v_mfma_f32_16x16x32_bf16 v[40:43], a[96:99], a[48:51], v[92:95]
  v_exp_f32 v36, v36
  v_cvt_pk_bf16_f32 v164, v164, v165
  v_mfma_f32_16x16x32_bf16 v[40:43], a[100:103], a[52:55], v[40:43]
  s_or_b32 s64, s62, s63
  v_cvt_pk_bf16_f32 v65, v34, v35
  v_cvt_pk_bf16_f32 v165, v166, v167
  v_cvt_pk_bf16_f32 v166, v180, v181
  v_mfma_f32_16x16x32_bf16 v[40:43], a[104:107], a[56:59], v[40:43]
  v_exp_f32 v37, v37
  v_cvt_pk_bf16_f32 v167, v182, v183
  v_mfma_f32_16x16x32_bf16 v[40:43], a[108:111], a[60:63], v[40:43]
  buffer_store_dwordx4 v[164:167], v28, s[8:11], s66 offen offset:1024 sc1
  v_mul_f32 v196, v196, v106
  v_mfma_f32_16x16x32_bf16 v[44:47], a[112:115], a[48:51], v[92:95]
  v_exp_f32 v38, v38
  v_mul_f32 v197, v197, v106
  v_mfma_f32_16x16x32_bf16 v[44:47], a[116:119], a[52:55], v[44:47]
  s_add_u32 m0, s51, 32768
  v_cvt_pk_bf16_f32 v66, v36, v37
  v_mul_f32 v198, v198, v106
  v_mul_f32 v199, v199, v106
  v_mfma_f32_16x16x32_bf16 v[44:47], a[120:123], a[56:59], v[44:47]
  v_exp_f32 v39, v39
  v_mul_f32 v212, v212, v106
  v_mfma_f32_16x16x32_bf16 v[44:47], a[124:127], a[60:63], v[44:47]
  v_mul_f32 v213, v213, v106
  v_mfma_f32_16x16x32_bf16 v[56:59], v[124:127], v[76:79], v[56:59]
  v_cvt_pk_bf16_f32 v67, v38, v39
  v_mul_f32 v214, v214, v106
  v_mul_f32 v215, v215, v106
  v_mfma_f32_16x16x32_bf16 v[136:139], a[224:227], v[76:79], v[136:139]
  buffer_load_dwordx4 v120, s[24:27], s64 offen lds
  v_cvt_pk_bf16_f32 v196, v196, v197
  v_mfma_f32_16x16x32_bf16 v[152:155], a[228:231], v[76:79], v[152:155]
  v_exp_f32 v40, v40
  v_cvt_pk_bf16_f32 v197, v198, v199
  v_cvt_pk_bf16_f32 v198, v212, v213
  v_mfma_f32_16x16x32_bf16 v[168:171], a[232:235], v[76:79], v[168:171]
  v_exp_f32 v41, v41
  v_cvt_pk_bf16_f32 v199, v214, v215
  v_mfma_f32_16x16x32_bf16 v[184:187], a[236:239], v[76:79], v[184:187]
  buffer_load_dwordx4 v121, s[24:27], s64 offen offset:1024 lds
  buffer_store_dwordx4 v[196:199], v28, s[8:11], s66 offen offset:2048 sc1
  v_mul_f32 v228, v228, v106
  v_mfma_f32_16x16x32_bf16 v[200:203], a[240:243], v[76:79], v[200:203]
  v_exp_f32 v42, v42
  v_mul_f32 v229, v229, v106
  v_mfma_f32_16x16x32_bf16 v[216:219], a[244:247], v[76:79], v[216:219]
  v_cvt_pk_bf16_f32 v68, v40, v41
  v_mul_f32 v230, v230, v106
  v_mfma_f32_16x16x32_bf16 v[232:235], a[248:251], v[76:79], v[232:235]
  v_exp_f32 v43, v43
  v_mul_f32 v231, v231, v106
  v_mul_f32 v244, v244, v106
  v_mfma_f32_16x16x32_bf16 v[248:251], a[252:255], v[76:79], v[248:251]
  buffer_load_dwordx4 v122, s[24:27], s64 offen offset:2048 lds
  v_mul_f32 v245, v245, v106
  v_mfma_f32_16x16x32_bf16 v[96:99], a[192:195], a[48:51], v[92:95]
  v_exp_f32 v44, v44
  v_mul_f32 v246, v246, v106
  v_mul_f32 v247, v247, v106
  v_mfma_f32_16x16x32_bf16 v[96:99], a[196:199], a[52:55], v[96:99]
  v_cvt_pk_bf16_f32 v69, v42, v43
  v_cvt_pk_bf16_f32 v228, v228, v229
  v_mfma_f32_16x16x32_bf16 v[96:99], a[200:203], a[56:59], v[96:99]
  v_exp_f32 v45, v45
  v_cvt_pk_bf16_f32 v229, v230, v231
  v_cvt_pk_bf16_f32 v230, v244, v245
  v_mfma_f32_16x16x32_bf16 v[96:99], a[204:207], a[60:63], v[96:99]
  buffer_load_dwordx4 v123, s[24:27], s64 offen offset:3072 lds
  v_cvt_pk_bf16_f32 v231, v246, v247
  v_mfma_f32_16x16x32_bf16 v[100:103], a[208:211], a[48:51], v[92:95]
  s_add_u32 s62, s62, 32768
  buffer_store_dwordx4 v[228:231], v28, s[8:11], s66 offen offset:3072 sc1
  v_exp_f32 v46, v46
  v_mfma_f32_16x16x32_bf16 v[100:103], a[212:215], a[52:55], v[100:103]
  v_cvt_pk_bf16_f32 v70, v44, v45
  v_mfma_f32_16x16x32_bf16 v[100:103], a[216:219], a[56:59], v[100:103]
  v_exp_f32 v47, v47
  v_mfma_f32_16x16x32_bf16 v[100:103], a[220:223], a[60:63], v[100:103]
  v_mfma_f32_16x16x32_bf16 v[56:59], v[124:127], v[64:67], v[56:59]
  s_and_b32 s62, s62, 0xf8000
  v_cvt_pk_bf16_f32 v71, v46, v47
  v_mfma_f32_16x16x32_bf16 v[136:139], a[128:131], v[64:67], v[136:139]
  v_mfma_f32_16x16x32_bf16 v[152:155], a[132:135], v[64:67], v[152:155]
  v_exp_f32 v96, v96
  v_mfma_f32_16x16x32_bf16 v[168:171], a[136:139], v[64:67], v[168:171]
  s_or_b32 s64, s62, s63
  v_exp_f32 v97, v97
  v_mfma_f32_16x16x32_bf16 v[184:187], a[140:143], v[64:67], v[184:187]
  v_cmp_nle_f32 s[38:39], v56, v31
  v_rcp_f32 v108, v56
  v_mfma_f32_16x16x32_bf16 v[200:203], a[144:147], v[64:67], v[200:203]
  s_or_b64 s[40:41], s[40:41], s[38:39]
  v_exp_f32 v98, v98
  v_mfma_f32_16x16x32_bf16 v[216:219], a[148:151], v[64:67], v[216:219]
  v_cvt_pk_bf16_f32 v72, v96, v97
  v_mfma_f32_16x16x32_bf16 v[232:235], a[152:155], v[64:67], v[232:235]
  s_add_u32 m0, s51, 36864
  v_exp_f32 v99, v99
  v_mfma_f32_16x16x32_bf16 v[248:251], a[156:159], v[64:67], v[248:251]
  v_mfma_f32_16x16x32_bf16 v[32:35], a[64:67], a[48:51], v[92:95]
  v_exp_f32 v100, v100
  v_mfma_f32_16x16x32_bf16 v[32:35], a[68:71], a[52:55], v[32:35]
  v_cvt_pk_bf16_f32 v73, v98, v99
  v_mfma_f32_16x16x32_bf16 v[32:35], a[72:75], a[56:59], v[32:35]
  v_exp_f32 v101, v101
  v_mul_f32 v136, v136, v108
  v_mul_f32 v137, v137, v108
  v_mfma_f32_16x16x32_bf16 v[32:35], a[76:79], a[60:63], v[32:35]
  buffer_load_dwordx4 v120, s[24:27], s64 offen lds
  v_mul_f32 v138, v138, v108
  v_mul_f32 v139, v139, v108
  v_mfma_f32_16x16x32_bf16 v[36:39], a[80:83], a[48:51], v[92:95]
  v_exp_f32 v102, v102
  v_mul_f32 v152, v152, v108
  v_mfma_f32_16x16x32_bf16 v[36:39], a[84:87], a[52:55], v[36:39]
  v_cvt_pk_bf16_f32 v74, v100, v101
  v_mul_f32 v153, v153, v108
  v_mul_f32 v154, v154, v108
  v_mfma_f32_16x16x32_bf16 v[36:39], a[88:91], a[56:59], v[36:39]
  v_exp_f32 v103, v103
  v_mul_f32 v155, v155, v108
  v_cvt_pk_bf16_f32 v136, v136, v137
  v_mfma_f32_16x16x32_bf16 v[36:39], a[92:95], a[60:63], v[36:39]
  buffer_load_dwordx4 v121, s[24:27], s64 offen offset:1024 lds
  v_cvt_pk_bf16_f32 v137, v138, v139
  v_mfma_f32_16x16x32_bf16 v[60:63], v[124:127], v[68:71], v[60:63]
  v_cvt_pk_bf16_f32 v75, v102, v103
  v_cvt_pk_bf16_f32 v138, v152, v153
  v_cvt_pk_bf16_f32 v139, v154, v155
  v_mfma_f32_16x16x32_bf16 v[140:143], a[160:163], v[68:71], v[140:143]
  s_add_u32 s66, s65, 8192
  buffer_load_dwordx4 v122, s[24:27], s64 offen offset:2048 lds
  v_mfma_f32_16x16x32_bf16 v[156:159], a[164:167], v[68:71], v[156:159]
  buffer_store_dwordx4 v[136:139], v28, s[8:11], s66 offen sc1
  v_exp_f32 v32, v32
  v_mul_f32 v168, v168, v108
  v_mfma_f32_16x16x32_bf16 v[172:175], a[168:171], v[68:71], v[172:175]
  v_exp_f32 v33, v33
  v_mul_f32 v169, v169, v108
  v_mul_f32 v170, v170, v108
  v_mfma_f32_16x16x32_bf16 v[188:191], a[172:175], v[68:71], v[188:191]
  buffer_load_dwordx4 v123, s[24:27], s64 offen offset:3072 lds
  v_mul_f32 v171, v171, v108
  v_mfma_f32_16x16x32_bf16 v[204:207], a[176:179], v[68:71], v[204:207]
  v_exp_f32 v34, v34
  v_mul_f32 v184, v184, v108
  v_mul_f32 v185, v185, v108
  v_mfma_f32_16x16x32_bf16 v[220:223], a[180:183], v[68:71], v[220:223]
  s_add_u32 s62, s62, 32768
  v_cvt_pk_bf16_f32 v76, v32, v33
  v_mul_f32 v186, v186, v108
  v_mfma_f32_16x16x32_bf16 v[236:239], a[184:187], v[68:71], v[236:239]
  v_exp_f32 v35, v35
  v_mul_f32 v187, v187, v108
  v_cvt_pk_bf16_f32 v168, v168, v169
  v_mfma_f32_16x16x32_bf16 v[252:255], a[188:191], v[68:71], v[252:255]
  v_cvt_pk_bf16_f32 v169, v170, v171
  v_cvt_pk_bf16_f32 v170, v184, v185
  v_mfma_f32_16x16x32_bf16 v[60:63], v[124:127], v[72:75], v[60:63]
  v_exp_f32 v36, v36
  v_cvt_pk_bf16_f32 v171, v186, v187
  v_mfma_f32_16x16x32_bf16 v[140:143], a[224:227], v[72:75], v[140:143]
  s_and_b32 s62, s62, 0xf8000
  buffer_store_dwordx4 v[168:171], v28, s[8:11], s66 offen offset:1024 sc1
  v_cvt_pk_bf16_f32 v77, v34, v35
  v_mul_f32 v200, v200, v108
  v_mfma_f32_16x16x32_bf16 v[156:159], a[228:231], v[72:75], v[156:159]
  v_exp_f32 v37, v37
  v_mul_f32 v201, v201, v108
  v_mfma_f32_16x16x32_bf16 v[172:175], a[232:235], v[72:75], v[172:175]
  v_mul_f32 v202, v202, v108
  v_mul_f32 v203, v203, v108
  v_mfma_f32_16x16x32_bf16 v[188:191], a[236:239], v[72:75], v[188:191]
  s_or_b32 s64, s62, s63
  v_exp_f32 v38, v38
  v_mul_f32 v216, v216, v108
  v_mul_f32 v217, v217, v108
  v_mfma_f32_16x16x32_bf16 v[204:207], a[240:243], v[72:75], v[204:207]
  v_cvt_pk_bf16_f32 v78, v36, v37
  v_mul_f32 v218, v218, v108
  v_mfma_f32_16x16x32_bf16 v[220:223], a[244:247], v[72:75], v[220:223]
  v_exp_f32 v39, v39
  v_mul_f32 v219, v219, v108
  v_cvt_pk_bf16_f32 v200, v200, v201
  v_mfma_f32_16x16x32_bf16 v[236:239], a[248:251], v[72:75], v[236:239]
  v_cvt_pk_bf16_f32 v201, v202, v203
  v_mfma_f32_16x16x32_bf16 v[252:255], a[252:255], v[72:75], v[252:255]
  v_cvt_pk_bf16_f32 v79, v38, v39
  v_cvt_pk_bf16_f32 v202, v216, v217
  v_cvt_pk_bf16_f32 v203, v218, v219
  v_mfma_f32_16x16x32_bf16 v[60:63], v[124:127], v[76:79], v[60:63]
  buffer_store_dwordx4 v[200:203], v28, s[8:11], s66 offen offset:2048 sc1
  v_mul_f32 v232, v232, v108
  v_mfma_f32_16x16x32_bf16 v[140:143], a[128:131], v[76:79], v[140:143]
  v_mul_f32 v233, v233, v108
  v_mfma_f32_16x16x32_bf16 v[156:159], a[132:135], v[76:79], v[156:159]
  v_mul_f32 v234, v234, v108
  v_mul_f32 v235, v235, v108
  v_mfma_f32_16x16x32_bf16 v[172:175], a[136:139], v[76:79], v[172:175]
  v_mul_f32 v248, v248, v108
  v_mfma_f32_16x16x32_bf16 v[188:191], a[140:143], v[76:79], v[188:191]
  v_mul_f32 v249, v249, v108
  v_mul_f32 v250, v250, v108
  v_cmp_nle_f32 s[38:39], v60, v31
  v_mfma_f32_16x16x32_bf16 v[204:207], a[144:147], v[76:79], v[204:207]
  v_mul_f32 v251, v251, v108
  v_cvt_pk_bf16_f32 v232, v232, v233
  v_rcp_f32 v110, v60
  v_mfma_f32_16x16x32_bf16 v[220:223], a[148:151], v[76:79], v[220:223]
  v_cvt_pk_bf16_f32 v233, v234, v235
  v_mov_b32 v111, v110
  v_mfma_f32_16x16x32_bf16 v[236:239], a[152:155], v[76:79], v[236:239]
  s_or_b64 s[40:41], s[40:41], s[38:39]
  v_cvt_pk_bf16_f32 v234, v248, v249
  v_cvt_pk_bf16_f32 v235, v250, v251
  v_mfma_f32_16x16x32_bf16 v[252:255], a[156:159], v[76:79], v[252:255]
  buffer_store_dwordx4 v[232:235], v28, s[8:11], s66 offen offset:3072 sc1
  v_pk_mul_f32 v[140:141], v[140:141], v[110:111]
  v_pk_mul_f32 v[142:143], v[142:143], v[110:111]
  v_pk_mul_f32 v[156:157], v[156:157], v[110:111]
  v_pk_mul_f32 v[158:159], v[158:159], v[110:111]
  v_cvt_pk_bf16_f32 v140, v140, v141
  v_cvt_pk_bf16_f32 v141, v142, v143
  v_cvt_pk_bf16_f32 v142, v156, v157
  v_cvt_pk_bf16_f32 v143, v158, v159
  s_add_u32 s66, s65, 12288
  buffer_store_dwordx4 v[140:143], v28, s[8:11], s66 offen sc1
  v_pk_mul_f32 v[172:173], v[172:173], v[110:111]
  v_pk_mul_f32 v[174:175], v[174:175], v[110:111]
  v_pk_mul_f32 v[188:189], v[188:189], v[110:111]
  v_pk_mul_f32 v[190:191], v[190:191], v[110:111]
  v_cvt_pk_bf16_f32 v172, v172, v173
  v_cvt_pk_bf16_f32 v173, v174, v175
  v_cvt_pk_bf16_f32 v174, v188, v189
  v_cvt_pk_bf16_f32 v175, v190, v191
  buffer_store_dwordx4 v[172:175], v28, s[8:11], s66 offen offset:1024 sc1
  v_pk_mul_f32 v[204:205], v[204:205], v[110:111]
  v_pk_mul_f32 v[206:207], v[206:207], v[110:111]
  v_pk_mul_f32 v[220:221], v[220:221], v[110:111]
  v_pk_mul_f32 v[222:223], v[222:223], v[110:111]
  v_cvt_pk_bf16_f32 v204, v204, v205
  v_cvt_pk_bf16_f32 v205, v206, v207
  v_cvt_pk_bf16_f32 v206, v220, v221
  v_cvt_pk_bf16_f32 v207, v222, v223
  buffer_store_dwordx4 v[204:207], v28, s[8:11], s66 offen offset:2048 sc1
  v_pk_mul_f32 v[236:237], v[236:237], v[110:111]
  v_pk_mul_f32 v[238:239], v[238:239], v[110:111]
  v_pk_mul_f32 v[252:253], v[252:253], v[110:111]
  v_pk_mul_f32 v[254:255], v[254:255], v[110:111]
  v_cvt_pk_bf16_f32 v236, v236, v237
  v_cvt_pk_bf16_f32 v237, v238, v239
  v_cvt_pk_bf16_f32 v238, v252, v253
  v_cvt_pk_bf16_f32 v239, v254, v255
  buffer_store_dwordx4 v[236:239], v28, s[8:11], s66 offen offset:3072 sc1
  s_cmp_lg_u64 s[40:41], 0
  s_cbranch_scc1 L_slow15
L_sback16:
  s_lshr_b32 s19, s44, 1
  s_lshl_b32 s3, s19, 2
  v_lshl_add_u32 v16, v2, 2, v29
  v_bfe_u32 v17, v16, 1, 2
  v_lshlrev_b32 v17, 1, v17
  v_xor_b32 v17, v17, v30
  v_xor_b32 v17, s3, v17
  v_lshlrev_b32 v18, 7, v16
  v_add_u32 v18, s51, v18
  v_lshl_add_u32 v96, v17, 4, v18
  v_xor_b32 v17, 4, v17
  v_lshl_add_u32 v97, v17, 4, v18
  v_add_u32 v98, 0x10000, v96
  v_add_u32 v100, 0x20000, v96
  v_add_u32 v99, 0x10000, v97
  v_add_u32 v101, 0x20000, v97
  s_waitcnt vmcnt(37)
  ds_read_b64_tr_b16 a[0:1], v98 offset:0
  ds_read_b64_tr_b16 a[2:3], v98 offset:2048
  ds_read_b64_tr_b16 a[4:5], v98 offset:8
  ds_read_b64_tr_b16 a[6:7], v98 offset:2056
  ds_read_b64_tr_b16 a[8:9], v99 offset:0
  ds_read_b64_tr_b16 a[10:11], v99 offset:2048
  ds_read_b64_tr_b16 a[12:13], v99 offset:8
  ds_read_b64_tr_b16 a[14:15], v99 offset:2056
  ds_read_b64_tr_b16 a[16:17], v98 offset:4096
  ds_read_b64_tr_b16 a[18:19], v98 offset:6144
  ds_read_b64_tr_b16 a[20:21], v98 offset:4104
  ds_read_b64_tr_b16 a[22:23], v98 offset:6152
  ds_read_b64_tr_b16 a[24:25], v99 offset:4096
  ds_read_b64_tr_b16 a[26:27], v99 offset:6144
  ds_read_b64_tr_b16 a[28:29], v99 offset:4104
  ds_read_b64_tr_b16 a[30:31], v99 offset:6152
  ds_read_b64_tr_b16 a[32:33], v98 offset:32768
  ds_read_b64_tr_b16 a[34:35], v98 offset:34816
  ds_read_b64_tr_b16 a[36:37], v98 offset:32776
  ds_read_b64_tr_b16 a[38:39], v98 offset:34824
  ds_read_b64_tr_b16 a[40:41], v99 offset:32768
  ds_read_b64_tr_b16 a[42:43], v99 offset:34816
  ds_read_b64_tr_b16 a[44:45], v99 offset:32776
  ds_read_b64_tr_b16 a[46:47], v99 offset:34824
  ds_read_b64_tr_b16 a[48:49], v98 offset:36864
  ds_read_b64_tr_b16 a[50:51], v98 offset:38912
  ds_read_b64_tr_b16 a[52:53], v98 offset:36872
  ds_read_b64_tr_b16 a[54:55], v98 offset:38920
  ds_read_b64_tr_b16 a[56:57], v99 offset:36864
  ds_read_b64_tr_b16 a[58:59], v99 offset:38912
  ds_read_b64_tr_b16 a[60:61], v99 offset:36872
  ds_read_b64_tr_b16 a[62:63], v99 offset:38920
  ds_read_b64_tr_b16 a[64:65], v100 offset:0
  ds_read_b64_tr_b16 a[66:67], v100 offset:2048
  ds_read_b64_tr_b16 a[68:69], v100 offset:8
  ds_read_b64_tr_b16 a[70:71], v100 offset:2056
  ds_read_b64_tr_b16 a[72:73], v101 offset:0
  ds_read_b64_tr_b16 a[74:75], v101 offset:2048
  ds_read_b64_tr_b16 a[76:77], v101 offset:8
  ds_read_b64_tr_b16 a[78:79], v101 offset:2056
  s_lshr_b32 s16, s47, 1
  s_lshl_b32 s17, s48, 1
  s_add_u32 s16, s16, s17
  s_and_b32 s17, s47, 1
  s_lshl_b32 s17, s17, 1
  s_lshl_b32 s18, s16, 2
  s_add_u32 s18, s18, s17
  s_lshl_b32 s18, s18, 4
  s_and_b32 s20, s67, 0xffff
  s_sub_u32 s20, 0xffff, s20
  s_and_b32 s21, s68, 0xffff
  s_sub_u32 s21, 0xffff, s21
  s_sub_u32 s20, s20, s18
  s_sub_u32 s21, s21, s18
  s_lshl_b32 s66, s18, 4
  s_add_u32 s66, s66, 0x8000
  s_and_b32 s17, s63, 0x3ff
  s_lshl_b32 s16, s19, 6
  s_add_u32 s17, s17, s16
  s_lshl_b32 s18, s18, 10
  s_add_u32 s18, s18, s17
  s_lshl_b32 s17, s17, 2
  s_add_u32 s69, s17, 0x24000
  s_add_u32 s17, s17, 0x20000
  s_add_u32 s22, s17, 4096
  s_add_u32 s23, s17, 8192
  s_min_u32 s38, s20, s21
  s_cmp_lt_u32 s38, 32
  s_cselect_b32 s69, s69, 0x40000000
  v_lshlrev_b32 v24, 10, v3
  v_lshl_add_u32 v24, v2, 4, v24
  v_add_u32 v24, s18, v24
  v_add_u32 v25, 16384, v24
  v_lshlrev_b32 v6, 4, v3
  v_lshrrev_b32 v13, 1, v1
  v_min_u32 v13, 1, v13
  v_lshlrev_b32 v13, 12, v13
  v_and_b32 v27, 1, v1
  v_lshl_add_u32 v13, v27, 7, v13
  buffer_load_dword v12, v13, s[8:11], s69 offen sc1
  buffer_load_dword v128, v6, s[8:11], s66 offen sc1
  buffer_load_dword v129, v6, s[8:11], s66 offen offset:256 sc1
  buffer_load_dwordx4 v[136:139], v24, s[4:7], 0 offen
  buffer_load_dwordx4 v[140:143], v25, s[4:7], 0 offen
  s_waitcnt lgkmcnt(0)
  s_waitcnt vmcnt(12)
  ds_read_b64_tr_b16 a[80:81], v100 offset:4096
  ds_read_b64_tr_b16 a[82:83], v100 offset:6144
  ds_read_b64_tr_b16 a[84:85], v100 offset:4104
  ds_read_b64_tr_b16 a[86:87], v100 offset:6152
  ds_read_b64_tr_b16 a[88:89], v101 offset:4096
  ds_read_b64_tr_b16 a[90:91], v101 offset:6144
  ds_read_b64_tr_b16 a[92:93], v101 offset:4104
  ds_read_b64_tr_b16 a[94:95], v101 offset:6152
  ds_read_b64_tr_b16 a[96:97], v96 offset:0
  ds_read_b64_tr_b16 a[98:99], v96 offset:2048
  ds_read_b64_tr_b16 a[100:101], v96 offset:8
  ds_read_b64_tr_b16 a[102:103], v96 offset:2056
  ds_read_b64_tr_b16 a[104:105], v97 offset:0
  ds_read_b64_tr_b16 a[106:107], v97 offset:2048
  ds_read_b64_tr_b16 a[108:109], v97 offset:8
  ds_read_b64_tr_b16 a[110:111], v97 offset:2056
  ds_read_b64_tr_b16 a[112:113], v96 offset:4096
  ds_read_b64_tr_b16 a[114:115], v96 offset:6144
  ds_read_b64_tr_b16 a[116:117], v96 offset:4104
  ds_read_b64_tr_b16 a[118:119], v96 offset:6152
  ds_read_b64_tr_b16 a[120:121], v97 offset:4096
  ds_read_b64_tr_b16 a[122:123], v97 offset:6144
  ds_read_b64_tr_b16 a[124:125], v97 offset:4104
  ds_read_b64_tr_b16 a[126:127], v97 offset:6152
  ds_read_b64_tr_b16 a[128:129], v96 offset:32768
  ds_read_b64_tr_b16 a[130:131], v96 offset:34816
  ds_read_b64_tr_b16 a[132:133], v96 offset:32776
  ds_read_b64_tr_b16 a[134:135], v96 offset:34824
  ds_read_b64_tr_b16 a[136:137], v97 offset:32768
  ds_read_b64_tr_b16 a[138:139], v97 offset:34816
  ds_read_b64_tr_b16 a[140:141], v97 offset:32776
  ds_read_b64_tr_b16 a[142:143], v97 offset:34824
  ds_read_b64_tr_b16 a[144:145], v96 offset:36864
  ds_read_b64_tr_b16 a[146:147], v96 offset:38912
  ds_read_b64_tr_b16 a[148:149], v96 offset:36872
  ds_read_b64_tr_b16 a[150:151], v96 offset:38920
  ds_read_b64_tr_b16 a[152:153], v97 offset:36864
  ds_read_b64_tr_b16 a[154:155], v97 offset:38912
  ds_read_b64_tr_b16 a[156:157], v97 offset:36872
  ds_read_b64_tr_b16 a[158:159], v97 offset:38920
  s_lshl_b32 s3, s19, 14
  v_add_u32 v7, s3, v28
  v_add_u32 v8, 0x10000, v7
  v_add_u32 v9, 0x20000, v7
  v_add_u32 v10, 2048, v28
  s_add_u32 s3, s51, 135168
  v_add_u32 v4, s3, v28
  v_xor_b32 v5, 0x4000, v4
  v_and_b32 v21, 7, v1
  v_lshlrev_b32 v21, 7, v21
  s_lshl_b32 s3, s46, 12
  s_lshl_b32 s59, s45, 7
  s_add_u32 s3, s3, s59
  s_add_u32 s3, s3, 0x10000
  s_cmp_eq_u32 s44, 0
  s_cselect_b32 s3, s3, 0x40000000
  v_mov_b32 v23, s43
  v_mov_b32 v20, 0
  s_waitcnt vmcnt(5) lgkmcnt(0)
  s_barrier
  buffer_store_dword v23, v20, s[8:11], s3 offen sc1
  s_lshr_b32 s52, s48, 1
  s_lshl_b32 s52, s52, 12
  s_lshl_b32 s59, s47, 10
  s_add_u32 s52, s52, s59
  s_add_u32 s52, s52, 0x10000
  s_add_u32 m0, s51, 65536
  s_nop 0
  buffer_load_dwordx4 v120, s[24:27], s64 offen lds
  v_mov_b32 v176, 0
  v_mov_b32 v177, 0
  v_mov_b32 v178, 0
  v_mov_b32 v179, 0
  v_mov_b32 v180, 0
  v_mov_b32 v181, 0
  v_mov_b32 v182, 0
  v_mov_b32 v183, 0
  buffer_load_dwordx4 v121, s[24:27], s64 offen offset:1024 lds
  v_mov_b32 v184, 0
  v_mov_b32 v185, 0
  v_mov_b32 v186, 0
  v_mov_b32 v187, 0
  v_mov_b32 v188, 0
  v_mov_b32 v189, 0
  v_mov_b32 v190, 0
  v_mov_b32 v191, 0
  buffer_load_dwordx4 v122, s[24:27], s64 offen offset:2048 lds
  v_mov_b32 v192, 0
  v_mov_b32 v193, 0
  v_mov_b32 v194, 0
  v_mov_b32 v195, 0
  v_mov_b32 v196, 0
  v_mov_b32 v197, 0
  v_mov_b32 v198, 0
  v_mov_b32 v199, 0
  buffer_load_dwordx4 v123, s[24:27], s64 offen offset:3072 lds
  v_mov_b32 v200, 0
  v_mov_b32 v201, 0
  v_mov_b32 v202, 0
  v_mov_b32 v203, 0
  v_mov_b32 v204, 0
  v_mov_b32 v205, 0
  v_mov_b32 v206, 0
  v_mov_b32 v207, 0
  s_add_u32 s62, s62, 32768
  s_and_b32 s62, s62, 0xf8000
  s_or_b32 s64, s62, s63
  s_add_u32 m0, s51, 69632
  s_nop 0
  buffer_load_dwordx4 v120, s[24:27], s64 offen lds
  v_lshrrev_b32 v27, 1, v2
  v_lshlrev_b32 v27, 7, v27
  v_and_b32 v26, 1, v2
  v_lshl_add_u32 v27, v26, 5, v27
  v_mov_b32 v11, 64
  v_mov_b32 v16, s67
  v_ashrrev_i32 v26, 31, v16
  v_not_b32 v26, v26
  buffer_load_dwordx4 v121, s[24:27], s64 offen offset:1024 lds
  v_or_b32 v26, 0x80000000, v26
  v_xor_b32 v16, v16, v26
  v_and_b32 v16, 0xffff0000, v16
  v_mul_f32 v16, 0xbfb8aa3b, v16
  v_exp_f32 v16, v16
  s_nop 0
  v_add_f32 v16, 1.0, v16
  v_rcp_f32 v16, v16
  s_nop 0
  v_cvt_pk_bf16_f32 v16, v16, v16
  buffer_load_dwordx4 v122, s[24:27], s64 offen offset:2048 lds
  v_lshlrev_b32 v16, 16, v16
  v_mov_b32 v17, s68
  v_ashrrev_i32 v26, 31, v17
  v_not_b32 v26, v26
  v_or_b32 v26, 0x80000000, v26
  v_xor_b32 v17, v17, v26
  v_and_b32 v17, 0xffff0000, v17
  v_mul_f32 v17, 0xbfb8aa3b, v17
  buffer_load_dwordx4 v123, s[24:27], s64 offen offset:3072 lds
  v_exp_f32 v17, v17
  s_nop 0
  v_add_f32 v17, 1.0, v17
  v_rcp_f32 v17, v17
  s_nop 0
  v_cvt_pk_bf16_f32 v17, v17, v17
  v_lshlrev_b32 v17, 16, v17
  v_add_u32 v26, 0, v3
  v_mov_b32 v31, 0x40000000
  v_cmp_eq_u32 vcc, s20, v26
  s_add_u32 s62, s62, 32768
  s_and_b32 s62, s62, 0xf8000
  s_or_b32 s64, s62, s63
  s_add_u32 m0, s51, 98304
  s_nop 0
  buffer_load_dwordx4 v120, s[24:27], s64 offen lds
  v_cndmask_b32 v31, v31, 0, vcc
  v_cmp_eq_u32 vcc, s21, v26
  s_nop 1
  v_cndmask_b32 v31, v31, v11, vcc
  s_nop 0
  v_cndmask_b32 v14, v16, v17, vcc
  v_add_u32 v18, v31, v27
  v_add_u32 v26, 16, v3
  v_mov_b32 v31, 0x40000000
  v_cmp_eq_u32 vcc, s20, v26
  buffer_load_dwordx4 v121, s[24:27], s64 offen offset:1024 lds
  s_nop 0
  v_cndmask_b32 v31, v31, 0, vcc
  v_cmp_eq_u32 vcc, s21, v26
  s_nop 1
  v_cndmask_b32 v31, v31, v11, vcc
  s_nop 0
  v_cndmask_b32 v15, v16, v17, vcc
  v_add_u32 v19, v31, v27
  s_waitcnt vmcnt(11)
  v_and_b32 v130, 0xffff0000, v128
  v_rcp_f32 v130, v130
  buffer_load_dwordx4 v122, s[24:27], s64 offen offset:2048 lds
  v_lshlrev_b32 v128, 16, v128
  v_and_b32 v131, 0xffff0000, v129
  v_rcp_f32 v131, v131
  v_lshlrev_b32 v129, 16, v129
  v_lshlrev_b32 v160, 16, v136
  v_and_b32 v161, 0xffff0000, v136
  v_sub_f32 v144, v160, v128
  v_sub_f32 v145, v161, v128
  buffer_load_dwordx4 v123, s[24:27], s64 offen offset:3072 lds
  v_cvt_pk_bf16_f32 v29, v144, v145
  v_lshlrev_b32 v144, 16, v29
  v_and_b32 v145, 0xffff0000, v29
  v_mul_f32 v144, v144, v130
  v_mul_f32 v145, v145, v130
  v_cvt_pk_bf16_f32 v29, v144, v145
  v_lshlrev_b32 v144, 16, v29
  v_and_b32 v145, 0xffff0000, v29
  s_add_u32 s62, s62, 32768
  s_and_b32 s62, s62, 0xf8000
  s_or_b32 s64, s62, s63
  s_add_u32 m0, s51, 102400
  s_nop 0
  buffer_load_dwordx4 v120, s[24:27], s64 offen lds
  v_lshlrev_b32 v162, 16, v137
  v_and_b32 v163, 0xffff0000, v137
  v_sub_f32 v146, v162, v128
  v_sub_f32 v147, v163, v128
  v_cvt_pk_bf16_f32 v29, v146, v147
  v_lshlrev_b32 v146, 16, v29
  v_and_b32 v147, 0xffff0000, v29
  v_mul_f32 v146, v146, v130
  buffer_load_dwordx4 v121, s[24:27], s64 offen offset:1024 lds
  v_mul_f32 v147, v147, v130
  v_cvt_pk_bf16_f32 v29, v146, v147
  v_lshlrev_b32 v146, 16, v29
  v_and_b32 v147, 0xffff0000, v29
  v_lshlrev_b32 v164, 16, v138
  v_and_b32 v165, 0xffff0000, v138
  v_sub_f32 v148, v164, v128
  v_sub_f32 v149, v165, v128
  buffer_load_dwordx4 v122, s[24:27], s64 offen offset:2048 lds
  v_cvt_pk_bf16_f32 v29, v148, v149
  v_lshlrev_b32 v148, 16, v29
  v_and_b32 v149, 0xffff0000, v29
  v_mul_f32 v148, v148, v130
  v_mul_f32 v149, v149, v130
  v_cvt_pk_bf16_f32 v29, v148, v149
  v_lshlrev_b32 v148, 16, v29
  v_and_b32 v149, 0xffff0000, v29
  buffer_load_dwordx4 v123, s[24:27], s64 offen offset:3072 lds
  v_lshlrev_b32 v166, 16, v139
  v_and_b32 v167, 0xffff0000, v139
  v_sub_f32 v150, v166, v128
  v_sub_f32 v151, v167, v128
  v_cvt_pk_bf16_f32 v29, v150, v151
  v_lshlrev_b32 v150, 16, v29
  v_and_b32 v151, 0xffff0000, v29
  v_mul_f32 v150, v150, v130
  s_add_u32 s62, s62, 32768
  s_and_b32 s62, s62, 0xf8000
  s_or_b32 s64, s62, s63
  buffer_load_dword v22, v21, s[8:11], s52 offen sc1
  v_mul_f32 v151, v151, v130
  v_cvt_pk_bf16_f32 v29, v150, v151
  v_lshlrev_b32 v150, 16, v29
  v_and_b32 v151, 0xffff0000, v29
  v_lshlrev_b32 v168, 16, v140
  v_and_b32 v169, 0xffff0000, v140
  v_sub_f32 v152, v168, v129
  v_sub_f32 v153, v169, v129
  s_add_u32 m0, s51, 131072
  s_nop 0
  buffer_load_dwordx4 v120, s[24:27], s64 offen lds
  v_cvt_pk_bf16_f32 v29, v152, v153
  v_lshlrev_b32 v152, 16, v29
  v_and_b32 v153, 0xffff0000, v29
  v_mul_f32 v152, v152, v131
  v_mul_f32 v153, v153, v131
  v_cvt_pk_bf16_f32 v29, v152, v153
  v_lshlrev_b32 v152, 16, v29
  v_and_b32 v153, 0xffff0000, v29
  buffer_load_dwordx4 v121, s[24:27], s64 offen offset:1024 lds
  v_lshlrev_b32 v170, 16, v141
  v_and_b32 v171, 0xffff0000, v141
  v_sub_f32 v154, v170, v129
  v_sub_f32 v155, v171, v129
  v_cvt_pk_bf16_f32 v29, v154, v155
  v_lshlrev_b32 v154, 16, v29
  v_and_b32 v155, 0xffff0000, v29
  v_mul_f32 v154, v154, v131
  buffer_load_dwordx4 v122, s[24:27], s64 offen offset:2048 lds
  v_mul_f32 v155, v155, v131
  v_cvt_pk_bf16_f32 v29, v154, v155
  v_lshlrev_b32 v154, 16, v29
  v_and_b32 v155, 0xffff0000, v29
  v_lshlrev_b32 v172, 16, v142
  v_and_b32 v173, 0xffff0000, v142
  v_sub_f32 v156, v172, v129
  v_sub_f32 v157, v173, v129
  buffer_load_dwordx4 v123, s[24:27], s64 offen offset:3072 lds
  v_cvt_pk_bf16_f32 v29, v156, v157
  v_lshlrev_b32 v156, 16, v29
  v_and_b32 v157, 0xffff0000, v29
  v_mul_f32 v156, v156, v131
  v_mul_f32 v157, v157, v131
  v_cvt_pk_bf16_f32 v29, v156, v157
  v_lshlrev_b32 v156, 16, v29
  v_and_b32 v157, 0xffff0000, v29
  s_add_u32 s62, s62, 32768
  s_and_b32 s62, s62, 0xf8000
  s_or_b32 s64, s62, s63
  s_add_u32 m0, s51, 135168
  s_nop 0
  buffer_load_dwordx4 v120, s[24:27], s64 offen lds
  v_lshlrev_b32 v174, 16, v143
  v_and_b32 v175, 0xffff0000, v143
  v_sub_f32 v158, v174, v129
  v_sub_f32 v159, v175, v129
  v_cvt_pk_bf16_f32 v29, v158, v159
  v_lshlrev_b32 v158, 16, v29
  v_and_b32 v159, 0xffff0000, v29
  v_mul_f32 v158, v158, v131
  buffer_load_dwordx4 v121, s[24:27], s64 offen offset:1024 lds
  v_mul_f32 v159, v159, v131
  v_cvt_pk_bf16_f32 v29, v158, v159
  v_lshlrev_b32 v158, 16, v29
  v_and_b32 v159, 0xffff0000, v29
  buffer_load_dwordx4 v122, s[24:27], s64 offen offset:2048 lds
  buffer_load_dwordx4 v123, s[24:27], s64 offen offset:3072 lds
  s_add_u32 s62, s62, 32768
  s_and_b32 s62, s62, 0xf8000
  s_or_b32 s64, s62, s63
  s_lshl_b32 s59, s49, 1
  s_add_u32 s59, s59, s48
  s_mul_i32 s59, s59, 1
  s_and_b32 s59, s59, 7
  s_lshl_b32 s55, s19, 2
  s_add_u32 s55, s55, s59
  s_mul_i32 s54, s48, 66
  s_lshl_b32 s59, s47, 3
  s_add_u32 s54, s54, s59
  s_mul_i32 s54, s54, 17664
  s_and_b32 s59, s44, 1
  s_lshl_b32 s59, s59, 11
  s_add_u32 s54, s54, s59
  s_add_u32 s54, s54, 0x400000
  s_cmp_ge_u32 s38, 32
  s_cbranch_scc1 L_noy19
  s_waitcnt vmcnt(30)
  v_cmp_ne_u32 vcc, s43, v12
  s_nop 0
  s_cbranch_vccnz L_spin20
L_back22:
  buffer_load_dwordx4 v[192:195], v18, s[8:11], s17 offen sc1
  buffer_load_dwordx4 v[196:199], v18, s[8:11], s17 offen offset:16 sc1
  buffer_load_dwordx4 v[200:203], v19, s[8:11], s17 offen sc1
  buffer_load_dwordx4 v[204:207], v19, s[8:11], s17 offen offset:16 sc1
  buffer_load_dwordx4 v[176:179], v18, s[8:11], s22 offen sc1
  buffer_load_dwordx4 v[180:183], v18, s[8:11], s22 offen offset:16 sc1
  buffer_load_dwordx4 v[184:187], v19, s[8:11], s22 offen sc1
  buffer_load_dwordx4 v[188:191], v19, s[8:11], s22 offen offset:16 sc1
L_noy19:
  s_waitcnt vmcnt(8)
  v_cmp_ne_u32 vcc, s43, v22
  s_nop 0
  s_cbranch_vccnz L_spin23
L_back25:
  s_add_u32 s53, s47, 1
  s_and_b32 s53, s53, 3
  s_lshr_b32 s56, s53, 1
  s_mul_i32 s56, s56, 582912
  s_add_u32 s56, s56, s54
  s_and_b32 s53, s53, 1
  s_lshl_b32 s53, s53, 13
  s_add_u32 s56, s56, s53
  s_add_u32 s58, s55, 0
  s_and_b32 s58, s58, 7
  s_mul_i32 s58, s58, 17664
  s_add_u32 s58, s58, s56
  s_add_u32 m0, s51, 0
  s_nop 0
  buffer_load_dwordx4 v28, s[8:11], s58 offen sc1 lds
  buffer_load_dwordx4 v28, s[8:11], s58 offen offset:1024 sc1 lds
  buffer_load_dwordx4 v10, s[8:11], s58 offen offset:2048 sc1 lds
  buffer_load_dwordx4 v10, s[8:11], s58 offen offset:3072 sc1 lds
  s_add_u32 s62, s55, 1
  s_and_b32 s62, s62, 7
  s_mul_i32 s62, s62, 17664
  s_add_u32 s62, s62, s56
  s_add_u32 m0, s51, 4096
  s_nop 0
  buffer_load_dwordx4 v28, s[8:11], s62 offen sc1 lds
  buffer_load_dwordx4 v28, s[8:11], s62 offen offset:1024 sc1 lds
  buffer_load_dwordx4 v10, s[8:11], s62 offen offset:2048 sc1 lds
  buffer_load_dwordx4 v10, s[8:11], s62 offen offset:3072 sc1 lds
  s_add_u32 s58, s55, 2
  s_and_b32 s58, s58, 7
  s_mul_i32 s58, s58, 17664
  s_add_u32 s58, s58, s56
  s_add_u32 m0, s51, 32768
  s_nop 0
  buffer_load_dwordx4 v28, s[8:11], s58 offen sc1 lds
  buffer_load_dwordx4 v28, s[8:11], s58 offen offset:1024 sc1 lds
  buffer_load_dwordx4 v10, s[8:11], s58 offen offset:2048 sc1 lds
  buffer_load_dwordx4 v10, s[8:11], s58 offen offset:3072 sc1 lds
  s_add_u32 s62, s55, 3
  s_and_b32 s62, s62, 7
  s_mul_i32 s62, s62, 17664
  s_add_u32 s62, s62, s56
  s_add_u32 m0, s51, 36864
  s_nop 0
  buffer_load_dwordx4 v28, s[8:11], s62 offen sc1 lds
  buffer_load_dwordx4 v28, s[8:11], s62 offen offset:1024 sc1 lds
  buffer_load_dwordx4 v10, s[8:11], s62 offen offset:2048 sc1 lds
  buffer_load_dwordx4 v10, s[8:11], s62 offen offset:3072 sc1 lds
  s_waitcnt vmcnt(16)
  ds_read_b64_tr_b16 a[160:161], v98 offset:0
  ds_read_b64_tr_b16 a[162:163], v98 offset:2048
  ds_read_b64_tr_b16 a[164:165], v98 offset:8
  ds_read_b64_tr_b16 a[166:167], v98 offset:2056
  ds_read_b64_tr_b16 a[168:169], v99 offset:0
  ds_read_b64_tr_b16 a[170:171], v99 offset:2048
  ds_read_b64_tr_b16 a[172:173], v99 offset:8
  ds_read_b64_tr_b16 a[174:175], v99 offset:2056
  ds_read_b64_tr_b16 a[176:177], v98 offset:4096
  ds_read_b64_tr_b16 a[178:179], v98 offset:6144
  ds_read_b64_tr_b16 a[180:181], v98 offset:4104
  ds_read_b64_tr_b16 a[182:183], v98 offset:6152
  ds_read_b64_tr_b16 a[184:185], v99 offset:4096
  ds_read_b64_tr_b16 a[186:187], v99 offset:6144
  ds_read_b64_tr_b16 a[188:189], v99 offset:4104
  ds_read_b64_tr_b16 a[190:191], v99 offset:6152
  ds_read_b64_tr_b16 a[192:193], v98 offset:32768
  ds_read_b64_tr_b16 a[194:195], v98 offset:34816
  ds_read_b64_tr_b16 a[196:197], v98 offset:32776
  ds_read_b64_tr_b16 a[198:199], v98 offset:34824
  ds_read_b64_tr_b16 a[200:201], v99 offset:32768
  ds_read_b64_tr_b16 a[202:203], v99 offset:34816
  ds_read_b64_tr_b16 a[204:205], v99 offset:32776
  ds_read_b64_tr_b16 a[206:207], v99 offset:34824
  ds_read_b64_tr_b16 a[208:209], v98 offset:36864
  ds_read_b64_tr_b16 a[210:211], v98 offset:38912
  ds_read_b64_tr_b16 a[212:213], v98 offset:36872
  ds_read_b64_tr_b16 a[214:215], v98 offset:38920
  ds_read_b64_tr_b16 a[216:217], v99 offset:36864
  ds_read_b64_tr_b16 a[218:219], v99 offset:38912
  ds_read_b64_tr_b16 a[220:221], v99 offset:36872
  ds_read_b64_tr_b16 a[222:223], v99 offset:38920
  ds_read_b64_tr_b16 a[224:225], v100 offset:0
  ds_read_b64_tr_b16 a[226:227], v100 offset:2048
  ds_read_b64_tr_b16 a[228:229], v100 offset:8
  ds_read_b64_tr_b16 a[230:231], v100 offset:2056
  ds_read_b64_tr_b16 a[232:233], v101 offset:0
  ds_read_b64_tr_b16 a[234:235], v101 offset:2048
  ds_read_b64_tr_b16 a[236:237], v101 offset:8
  ds_read_b64_tr_b16 a[238:239], v101 offset:2056
  ds_read_b64_tr_b16 a[240:241], v100 offset:4096
  ds_read_b64_tr_b16 a[242:243], v100 offset:6144
  ds_read_b64_tr_b16 a[244:245], v100 offset:4104
  ds_read_b64_tr_b16 a[246:247], v100 offset:6152
  ds_read_b64_tr_b16 a[248:249], v101 offset:4096
  ds_read_b64_tr_b16 a[250:251], v101 offset:6144
  ds_read_b64_tr_b16 a[252:253], v101 offset:4104
  ds_read_b64_tr_b16 a[254:255], v101 offset:6152
  s_waitcnt vmcnt(16)
  s_add_u32 s53, s47, 2
  s_and_b32 s53, s53, 3
  s_lshr_b32 s56, s53, 1
  s_mul_i32 s56, s56, 582912
  s_add_u32 s56, s56, s54
  s_and_b32 s53, s53, 1
  s_lshl_b32 s53, s53, 13
  s_add_u32 s56, s56, s53
  s_add_u32 s58, s55, 0
  s_and_b32 s58, s58, 7
  s_mul_i32 s58, s58, 17664
  s_add_u32 s58, s58, s56
  s_waitcnt vmcnt(12) lgkmcnt(0)
  s_barrier
  ds_read_b128 v[216:219], v7 offset:0
  ds_read_b128 v[220:223], v7 offset:2048
  ds_read_b128 v[224:227], v7 offset:1024
  ds_read_b128 v[228:231], v7 offset:3072
  s_waitcnt lgkmcnt(3)
  v_mfma_f32_16x16x32_bf16 v[32:35], a[0:3], v[216:219], 0
  s_add_u32 m0, s51, 65536
  ds_read_b128 v[232:235], v7 offset:8192
  v_mfma_f32_16x16x32_bf16 v[36:39], a[4:7], v[216:219], 0
  s_add_u32 s62, s55, 1
  buffer_load_dwordx4 v28, s[8:11], s58 offen sc1 lds
  v_mfma_f32_16x16x32_bf16 v[48:51], a[8:11], v[216:219], 0
  s_and_b32 s62, s62, 7
  v_mfma_f32_16x16x32_bf16 v[52:55], a[12:15], v[216:219], 0
  s_waitcnt lgkmcnt(3)
  v_mfma_f32_16x16x32_bf16 v[40:43], a[0:3], v[220:223], 0
  s_mul_i32 s62, s62, 17664
  ds_read_b128 v[236:239], v7 offset:10240
  v_mfma_f32_16x16x32_bf16 v[44:47], a[4:7], v[220:223], 0
  s_add_u32 s62, s62, s56
  v_mfma_f32_16x16x32_bf16 v[56:59], a[8:11], v[220:223], 0
  s_lshl_b32 s57, s48, 2
  v_mfma_f32_16x16x32_bf16 v[60:63], a[12:15], v[220:223], 0
  s_waitcnt lgkmcnt(3)
  buffer_load_dwordx4 v28, s[8:11], s58 offen offset:1024 sc1 lds
  v_mfma_f32_16x16x32_bf16 v[32:35], a[16:19], v[224:227], v[32:35]
  s_add_u32 s57, s57, s49
  ds_read_b128 v[240:243], v7 offset:9216
  v_mfma_f32_16x16x32_bf16 v[36:39], a[20:23], v[224:227], v[36:39]
  s_lshl_b32 s57, s57, 2
  v_mfma_f32_16x16x32_bf16 v[48:51], a[24:27], v[224:227], v[48:51]
  s_add_u32 s52, s57, s47
  v_mfma_f32_16x16x32_bf16 v[52:55], a[28:31], v[224:227], v[52:55]
  s_waitcnt lgkmcnt(3)
  v_mfma_f32_16x16x32_bf16 v[40:43], a[16:19], v[228:231], v[40:43]
  s_mul_i32 s65, s52, 13
  ds_read_b128 v[244:247], v7 offset:11264
  v_mfma_f32_16x16x32_bf16 v[44:47], a[20:23], v[228:231], v[44:47]
  s_add_u32 s65, s65, s44
  buffer_load_dwordx4 v10, s[8:11], s58 offen offset:2048 sc1 lds
  v_mfma_f32_16x16x32_bf16 v[56:59], a[24:27], v[228:231], v[56:59]
  s_waitcnt vmcnt(11)
  v_mfma_f32_16x16x32_bf16 v[60:63], a[28:31], v[228:231], v[60:63]
  s_waitcnt lgkmcnt(3)
  v_mfma_f32_16x16x32_bf16 v[32:35], a[32:35], v[232:235], v[32:35]
  s_barrier
  ds_read_b128 v[248:251], v7 offset:4096
  v_mfma_f32_16x16x32_bf16 v[36:39], a[36:39], v[232:235], v[36:39]
  s_mul_i32 s65, s65, 3328
  v_mfma_f32_16x16x32_bf16 v[48:51], a[40:43], v[232:235], v[48:51]
  s_add_u32 s65, s65, 0x1800000
  v_mfma_f32_16x16x32_bf16 v[52:55], a[44:47], v[232:235], v[52:55]
  s_waitcnt lgkmcnt(3)
  buffer_load_dwordx4 v10, s[8:11], s58 offen offset:3072 sc1 lds
  v_mfma_f32_16x16x32_bf16 v[40:43], a[32:35], v[236:239], v[40:43]
  s_add_u32 m0, s51, 69632
  ds_read_b128 v[252:255], v7 offset:6144
  v_mov_b32 v115, s43
  v_mfma_f32_16x16x32_bf16 v[44:47], a[36:39], v[236:239], v[44:47]
  s_add_u32 s58, s55, 2
  v_mov_b32 v119, s43
  v_mov_b32 v122, s43
  v_mfma_f32_16x16x32_bf16 v[56:59], a[40:43], v[236:239], v[56:59]
  s_and_b32 s58, s58, 7
  v_mov_b32 v123, s43
  v_add_f32 v192, v192, v176
  v_mfma_f32_16x16x32_bf16 v[60:63], a[44:47], v[236:239], v[60:63]
  s_waitcnt lgkmcnt(3)
  v_add_f32 v193, v193, v177
  v_add_f32 v194, v194, v178
  v_mfma_f32_16x16x32_bf16 v[32:35], a[48:51], v[240:243], v[32:35]
  s_mul_i32 s58, s58, 17664
  ds_read_b128 v[216:219], v7 offset:5120
  v_add_f32 v195, v195, v179
  v_mfma_f32_16x16x32_bf16 v[36:39], a[52:55], v[240:243], v[36:39]
  s_add_u32 s58, s58, s56
  buffer_load_dwordx4 v28, s[8:11], s62 offen sc1 lds
  v_add_f32 v196, v196, v180
  v_mfma_f32_16x16x32_bf16 v[48:51], a[56:59], v[240:243], v[48:51]
  s_add_u32 s16, s65, 13312
  v_add_f32 v197, v197, v181
  v_add_f32 v198, v198, v182
  v_mfma_f32_16x16x32_bf16 v[52:55], a[60:63], v[240:243], v[52:55]
  s_waitcnt lgkmcnt(3)
  v_add_f32 v199, v199, v183
  v_add_f32 v200, v200, v184
  v_mfma_f32_16x16x32_bf16 v[40:43], a[48:51], v[244:247], v[40:43]
  s_add_u32 s17, s65, 26624
  ds_read_b128 v[220:223], v7 offset:7168
  v_add_f32 v201, v201, v185
  v_mfma_f32_16x16x32_bf16 v[44:47], a[52:55], v[244:247], v[44:47]
  s_mov_b32 s18, 0
  v_add_f32 v202, v202, v186
  v_add_f32 v203, v203, v187
  v_mfma_f32_16x16x32_bf16 v[56:59], a[56:59], v[244:247], v[56:59]
  s_mov_b32 s12, s34
  v_add_f32 v204, v204, v188
  v_add_f32 v205, v205, v189
  v_mfma_f32_16x16x32_bf16 v[60:63], a[60:63], v[244:247], v[60:63]
  s_waitcnt lgkmcnt(3)
  buffer_load_dwordx4 v28, s[8:11], s62 offen offset:1024 sc1 lds
  v_add_f32 v206, v206, v190
  v_mfma_f32_16x16x32_bf16 v[32:35], a[64:67], v[248:251], v[32:35]
  s_mov_b32 s13, s35
  ds_read_b128 v[224:227], v7 offset:12288
  v_add_f32 v207, v207, v191
  v_mfma_f32_16x16x32_bf16 v[36:39], a[68:71], v[248:251], v[36:39]
  s_mov_b32 s14, 0x200000
  v_cvt_pk_bf16_f32 v29, v192, v193
  v_lshlrev_b32 v192, 16, v29
  v_mfma_f32_16x16x32_bf16 v[48:51], a[72:75], v[248:251], v[48:51]
  s_mov_b32 s15, 0x00020000
  v_and_b32 v193, 0xffff0000, v29
  v_mul_f32 v192, v192, v14
  v_mfma_f32_16x16x32_bf16 v[52:55], a[76:79], v[248:251], v[52:55]
  s_waitcnt lgkmcnt(3)
  v_mul_f32 v193, v193, v14
  v_cvt_pk_bf16_f32 v29, v192, v193
  v_mfma_f32_16x16x32_bf16 v[40:43], a[64:67], v[252:255], v[40:43]
  ds_read_b128 v[228:231], v7 offset:14336
  v_lshlrev_b32 v192, 16, v29
  v_mfma_f32_16x16x32_bf16 v[44:47], a[68:71], v[252:255], v[44:47]
  buffer_load_dwordx4 v10, s[8:11], s62 offen offset:2048 sc1 lds
  v_and_b32 v193, 0xffff0000, v29
  v_mfma_f32_16x16x32_bf16 v[56:59], a[72:75], v[252:255], v[56:59]
  v_add_f32 v144, v144, v192
  v_add_f32 v145, v145, v193
  v_mfma_f32_16x16x32_bf16 v[60:63], a[76:79], v[252:255], v[60:63]
  s_waitcnt lgkmcnt(3)
  v_cvt_pk_bf16_f32 v29, v144, v145
  v_lshlrev_b32 v144, 16, v29
  v_mfma_f32_16x16x32_bf16 v[32:35], a[80:83], v[216:219], v[32:35]
  ds_read_b128 v[232:235], v7 offset:13312
  v_and_b32 v145, 0xffff0000, v29
  v_mfma_f32_16x16x32_bf16 v[36:39], a[84:87], v[216:219], v[36:39]
  v_cvt_pk_bf16_f32 v29, v194, v195
  v_lshlrev_b32 v194, 16, v29
  v_mfma_f32_16x16x32_bf16 v[48:51], a[88:91], v[216:219], v[48:51]
  v_and_b32 v195, 0xffff0000, v29
  v_mul_f32 v194, v194, v14
  v_mfma_f32_16x16x32_bf16 v[52:55], a[92:95], v[216:219], v[52:55]
  s_waitcnt lgkmcnt(3)
  buffer_load_dwordx4 v10, s[8:11], s62 offen offset:3072 sc1 lds
  v_mul_f32 v195, v195, v14
  v_mfma_f32_16x16x32_bf16 v[40:43], a[80:83], v[220:223], v[40:43]
  s_add_u32 m0, s51, 98304
  ds_read_b128 v[236:239], v7 offset:15360
  v_cvt_pk_bf16_f32 v29, v194, v195
  v_mfma_f32_16x16x32_bf16 v[44:47], a[84:87], v[220:223], v[44:47]
  s_add_u32 s62, s55, 3
  v_lshlrev_b32 v194, 16, v29
  v_and_b32 v195, 0xffff0000, v29
  v_mfma_f32_16x16x32_bf16 v[56:59], a[88:91], v[220:223], v[56:59]
  s_waitcnt vmcnt(8)
  v_add_f32 v146, v146, v194
  v_add_f32 v147, v147, v195
  v_mfma_f32_16x16x32_bf16 v[60:63], a[92:95], v[220:223], v[60:63]
  s_waitcnt lgkmcnt(3)
  v_cvt_pk_bf16_f32 v29, v146, v147
  v_lshlrev_b32 v146, 16, v29
  v_mfma_f32_16x16x32_bf16 v[32:35], a[96:99], v[224:227], v[32:35]
  s_barrier
  ds_read_b128 v[240:243], v7 offset:32768
  v_and_b32 v147, 0xffff0000, v29
  v_mfma_f32_16x16x32_bf16 v[36:39], a[100:103], v[224:227], v[36:39]
  s_and_b32 s62, s62, 7
  buffer_load_dwordx4 v28, s[8:11], s58 offen sc1 lds
  v_cvt_pk_bf16_f32 v29, v196, v197
  v_mfma_f32_16x16x32_bf16 v[48:51], a[104:107], v[224:227], v[48:51]
  s_mul_i32 s62, s62, 17664
  v_lshlrev_b32 v196, 16, v29
  v_and_b32 v197, 0xffff0000, v29
  v_mfma_f32_16x16x32_bf16 v[52:55], a[108:111], v[224:227], v[52:55]
  s_waitcnt lgkmcnt(3)
  v_mul_f32 v196, v196, v14
  v_mul_f32 v197, v197, v14
  v_mfma_f32_16x16x32_bf16 v[40:43], a[96:99], v[228:231], v[40:43]
  s_add_u32 s62, s62, s56
  ds_read_b128 v[244:247], v7 offset:34816
  v_cvt_pk_bf16_f32 v29, v196, v197
  v_mfma_f32_16x16x32_bf16 v[44:47], a[100:103], v[228:231], v[44:47]
  v_lshlrev_b32 v196, 16, v29
  v_and_b32 v197, 0xffff0000, v29
  v_mfma_f32_16x16x32_bf16 v[56:59], a[104:107], v[228:231], v[56:59]
  v_add_f32 v148, v148, v196
  v_add_f32 v149, v149, v197
  v_mfma_f32_16x16x32_bf16 v[60:63], a[108:111], v[228:231], v[60:63]
  s_waitcnt lgkmcnt(3)
  buffer_load_dwordx4 v28, s[8:11], s58 offen offset:1024 sc1 lds
  v_cvt_pk_bf16_f32 v29, v148, v149
  v_mfma_f32_16x16x32_bf16 v[32:35], a[112:115], v[232:235], v[32:35]
  ds_read_b128 v[248:251], v7 offset:33792
  v_lshlrev_b32 v148, 16, v29
  v_mfma_f32_16x16x32_bf16 v[36:39], a[116:119], v[232:235], v[36:39]
  v_and_b32 v149, 0xffff0000, v29
  v_cvt_pk_bf16_f32 v29, v198, v199
  v_mfma_f32_16x16x32_bf16 v[48:51], a[120:123], v[232:235], v[48:51]
  v_lshlrev_b32 v198, 16, v29
  v_and_b32 v199, 0xffff0000, v29
  v_mfma_f32_16x16x32_bf16 v[52:55], a[124:127], v[232:235], v[52:55]
  s_waitcnt lgkmcnt(3)
  v_mul_f32 v198, v198, v14
  v_mul_f32 v199, v199, v14
  v_mfma_f32_16x16x32_bf16 v[40:43], a[112:115], v[236:239], v[40:43]
  ds_read_b128 v[252:255], v7 offset:35840
  v_cvt_pk_bf16_f32 v29, v198, v199
  v_mfma_f32_16x16x32_bf16 v[44:47], a[116:119], v[236:239], v[44:47]
  buffer_load_dwordx4 v10, s[8:11], s58 offen offset:2048 sc1 lds
  v_lshlrev_b32 v198, 16, v29
  v_mfma_f32_16x16x32_bf16 v[56:59], a[120:123], v[236:239], v[56:59]
  v_and_b32 v199, 0xffff0000, v29
  v_add_f32 v150, v150, v198
  v_mfma_f32_16x16x32_bf16 v[60:63], a[124:127], v[236:239], v[60:63]
  s_waitcnt lgkmcnt(3)
  v_add_f32 v151, v151, v199
  v_cvt_pk_bf16_f32 v29, v150, v151
  v_mfma_f32_16x16x32_bf16 v[32:35], a[128:131], v[240:243], v[32:35]
  ds_read_b128 v[216:219], v7 offset:40960
  v_lshlrev_b32 v150, 16, v29
  v_mfma_f32_16x16x32_bf16 v[36:39], a[132:135], v[240:243], v[36:39]
  v_and_b32 v151, 0xffff0000, v29
  v_cvt_pk_bf16_f32 v29, v200, v201
  v_mfma_f32_16x16x32_bf16 v[48:51], a[136:139], v[240:243], v[48:51]
  v_lshlrev_b32 v200, 16, v29
  v_and_b32 v201, 0xffff0000, v29
  v_mfma_f32_16x16x32_bf16 v[52:55], a[140:143], v[240:243], v[52:55]
  s_waitcnt lgkmcnt(3)
  buffer_load_dwordx4 v10, s[8:11], s58 offen offset:3072 sc1 lds
  v_mul_f32 v200, v200, v15
  v_mfma_f32_16x16x32_bf16 v[40:43], a[128:131], v[244:247], v[40:43]
  s_add_u32 m0, s51, 102400
  ds_read_b128 v[220:223], v7 offset:43008
  v_mul_f32 v201, v201, v15
  v_mfma_f32_16x16x32_bf16 v[44:47], a[132:135], v[244:247], v[44:47]
  s_add_u32 s53, s47, 3
  v_cvt_pk_bf16_f32 v29, v200, v201
  v_lshlrev_b32 v200, 16, v29
  v_mfma_f32_16x16x32_bf16 v[56:59], a[136:139], v[244:247], v[56:59]
  s_and_b32 s53, s53, 3
  v_and_b32 v201, 0xffff0000, v29
  v_add_f32 v152, v152, v200
  v_mfma_f32_16x16x32_bf16 v[60:63], a[140:143], v[244:247], v[60:63]
  s_waitcnt lgkmcnt(3)
  v_add_f32 v153, v153, v201
  v_cvt_pk_bf16_f32 v29, v152, v153
  v_mfma_f32_16x16x32_bf16 v[32:35], a[144:147], v[248:251], v[32:35]
  s_lshr_b32 s56, s53, 1
  ds_read_b128 v[224:227], v7 offset:41984
  v_lshlrev_b32 v152, 16, v29
  v_mfma_f32_16x16x32_bf16 v[36:39], a[148:151], v[248:251], v[36:39]
  s_mul_i32 s56, s56, 582912
  buffer_load_dwordx4 v28, s[8:11], s62 offen sc1 lds
  v_and_b32 v153, 0xffff0000, v29
  v_mfma_f32_16x16x32_bf16 v[48:51], a[152:155], v[248:251], v[48:51]
  s_add_u32 s56, s56, s54
  v_cvt_pk_bf16_f32 v29, v202, v203
  v_lshlrev_b32 v202, 16, v29
  v_mfma_f32_16x16x32_bf16 v[52:55], a[156:159], v[248:251], v[52:55]
  s_waitcnt lgkmcnt(3)
  v_and_b32 v203, 0xffff0000, v29
  v_mul_f32 v202, v202, v15
  v_mfma_f32_16x16x32_bf16 v[40:43], a[144:147], v[252:255], v[40:43]
  s_and_b32 s53, s53, 1
  ds_read_b128 v[228:231], v7 offset:44032
  v_mul_f32 v203, v203, v15
  v_mfma_f32_16x16x32_bf16 v[44:47], a[148:151], v[252:255], v[44:47]
  s_lshl_b32 s53, s53, 13
  v_cvt_pk_bf16_f32 v29, v202, v203
  v_lshlrev_b32 v202, 16, v29
  v_mfma_f32_16x16x32_bf16 v[56:59], a[152:155], v[252:255], v[56:59]
  s_add_u32 s56, s56, s53
  v_and_b32 v203, 0xffff0000, v29
  v_add_f32 v154, v154, v202
  v_mfma_f32_16x16x32_bf16 v[60:63], a[156:159], v[252:255], v[60:63]
  s_waitcnt lgkmcnt(3)
  buffer_load_dwordx4 v28, s[8:11], s62 offen offset:1024 sc1 lds
  v_add_f32 v155, v155, v203
  v_mfma_f32_16x16x32_bf16 v[32:35], a[160:163], v[216:219], v[32:35]
  s_add_u32 s58, s55, 0
  ds_read_b128 v[232:235], v7 offset:36864
  v_cvt_pk_bf16_f32 v29, v154, v155
  v_mfma_f32_16x16x32_bf16 v[36:39], a[164:167], v[216:219], v[36:39]
  s_and_b32 s58, s58, 7
  v_lshlrev_b32 v154, 16, v29
  v_and_b32 v155, 0xffff0000, v29
  v_mfma_f32_16x16x32_bf16 v[48:51], a[168:171], v[216:219], v[48:51]
  s_mul_i32 s58, s58, 17664
  v_cvt_pk_bf16_f32 v29, v204, v205
  v_lshlrev_b32 v204, 16, v29
  v_mfma_f32_16x16x32_bf16 v[52:55], a[172:175], v[216:219], v[52:55]
  s_waitcnt lgkmcnt(3)
  v_and_b32 v205, 0xffff0000, v29
  v_mul_f32 v204, v204, v15
  v_mfma_f32_16x16x32_bf16 v[40:43], a[160:163], v[220:223], v[40:43]
  s_add_u32 s58, s58, s56
  ds_read_b128 v[236:239], v7 offset:38912
  v_mul_f32 v205, v205, v15
  v_mfma_f32_16x16x32_bf16 v[44:47], a[164:167], v[220:223], v[44:47]
  buffer_load_dwordx4 v10, s[8:11], s62 offen offset:2048 sc1 lds
  v_cvt_pk_bf16_f32 v29, v204, v205
  v_mfma_f32_16x16x32_bf16 v[56:59], a[168:171], v[220:223], v[56:59]
  v_lshlrev_b32 v204, 16, v29
  v_and_b32 v205, 0xffff0000, v29
  v_mfma_f32_16x16x32_bf16 v[60:63], a[172:175], v[220:223], v[60:63]
  s_waitcnt lgkmcnt(3)
  v_add_f32 v156, v156, v204
  v_add_f32 v157, v157, v205
  v_mfma_f32_16x16x32_bf16 v[32:35], a[176:179], v[224:227], v[32:35]
  ds_read_b128 v[240:243], v7 offset:37888
  v_cvt_pk_bf16_f32 v29, v156, v157
  v_mfma_f32_16x16x32_bf16 v[36:39], a[180:183], v[224:227], v[36:39]
  v_lshlrev_b32 v156, 16, v29
  v_and_b32 v157, 0xffff0000, v29
  v_mfma_f32_16x16x32_bf16 v[48:51], a[184:187], v[224:227], v[48:51]
  v_cvt_pk_bf16_f32 v29, v206, v207
  v_lshlrev_b32 v206, 16, v29
  v_mfma_f32_16x16x32_bf16 v[52:55], a[188:191], v[224:227], v[52:55]
  s_waitcnt lgkmcnt(3)
  buffer_load_dwordx4 v10, s[8:11], s62 offen offset:3072 sc1 lds
  v_and_b32 v207, 0xffff0000, v29
  v_mfma_f32_16x16x32_bf16 v[40:43], a[176:179], v[228:231], v[40:43]
  s_add_u32 m0, s51, 131072
  ds_read_b128 v[244:247], v7 offset:39936
  v_mul_f32 v206, v206, v15
  v_mfma_f32_16x16x32_bf16 v[44:47], a[180:183], v[228:231], v[44:47]
  s_add_u32 s62, s55, 1
  v_mul_f32 v207, v207, v15
  v_cvt_pk_bf16_f32 v29, v206, v207
  v_mfma_f32_16x16x32_bf16 v[56:59], a[184:187], v[228:231], v[56:59]
  s_and_b32 s62, s62, 7
  v_lshlrev_b32 v206, 16, v29
  v_and_b32 v207, 0xffff0000, v29
  v_mfma_f32_16x16x32_bf16 v[60:63], a[188:191], v[228:231], v[60:63]
  s_waitcnt lgkmcnt(3)
  v_add_f32 v158, v158, v206
  v_add_f32 v159, v159, v207
  v_mfma_f32_16x16x32_bf16 v[32:35], a[192:195], v[232:235], v[32:35]
  s_mul_i32 s62, s62, 17664
  ds_read_b128 v[248:251], v7 offset:45056
  v_cvt_pk_bf16_f32 v29, v158, v159
  v_mfma_f32_16x16x32_bf16 v[36:39], a[196:199], v[232:235], v[36:39]
  s_add_u32 s62, s62, s56
  buffer_load_dwordx4 v28, s[8:11], s58 offen sc1 lds
  v_lshlrev_b32 v158, 16, v29
  v_mfma_f32_16x16x32_bf16 v[48:51], a[200:203], v[232:235], v[48:51]
  v_and_b32 v159, 0xffff0000, v29
  v_mul_f32 v128, 0xbfb8aa3b, v144
  v_mfma_f32_16x16x32_bf16 v[52:55], a[204:207], v[232:235], v[52:55]
  s_waitcnt lgkmcnt(3)
  v_mul_f32 v129, 0xbfb8aa3b, v145
  v_mfma_f32_16x16x32_bf16 v[40:43], a[192:195], v[236:239], v[40:43]
  ds_read_b128 v[252:255], v7 offset:47104
  v_mfma_f32_16x16x32_bf16 v[44:47], a[196:199], v[236:239], v[44:47]
  v_exp_f32 v128, v128
  v_mfma_f32_16x16x32_bf16 v[56:59], a[200:203], v[236:239], v[56:59]
  v_exp_f32 v129, v129
  v_mfma_f32_16x16x32_bf16 v[60:63], a[204:207], v[236:239], v[60:63]
  s_waitcnt lgkmcnt(3)
  buffer_load_dwordx4 v28, s[8:11], s58 offen offset:1024 sc1 lds
  v_add_f32 v128, 1.0, v128
  v_mfma_f32_16x16x32_bf16 v[32:35], a[208:211], v[240:243], v[32:35]
  s_add_u32 s59, s47, 1
  ds_read_b128 v[216:219], v7 offset:46080
  v_add_f32 v129, 1.0, v129
  v_mfma_f32_16x16x32_bf16 v[36:39], a[212:215], v[240:243], v[36:39]
  s_and_b32 s59, s59, 3
  v_rcp_f32 v128, v128
  v_mfma_f32_16x16x32_bf16 v[48:51], a[216:219], v[240:243], v[48:51]
  s_add_u32 s59, s59, s57
  v_rcp_f32 v129, v129
  v_mfma_f32_16x16x32_bf16 v[52:55], a[220:223], v[240:243], v[52:55]
  s_waitcnt lgkmcnt(3)
  v_mul_f32 v144, v144, v128
  v_mul_f32 v145, v145, v129
  v_mfma_f32_16x16x32_bf16 v[40:43], a[208:211], v[244:247], v[40:43]
  s_mul_i32 s61, s59, 13
  ds_read_b128 v[220:223], v7 offset:48128
  v_cvt_pk_bf16_f32 v29, v144, v145
  v_mfma_f32_16x16x32_bf16 v[44:47], a[212:215], v[244:247], v[44:47]
  s_add_u32 s61, s61, s44
  buffer_load_dwordx4 v10, s[8:11], s58 offen offset:2048 sc1 lds
  v_lshlrev_b32 v144, 16, v29
  v_mfma_f32_16x16x32_bf16 v[56:59], a[216:219], v[244:247], v[56:59]
  s_waitcnt vmcnt(11)
  v_and_b32 v145, 0xffff0000, v29
  v_mul_f32 v130, 0xbfb8aa3b, v146
  v_mfma_f32_16x16x32_bf16 v[60:63], a[220:223], v[244:247], v[60:63]
  s_waitcnt lgkmcnt(3)
  v_mul_f32 v131, 0xbfb8aa3b, v147
  v_mfma_f32_16x16x32_bf16 v[32:35], a[224:227], v[248:251], v[32:35]
  s_barrier
  ds_read_b128 v[224:227], v8 offset:0
  v_mfma_f32_16x16x32_bf16 v[36:39], a[228:231], v[248:251], v[36:39]
  s_mul_i32 s61, s61, 3328
  v_exp_f32 v130, v130
  v_mfma_f32_16x16x32_bf16 v[48:51], a[232:235], v[248:251], v[48:51]
  s_add_u32 s61, s61, 0x1800000
  v_exp_f32 v131, v131
  v_mfma_f32_16x16x32_bf16 v[52:55], a[236:239], v[248:251], v[52:55]
  s_waitcnt lgkmcnt(3)
  buffer_load_dwordx4 v10, s[8:11], s58 offen offset:3072 sc1 lds
  v_add_f32 v130, 1.0, v130
  v_mfma_f32_16x16x32_bf16 v[40:43], a[224:227], v[252:255], v[40:43]
  s_add_u32 m0, s51, 0
  ds_read_b128 v[228:231], v8 offset:2048
  v_add_f32 v131, 1.0, v131
  v_mfma_f32_16x16x32_bf16 v[44:47], a[228:231], v[252:255], v[44:47]
  s_add_u32 s58, s55, 2
  v_rcp_f32 v130, v130
  v_mfma_f32_16x16x32_bf16 v[56:59], a[232:235], v[252:255], v[56:59]
  s_and_b32 s58, s58, 7
  v_rcp_f32 v131, v131
  v_mfma_f32_16x16x32_bf16 v[60:63], a[236:239], v[252:255], v[60:63]
  s_waitcnt lgkmcnt(3)
  v_mul_f32 v146, v146, v130
  v_mul_f32 v147, v147, v131
  v_mfma_f32_16x16x32_bf16 v[32:35], a[240:243], v[216:219], v[32:35]
  s_mul_i32 s58, s58, 17664
  ds_read_b128 v[232:235], v8 offset:1024
  v_cvt_pk_bf16_f32 v29, v146, v147
  v_mfma_f32_16x16x32_bf16 v[36:39], a[244:247], v[216:219], v[36:39]
  s_add_u32 s58, s58, s56
  buffer_load_dwordx4 v28, s[8:11], s62 offen sc1 lds
  v_lshlrev_b32 v146, 16, v29
  v_mfma_f32_16x16x32_bf16 v[48:51], a[248:251], v[216:219], v[48:51]
  v_and_b32 v147, 0xffff0000, v29
  v_mul_f32 v132, 0xbfb8aa3b, v148
  v_mfma_f32_16x16x32_bf16 v[52:55], a[252:255], v[216:219], v[52:55]
  s_waitcnt lgkmcnt(3)
  v_mul_f32 v133, 0xbfb8aa3b, v149
  v_mfma_f32_16x16x32_bf16 v[40:43], a[240:243], v[220:223], v[40:43]
  ds_read_b128 v[236:239], v8 offset:3072
  v_mfma_f32_16x16x32_bf16 v[44:47], a[244:247], v[220:223], v[44:47]
  v_exp_f32 v132, v132
  v_mfma_f32_16x16x32_bf16 v[56:59], a[248:251], v[220:223], v[56:59]
  v_exp_f32 v133, v133
  v_mfma_f32_16x16x32_bf16 v[60:63], a[252:255], v[220:223], v[60:63]
  s_waitcnt lgkmcnt(3)
  buffer_load_dwordx4 v28, s[8:11], s62 offen offset:1024 sc1 lds
  v_add_f32 v132, 1.0, v132
  v_mfma_f32_16x16x32_bf16 v[64:67], a[0:3], v[224:227], 0
  ds_read_b128 v[240:243], v8 offset:8192
  v_add_f32 v133, 1.0, v133
  v_mfma_f32_16x16x32_bf16 v[68:71], a[4:7], v[224:227], 0
  v_rcp_f32 v132, v132
  v_mfma_f32_16x16x32_bf16 v[80:83], a[8:11], v[224:227], 0
  v_rcp_f32 v133, v133
  v_mfma_f32_16x16x32_bf16 v[84:87], a[12:15], v[224:227], 0
  s_waitcnt lgkmcnt(3)
  v_mul_f32 v148, v148, v132
  v_mul_f32 v149, v149, v133
  v_mfma_f32_16x16x32_bf16 v[72:75], a[0:3], v[228:231], 0
  ds_read_b128 v[244:247], v8 offset:10240
  ds_write_b128 v4, v[48:51] offset:0
  v_mfma_f32_16x16x32_bf16 v[76:79], a[4:7], v[228:231], 0
  buffer_load_dwordx4 v10, s[8:11], s62 offen offset:2048 sc1 lds
  ds_write_b128 v4, v[52:55] offset:1024
  v_mfma_f32_16x16x32_bf16 v[88:91], a[8:11], v[228:231], 0
  ds_write_b128 v4, v[56:59] offset:2048
  v_cvt_pk_bf16_f32 v29, v148, v149
  v_mfma_f32_16x16x32_bf16 v[92:95], a[12:15], v[228:231], 0
  s_waitcnt lgkmcnt(6)
  ds_write_b128 v4, v[60:63] offset:3072
  v_lshlrev_b32 v148, 16, v29
  v_mfma_f32_16x16x32_bf16 v[64:67], a[16:19], v[232:235], v[64:67]
  ds_read_b128 v[248:251], v8 offset:9216
  v_and_b32 v149, 0xffff0000, v29
  v_mfma_f32_16x16x32_bf16 v[68:71], a[20:23], v[232:235], v[68:71]
  v_mul_f32 v134, 0xbfb8aa3b, v150
  v_mul_f32 v135, 0xbfb8aa3b, v151
  v_mfma_f32_16x16x32_bf16 v[80:83], a[24:27], v[232:235], v[80:83]
  v_exp_f32 v134, v134
  v_mfma_f32_16x16x32_bf16 v[84:87], a[28:31], v[232:235], v[84:87]
  s_waitcnt lgkmcnt(7)
  buffer_load_dwordx4 v10, s[8:11], s62 offen offset:3072 sc1 lds
  v_mfma_f32_16x16x32_bf16 v[72:75], a[16:19], v[236:239], v[72:75]
  s_add_u32 m0, s51, 4096
  ds_read_b128 v[252:255], v8 offset:11264
  v_mfma_f32_16x16x32_bf16 v[76:79], a[20:23], v[236:239], v[76:79]
  s_add_u32 s62, s55, 3
  v_exp_f32 v135, v135
  v_mfma_f32_16x16x32_bf16 v[88:91], a[24:27], v[236:239], v[88:91]
  s_and_b32 s62, s62, 7
  v_add_f32 v134, 1.0, v134
  v_add_f32 v135, 1.0, v135
  v_mfma_f32_16x16x32_bf16 v[92:95], a[28:31], v[236:239], v[92:95]
  s_waitcnt lgkmcnt(7)
  v_rcp_f32 v134, v134
  v_mfma_f32_16x16x32_bf16 v[64:67], a[32:35], v[240:243], v[64:67]
  s_mul_i32 s62, s62, 17664
  ds_read_b128 v[216:219], v8 offset:4096
  v_mfma_f32_16x16x32_bf16 v[68:71], a[36:39], v[240:243], v[68:71]
  s_add_u32 s62, s62, s56
  buffer_load_dwordx4 v28, s[8:11], s58 offen sc1 lds
  v_mfma_f32_16x16x32_bf16 v[80:83], a[40:43], v[240:243], v[80:83]
  v_rcp_f32 v135, v135
  v_mfma_f32_16x16x32_bf16 v[84:87], a[44:47], v[240:243], v[84:87]
  s_waitcnt lgkmcnt(7)
  v_mul_f32 v150, v150, v134
  v_mul_f32 v151, v151, v135
  v_mfma_f32_16x16x32_bf16 v[72:75], a[32:35], v[244:247], v[72:75]
  ds_read_b128 v[220:223], v8 offset:6144
  v_cvt_pk_bf16_f32 v29, v150, v151
  v_mfma_f32_16x16x32_bf16 v[76:79], a[36:39], v[244:247], v[76:79]
  v_lshlrev_b32 v150, 16, v29
  v_and_b32 v151, 0xffff0000, v29
  v_mfma_f32_16x16x32_bf16 v[88:91], a[40:43], v[244:247], v[88:91]
  v_mul_f32 v136, 0xbfb8aa3b, v152
  v_mul_f32 v137, 0xbfb8aa3b, v153
  v_mfma_f32_16x16x32_bf16 v[92:95], a[44:47], v[244:247], v[92:95]
  s_waitcnt lgkmcnt(3)
  buffer_load_dwordx4 v28, s[8:11], s58 offen offset:1024 sc1 lds
  v_mfma_f32_16x16x32_bf16 v[64:67], a[48:51], v[248:251], v[64:67]
  ds_read_b128 v[224:227], v8 offset:5120
  v_mfma_f32_16x16x32_bf16 v[68:71], a[52:55], v[248:251], v[68:71]
  v_exp_f32 v136, v136
  v_mfma_f32_16x16x32_bf16 v[80:83], a[56:59], v[248:251], v[80:83]
  v_exp_f32 v137, v137
  v_mfma_f32_16x16x32_bf16 v[84:87], a[60:63], v[248:251], v[84:87]
  s_waitcnt lgkmcnt(3)
  v_add_f32 v136, 1.0, v136
  v_add_f32 v137, 1.0, v137
  v_mfma_f32_16x16x32_bf16 v[72:75], a[48:51], v[252:255], v[72:75]
  ds_read_b128 v[228:231], v8 offset:7168
  v_mfma_f32_16x16x32_bf16 v[76:79], a[52:55], v[252:255], v[76:79]
  buffer_load_dwordx4 v10, s[8:11], s58 offen offset:2048 sc1 lds
  v_mfma_f32_16x16x32_bf16 v[88:91], a[56:59], v[252:255], v[88:91]
  v_rcp_f32 v136, v136
  v_mfma_f32_16x16x32_bf16 v[92:95], a[60:63], v[252:255], v[92:95]
  s_waitcnt lgkmcnt(3)
  v_rcp_f32 v137, v137
  v_mfma_f32_16x16x32_bf16 v[64:67], a[64:67], v[216:219], v[64:67]
  ds_read_b128 v[232:235], v8 offset:12288
  v_mul_f32 v152, v152, v136
  v_mfma_f32_16x16x32_bf16 v[68:71], a[68:71], v[216:219], v[68:71]
  v_mul_f32 v153, v153, v137
  v_cvt_pk_bf16_f32 v29, v152, v153
  v_mfma_f32_16x16x32_bf16 v[80:83], a[72:75], v[216:219], v[80:83]
  v_lshlrev_b32 v152, 16, v29
  v_and_b32 v153, 0xffff0000, v29
  v_mfma_f32_16x16x32_bf16 v[84:87], a[76:79], v[216:219], v[84:87]
  s_waitcnt lgkmcnt(3)
  buffer_load_dwordx4 v10, s[8:11], s58 offen offset:3072 sc1 lds
  v_mul_f32 v138, 0xbfb8aa3b, v154
  v_mfma_f32_16x16x32_bf16 v[72:75], a[64:67], v[220:223], v[72:75]
  s_add_u32 m0, s51, 32768
  ds_read_b128 v[236:239], v8 offset:14336
  v_mul_f32 v139, 0xbfb8aa3b, v155
  v_mfma_f32_16x16x32_bf16 v[76:79], a[68:71], v[220:223], v[76:79]
  s_add_u32 s53, s47, 4
  v_exp_f32 v138, v138
  v_mfma_f32_16x16x32_bf16 v[88:91], a[72:75], v[220:223], v[88:91]
  s_and_b32 s53, s53, 3
  v_exp_f32 v139, v139
  v_mfma_f32_16x16x32_bf16 v[92:95], a[76:79], v[220:223], v[92:95]
  s_waitcnt lgkmcnt(3)
  v_add_f32 v138, 1.0, v138
  v_add_f32 v139, 1.0, v139
  v_mfma_f32_16x16x32_bf16 v[64:67], a[80:83], v[224:227], v[64:67]
  s_lshr_b32 s56, s53, 1
  ds_read_b128 v[240:243], v8 offset:13312
  v_mfma_f32_16x16x32_bf16 v[68:71], a[84:87], v[224:227], v[68:71]
  s_mul_i32 s56, s56, 582912
  buffer_load_dwordx4 v28, s[8:11], s62 offen sc1 lds
  v_mfma_f32_16x16x32_bf16 v[80:83], a[88:91], v[224:227], v[80:83]
  s_add_u32 s56, s56, s54
  v_rcp_f32 v138, v138
  v_mfma_f32_16x16x32_bf16 v[84:87], a[92:95], v[224:227], v[84:87]
  s_waitcnt lgkmcnt(3)
  v_rcp_f32 v139, v139
  v_mfma_f32_16x16x32_bf16 v[72:75], a[80:83], v[228:231], v[72:75]
  s_and_b32 s53, s53, 1
  ds_read_b128 v[244:247], v8 offset:15360
  v_mul_f32 v154, v154, v138
  v_mfma_f32_16x16x32_bf16 v[76:79], a[84:87], v[228:231], v[76:79]
  s_lshl_b32 s53, s53, 13
  v_mul_f32 v155, v155, v139
  v_cvt_pk_bf16_f32 v29, v154, v155
  v_mfma_f32_16x16x32_bf16 v[88:91], a[88:91], v[228:231], v[88:91]
  s_waitcnt vmcnt(13)
  v_lshlrev_b32 v154, 16, v29
  v_and_b32 v155, 0xffff0000, v29
  v_mfma_f32_16x16x32_bf16 v[92:95], a[92:95], v[228:231], v[92:95]
  s_waitcnt lgkmcnt(3)
  s_waitcnt lgkmcnt(10)
  buffer_load_dwordx4 v28, s[8:11], s62 offen offset:1024 sc1 lds
  v_mfma_f32_16x16x32_bf16 v[64:67], a[96:99], v[232:235], v[64:67]
  s_barrier
  ds_read_b128 v[248:251], v8 offset:32768
  v_mul_f32 v140, 0xbfb8aa3b, v156
  v_mfma_f32_16x16x32_bf16 v[68:71], a[100:103], v[232:235], v[68:71]
  s_add_u32 s56, s56, s53
  ds_read_b128 v[96:99], v5 offset:0
  v_mul_f32 v141, 0xbfb8aa3b, v157
  v_mfma_f32_16x16x32_bf16 v[80:83], a[104:107], v[232:235], v[80:83]
  s_add_u32 s58, s55, 0
  ds_read_b128 v[100:103], v5 offset:1024
  v_mfma_f32_16x16x32_bf16 v[84:87], a[108:111], v[232:235], v[84:87]
  s_waitcnt lgkmcnt(5)
  ds_read_b128 v[104:107], v5 offset:2048
  ds_read_b128 v[108:111], v5 offset:3072
  v_mfma_f32_16x16x32_bf16 v[72:75], a[96:99], v[236:239], v[72:75]
  s_and_b32 s58, s58, 7
  ds_read_b128 v[252:255], v8 offset:34816
  v_mfma_f32_16x16x32_bf16 v[76:79], a[100:103], v[236:239], v[76:79]
  s_mul_i32 s58, s58, 17664
  buffer_load_dwordx4 v10, s[8:11], s62 offen offset:2048 sc1 lds
  v_mfma_f32_16x16x32_bf16 v[88:91], a[104:107], v[236:239], v[88:91]
  s_add_u32 s58, s58, s56
  v_exp_f32 v140, v140
  v_mfma_f32_16x16x32_bf16 v[92:95], a[108:111], v[236:239], v[92:95]
  s_waitcnt lgkmcnt(7)
  v_exp_f32 v141, v141
  v_mfma_f32_16x16x32_bf16 v[64:67], a[112:115], v[240:243], v[64:67]
  s_waitcnt lgkmcnt(1)
  ds_read_b128 v[216:219], v8 offset:33792
  v_add_f32 v32, v32, v96
  v_mfma_f32_16x16x32_bf16 v[68:71], a[116:119], v[240:243], v[68:71]
  v_add_f32 v33, v33, v97
  v_add_f32 v34, v34, v98
  v_mfma_f32_16x16x32_bf16 v[80:83], a[120:123], v[240:243], v[80:83]
  v_add_f32 v35, v35, v99
  v_add_f32 v36, v36, v100
  v_mfma_f32_16x16x32_bf16 v[84:87], a[124:127], v[240:243], v[84:87]
  s_waitcnt lgkmcnt(7)
  buffer_load_dwordx4 v10, s[8:11], s62 offen offset:3072 sc1 lds
  v_add_f32 v37, v37, v101
  v_mfma_f32_16x16x32_bf16 v[72:75], a[112:115], v[244:247], v[72:75]
  s_add_u32 m0, s51, 36864
  ds_read_b128 v[220:223], v8 offset:35840
  v_add_f32 v38, v38, v102
  v_mfma_f32_16x16x32_bf16 v[76:79], a[116:119], v[244:247], v[76:79]
  s_add_u32 s62, s55, 1
  v_add_f32 v39, v39, v103
  v_add_f32 v40, v40, v104
  v_mfma_f32_16x16x32_bf16 v[88:91], a[120:123], v[244:247], v[88:91]
  s_and_b32 s62, s62, 7
  v_add_f32 v41, v41, v105
  v_add_f32 v42, v42, v106
  v_mfma_f32_16x16x32_bf16 v[92:95], a[124:127], v[244:247], v[92:95]
  s_waitcnt lgkmcnt(7)
  v_add_f32 v43, v43, v107
  v_add_f32 v44, v44, v108
  v_mfma_f32_16x16x32_bf16 v[64:67], a[128:131], v[248:251], v[64:67]
  s_mul_i32 s62, s62, 17664
  ds_read_b128 v[224:227], v8 offset:40960
  v_add_f32 v45, v45, v109
  v_mfma_f32_16x16x32_bf16 v[68:71], a[132:135], v[248:251], v[68:71]
  s_add_u32 s62, s62, s56
  buffer_load_dwordx4 v28, s[8:11], s58 offen sc1 lds
  v_add_f32 v46, v46, v110
  v_mfma_f32_16x16x32_bf16 v[80:83], a[136:139], v[248:251], v[80:83]
  v_add_f32 v47, v47, v111
  v_cvt_pk_bf16_f32 v112, v32, v33
  v_mfma_f32_16x16x32_bf16 v[84:87], a[140:143], v[248:251], v[84:87]
  s_waitcnt lgkmcnt(3)
  v_cvt_pk_bf16_f32 v113, v34, v35
  v_cvt_pk_bf16_f32 v114, v36, v37
  v_mfma_f32_16x16x32_bf16 v[72:75], a[128:131], v[252:255], v[72:75]
  ds_read_b128 v[228:231], v8 offset:43008
  v_cvt_pk_bf16_f32 v116, v38, v39
  v_mfma_f32_16x16x32_bf16 v[76:79], a[132:135], v[252:255], v[76:79]
  v_cvt_pk_bf16_f32 v117, v40, v41
  v_cvt_pk_bf16_f32 v118, v42, v43
  v_mfma_f32_16x16x32_bf16 v[88:91], a[136:139], v[252:255], v[88:91]
  v_cvt_pk_bf16_f32 v120, v44, v45
  v_cvt_pk_bf16_f32 v121, v46, v47
  v_mfma_f32_16x16x32_bf16 v[92:95], a[140:143], v[252:255], v[92:95]
  s_waitcnt lgkmcnt(3)
  buffer_load_dwordx4 v28, s[8:11], s58 offen offset:1024 sc1 lds
  v_add_f32 v140, 1.0, v140
  v_mfma_f32_16x16x32_bf16 v[64:67], a[144:147], v[216:219], v[64:67]
  ds_read_b128 v[232:235], v8 offset:41984
  v_add_f32 v141, 1.0, v141
  v_mfma_f32_16x16x32_bf16 v[68:71], a[148:151], v[216:219], v[68:71]
  buffer_store_dwordx4 v[112:115], v28, s[8:11], s61 offen sc1
  v_mfma_f32_16x16x32_bf16 v[80:83], a[152:155], v[216:219], v[80:83]
  v_rcp_f32 v140, v140
  v_mfma_f32_16x16x32_bf16 v[84:87], a[156:159], v[216:219], v[84:87]
  s_waitcnt lgkmcnt(3)
  v_rcp_f32 v141, v141
  v_mfma_f32_16x16x32_bf16 v[72:75], a[144:147], v[220:223], v[72:75]
  ds_read_b128 v[236:239], v8 offset:44032
  v_mul_f32 v156, v156, v140
  v_mfma_f32_16x16x32_bf16 v[76:79], a[148:151], v[220:223], v[76:79]
  buffer_load_dwordx4 v10, s[8:11], s58 offen offset:2048 sc1 lds
  v_mul_f32 v157, v157, v141
  v_mfma_f32_16x16x32_bf16 v[88:91], a[152:155], v[220:223], v[88:91]
  buffer_store_dwordx4 v[116:119], v28, s[8:11], s61 offen offset:1024 sc1
  v_cvt_pk_bf16_f32 v29, v156, v157
  v_mfma_f32_16x16x32_bf16 v[92:95], a[156:159], v[220:223], v[92:95]
  s_waitcnt lgkmcnt(3)
  v_lshlrev_b32 v156, 16, v29
  v_and_b32 v157, 0xffff0000, v29
  v_mfma_f32_16x16x32_bf16 v[64:67], a[160:163], v[224:227], v[64:67]
  ds_read_b128 v[240:243], v8 offset:36864
  v_mul_f32 v142, 0xbfb8aa3b, v158
  v_mfma_f32_16x16x32_bf16 v[68:71], a[164:167], v[224:227], v[68:71]
  v_mul_f32 v143, 0xbfb8aa3b, v159
  v_mfma_f32_16x16x32_bf16 v[80:83], a[168:171], v[224:227], v[80:83]
  v_exp_f32 v142, v142
  v_mfma_f32_16x16x32_bf16 v[84:87], a[172:175], v[224:227], v[84:87]
  s_waitcnt lgkmcnt(3)
  buffer_load_dwordx4 v10, s[8:11], s58 offen offset:3072 sc1 lds
  v_mfma_f32_16x16x32_bf16 v[72:75], a[160:163], v[228:231], v[72:75]
  s_add_u32 m0, s51, 65536
  ds_read_b128 v[244:247], v8 offset:38912
  v_mfma_f32_16x16x32_bf16 v[76:79], a[164:167], v[228:231], v[76:79]
  s_add_u32 s58, s55, 2
  buffer_store_dwordx4 v[120:123], v28, s[8:11], s61 offen offset:2048 sc1
  v_mfma_f32_16x16x32_bf16 v[88:91], a[168:171], v[228:231], v[88:91]
  s_and_b32 s58, s58, 7
  v_exp_f32 v143, v143
  v_mfma_f32_16x16x32_bf16 v[92:95], a[172:175], v[228:231], v[92:95]
  s_waitcnt lgkmcnt(3)
  v_add_f32 v142, 1.0, v142
  v_add_f32 v143, 1.0, v143
  v_mfma_f32_16x16x32_bf16 v[64:67], a[176:179], v[232:235], v[64:67]
  s_mul_i32 s58, s58, 17664
  ds_read_b128 v[248:251], v8 offset:37888
  v_mfma_f32_16x16x32_bf16 v[68:71], a[180:183], v[232:235], v[68:71]
  s_add_u32 s58, s58, s56
  buffer_load_dwordx4 v28, s[8:11], s62 offen sc1 lds
  v_mfma_f32_16x16x32_bf16 v[80:83], a[184:187], v[232:235], v[80:83]
  v_rcp_f32 v142, v142
  v_mfma_f32_16x16x32_bf16 v[84:87], a[188:191], v[232:235], v[84:87]
  s_waitcnt lgkmcnt(3)
  v_rcp_f32 v143, v143
  v_mfma_f32_16x16x32_bf16 v[72:75], a[176:179], v[236:239], v[72:75]
  ds_read_b128 v[252:255], v8 offset:39936
  v_mul_f32 v158, v158, v142
  v_mfma_f32_16x16x32_bf16 v[76:79], a[180:183], v[236:239], v[76:79]
  v_mul_f32 v159, v159, v143
  v_cvt_pk_bf16_f32 v29, v158, v159
  v_mfma_f32_16x16x32_bf16 v[88:91], a[184:187], v[236:239], v[88:91]
  v_lshlrev_b32 v158, 16, v29
  v_and_b32 v159, 0xffff0000, v29
  v_mfma_f32_16x16x32_bf16 v[92:95], a[188:191], v[236:239], v[92:95]
  s_waitcnt lgkmcnt(3)
  buffer_load_dwordx4 v28, s[8:11], s62 offen offset:1024 sc1 lds
  v_mfma_f32_16x16x32_bf16 v[64:67], a[192:195], v[240:243], v[64:67]
  ds_read_b128 v[216:219], v8 offset:45056
  v_mfma_f32_16x16x32_bf16 v[68:71], a[196:199], v[240:243], v[68:71]
  v_mfma_f32_16x16x32_bf16 v[80:83], a[200:203], v[240:243], v[80:83]
  v_mfma_f32_16x16x32_bf16 v[84:87], a[204:207], v[240:243], v[84:87]
  s_waitcnt lgkmcnt(3)
  v_mfma_f32_16x16x32_bf16 v[72:75], a[192:195], v[244:247], v[72:75]
  ds_read_b128 v[220:223], v8 offset:47104
  v_mfma_f32_16x16x32_bf16 v[76:79], a[196:199], v[244:247], v[76:79]
  buffer_load_dwordx4 v10, s[8:11], s62 offen offset:2048 sc1 lds
  v_mfma_f32_16x16x32_bf16 v[88:91], a[200:203], v[244:247], v[88:91]
  v_mfma_f32_16x16x32_bf16 v[92:95], a[204:207], v[244:247], v[92:95]
  s_waitcnt lgkmcnt(3)
  v_mfma_f32_16x16x32_bf16 v[64:67], a[208:211], v[248:251], v[64:67]
  s_add_u32 s59, s47, 2
  ds_read_b128 v[224:227], v8 offset:46080
  v_mfma_f32_16x16x32_bf16 v[68:71], a[212:215], v[248:251], v[68:71]
  s_and_b32 s59, s59, 3
  v_mfma_f32_16x16x32_bf16 v[80:83], a[216:219], v[248:251], v[80:83]
  s_add_u32 s59, s59, s57
  v_mfma_f32_16x16x32_bf16 v[84:87], a[220:223], v[248:251], v[84:87]
  s_waitcnt lgkmcnt(3)
  buffer_load_dwordx4 v10, s[8:11], s62 offen offset:3072 sc1 lds
  v_mfma_f32_16x16x32_bf16 v[72:75], a[208:211], v[252:255], v[72:75]
  s_add_u32 s62, s55, 3
  ds_read_b128 v[228:231], v8 offset:48128
  v_mfma_f32_16x16x32_bf16 v[76:79], a[212:215], v[252:255], v[76:79]
  s_and_b32 s62, s62, 7
  v_mfma_f32_16x16x32_bf16 v[88:91], a[216:219], v[252:255], v[88:91]
  s_waitcnt vmcnt(19)
  v_mfma_f32_16x16x32_bf16 v[92:95], a[220:223], v[252:255], v[92:95]
  s_waitcnt lgkmcnt(3)
  v_mfma_f32_16x16x32_bf16 v[64:67], a[224:227], v[216:219], v[64:67]
  s_barrier
  ds_read_b128 v[232:235], v9 offset:0
  v_mfma_f32_16x16x32_bf16 v[68:71], a[228:231], v[216:219], v[68:71]
  s_add_u32 m0, s51, 69632
  v_mfma_f32_16x16x32_bf16 v[80:83], a[232:235], v[216:219], v[80:83]
  s_mul_i32 s62, s62, 17664
  buffer_load_dwordx4 v28, s[8:11], s58 offen sc1 lds
  v_mfma_f32_16x16x32_bf16 v[84:87], a[236:239], v[216:219], v[84:87]
  s_waitcnt lgkmcnt(3)
  v_mfma_f32_16x16x32_bf16 v[72:75], a[224:227], v[220:223], v[72:75]
  s_add_u32 s62, s62, s56
  ds_read_b128 v[236:239], v9 offset:2048
  v_mfma_f32_16x16x32_bf16 v[76:79], a[228:231], v[220:223], v[76:79]
  s_mul_i32 s61, s59, 13
  v_mfma_f32_16x16x32_bf16 v[88:91], a[232:235], v[220:223], v[88:91]
  s_add_u32 s61, s61, s44
  v_mfma_f32_16x16x32_bf16 v[92:95], a[236:239], v[220:223], v[92:95]
  s_waitcnt lgkmcnt(3)
  v_mfma_f32_16x16x32_bf16 v[64:67], a[240:243], v[224:227], v[64:67]
  s_mul_i32 s61, s61, 3328
  ds_read_b128 v[240:243], v9 offset:1024
  v_mfma_f32_16x16x32_bf16 v[68:71], a[244:247], v[224:227], v[68:71]
  s_add_u32 s61, s61, 0x1803400
  buffer_load_dwordx4 v28, s[8:11], s58 offen offset:1024 sc1 lds
  v_mfma_f32_16x16x32_bf16 v[80:83], a[248:251], v[224:227], v[80:83]
  v_mfma_f32_16x16x32_bf16 v[84:87], a[252:255], v[224:227], v[84:87]
  s_waitcnt lgkmcnt(3)
  v_mfma_f32_16x16x32_bf16 v[72:75], a[240:243], v[228:231], v[72:75]
  ds_read_b128 v[244:247], v9 offset:3072
  v_mfma_f32_16x16x32_bf16 v[76:79], a[244:247], v[228:231], v[76:79]
  v_mfma_f32_16x16x32_bf16 v[88:91], a[248:251], v[228:231], v[88:91]
  v_mfma_f32_16x16x32_bf16 v[92:95], a[252:255], v[228:231], v[92:95]
  s_waitcnt lgkmcnt(3)
  buffer_load_dwordx4 v10, s[8:11], s58 offen offset:2048 sc1 lds
  v_mfma_f32_16x16x32_bf16 v[32:35], a[0:3], v[232:235], 0
  ds_read_b128 v[248:251], v9 offset:8192
  v_mfma_f32_16x16x32_bf16 v[36:39], a[4:7], v[232:235], 0
  v_mfma_f32_16x16x32_bf16 v[48:51], a[8:11], v[232:235], 0
  v_mfma_f32_16x16x32_bf16 v[52:55], a[12:15], v[232:235], 0
  s_waitcnt lgkmcnt(3)
  v_mfma_f32_16x16x32_bf16 v[40:43], a[0:3], v[236:239], 0
  ds_read_b128 v[252:255], v9 offset:10240
  ds_write_b128 v4, v[80:83] offset:0
  v_mfma_f32_16x16x32_bf16 v[44:47], a[4:7], v[236:239], 0
  buffer_load_dwordx4 v10, s[8:11], s58 offen offset:3072 sc1 lds
  ds_write_b128 v4, v[84:87] offset:1024
  v_mfma_f32_16x16x32_bf16 v[56:59], a[8:11], v[236:239], 0
  s_add_u32 m0, s51, 98304
  ds_write_b128 v4, v[88:91] offset:2048
  v_mfma_f32_16x16x32_bf16 v[60:63], a[12:15], v[236:239], 0
  s_waitcnt lgkmcnt(6)
  ds_write_b128 v4, v[92:95] offset:3072
  v_mfma_f32_16x16x32_bf16 v[32:35], a[16:19], v[240:243], v[32:35]
  ds_read_b128 v[216:219], v9 offset:9216
  v_mfma_f32_16x16x32_bf16 v[36:39], a[20:23], v[240:243], v[36:39]
  v_mfma_f32_16x16x32_bf16 v[48:51], a[24:27], v[240:243], v[48:51]
  v_mfma_f32_16x16x32_bf16 v[52:55], a[28:31], v[240:243], v[52:55]
  s_waitcnt lgkmcnt(7)
  buffer_load_dwordx4 v28, s[8:11], s62 offen sc1 lds
  v_mfma_f32_16x16x32_bf16 v[40:43], a[16:19], v[244:247], v[40:43]
  ds_read_b128 v[220:223], v9 offset:11264
  v_mfma_f32_16x16x32_bf16 v[44:47], a[20:23], v[244:247], v[44:47]
  s_waitcnt lgkmcnt(2)
  v_mfma_f32_16x16x32_bf16 v[56:59], a[24:27], v[244:247], v[56:59]
  s_barrier
  ds_read_b128 v[96:99], v5 offset:0
  v_mfma_f32_16x16x32_bf16 v[60:63], a[28:31], v[244:247], v[60:63]
  s_waitcnt lgkmcnt(8)
  ds_read_b128 v[100:103], v5 offset:1024
  ds_read_b128 v[104:107], v5 offset:2048
  v_mfma_f32_16x16x32_bf16 v[32:35], a[32:35], v[248:251], v[32:35]
  ds_read_b128 v[224:227], v7 offset:0
  ds_read_b128 v[108:111], v5 offset:3072
  v_mfma_f32_16x16x32_bf16 v[36:39], a[36:39], v[248:251], v[36:39]
  buffer_load_dwordx4 v28, s[8:11], s62 offen offset:1024 sc1 lds
  v_mfma_f32_16x16x32_bf16 v[48:51], a[40:43], v[248:251], v[48:51]
  v_mfma_f32_16x16x32_bf16 v[52:55], a[44:47], v[248:251], v[52:55]
  s_waitcnt lgkmcnt(11)
  v_mfma_f32_16x16x32_bf16 v[40:43], a[32:35], v[252:255], v[40:43]
  ds_read_b128 v[228:231], v7 offset:2048
  v_mfma_f32_16x16x32_bf16 v[44:47], a[36:39], v[252:255], v[44:47]
  s_waitcnt lgkmcnt(1)
  v_add_f32 v64, v64, v96
  v_add_f32 v65, v65, v97
  v_mfma_f32_16x16x32_bf16 v[56:59], a[40:43], v[252:255], v[56:59]
  v_add_f32 v66, v66, v98
  v_add_f32 v67, v67, v99
  v_mfma_f32_16x16x32_bf16 v[60:63], a[44:47], v[252:255], v[60:63]
  s_waitcnt lgkmcnt(7)
  buffer_load_dwordx4 v10, s[8:11], s62 offen offset:2048 sc1 lds
  v_add_f32 v68, v68, v100
  v_mfma_f32_16x16x32_bf16 v[32:35], a[48:51], v[216:219], v[32:35]
  ds_read_b128 v[232:235], v7 offset:1024
  v_add_f32 v69, v69, v101
  v_mfma_f32_16x16x32_bf16 v[36:39], a[52:55], v[216:219], v[36:39]
  v_add_f32 v70, v70, v102
  v_add_f32 v71, v71, v103
  v_mfma_f32_16x16x32_bf16 v[48:51], a[56:59], v[216:219], v[48:51]
  v_add_f32 v72, v72, v104
  v_add_f32 v73, v73, v105
  v_mfma_f32_16x16x32_bf16 v[52:55], a[60:63], v[216:219], v[52:55]
  s_waitcnt lgkmcnt(7)
  v_add_f32 v74, v74, v106
  v_add_f32 v75, v75, v107
  v_mfma_f32_16x16x32_bf16 v[40:43], a[48:51], v[220:223], v[40:43]
  ds_read_b128 v[236:239], v7 offset:3072
  v_add_f32 v76, v76, v108
  v_mfma_f32_16x16x32_bf16 v[44:47], a[52:55], v[220:223], v[44:47]
  buffer_load_dwordx4 v10, s[8:11], s62 offen offset:3072 sc1 lds
  v_add_f32 v77, v77, v109
  v_mfma_f32_16x16x32_bf16 v[56:59], a[56:59], v[220:223], v[56:59]
  v_add_f32 v78, v78, v110
  v_add_f32 v79, v79, v111
  v_mfma_f32_16x16x32_bf16 v[60:63], a[60:63], v[220:223], v[60:63]
  s_waitcnt lgkmcnt(4)
  v_cvt_pk_bf16_f32 v112, v64, v65
  v_cvt_pk_bf16_f32 v113, v66, v67
  v_mfma_f32_16x16x32_bf16 v[32:35], a[64:67], v[224:227], v[32:35]
  ds_read_b128 v[240:243], v7 offset:8192
  v_cvt_pk_bf16_f32 v114, v68, v69
  v_mfma_f32_16x16x32_bf16 v[36:39], a[68:71], v[224:227], v[36:39]
  v_cvt_pk_bf16_f32 v116, v70, v71
  v_cvt_pk_bf16_f32 v117, v72, v73
  v_mfma_f32_16x16x32_bf16 v[48:51], a[72:75], v[224:227], v[48:51]
  v_cvt_pk_bf16_f32 v118, v74, v75
  v_cvt_pk_bf16_f32 v120, v76, v77
  v_mfma_f32_16x16x32_bf16 v[52:55], a[76:79], v[224:227], v[52:55]
  s_waitcnt lgkmcnt(3)
  v_cvt_pk_bf16_f32 v121, v78, v79
  v_mfma_f32_16x16x32_bf16 v[40:43], a[64:67], v[228:231], v[40:43]
  ds_read_b128 v[244:247], v7 offset:10240
  v_mfma_f32_16x16x32_bf16 v[44:47], a[68:71], v[228:231], v[44:47]
  buffer_store_dwordx4 v[112:115], v28, s[8:11], s61 offen sc1
  v_mfma_f32_16x16x32_bf16 v[56:59], a[72:75], v[228:231], v[56:59]
  v_mfma_f32_16x16x32_bf16 v[60:63], a[76:79], v[228:231], v[60:63]
  s_waitcnt lgkmcnt(3)
  v_mfma_f32_16x16x32_bf16 v[32:35], a[80:83], v[232:235], v[32:35]
  ds_read_b128 v[248:251], v7 offset:9216
  v_mfma_f32_16x16x32_bf16 v[36:39], a[84:87], v[232:235], v[36:39]
  v_mfma_f32_16x16x32_bf16 v[48:51], a[88:91], v[232:235], v[48:51]
  v_mfma_f32_16x16x32_bf16 v[52:55], a[92:95], v[232:235], v[52:55]
  s_waitcnt lgkmcnt(3)
  buffer_store_dwordx4 v[116:119], v28, s[8:11], s61 offen offset:1024 sc1
  v_mfma_f32_16x16x32_bf16 v[40:43], a[80:83], v[236:239], v[40:43]
  ds_read_b128 v[252:255], v7 offset:11264
  v_mfma_f32_16x16x32_bf16 v[44:47], a[84:87], v[236:239], v[44:47]
  buffer_store_dwordx4 v[120:123], v28, s[8:11], s61 offen offset:2048 sc1
  v_mfma_f32_16x16x32_bf16 v[56:59], a[88:91], v[236:239], v[56:59]
  s_waitcnt vmcnt(22)
  v_mfma_f32_16x16x32_bf16 v[60:63], a[92:95], v[236:239], v[60:63]
  s_waitcnt lgkmcnt(3)
  v_mfma_f32_16x16x32_bf16 v[32:35], a[96:99], v[240:243], v[32:35]
  s_barrier
  ds_read_b128 v[216:219], v7 offset:4096
  v_mfma_f32_16x16x32_bf16 v[36:39], a[100:103], v[240:243], v[36:39]
  v_mfma_f32_16x16x32_bf16 v[48:51], a[104:107], v[240:243], v[48:51]
  v_mfma_f32_16x16x32_bf16 v[52:55], a[108:111], v[240:243], v[52:55]
  s_waitcnt lgkmcnt(3)
  v_mfma_f32_16x16x32_bf16 v[40:43], a[96:99], v[244:247], v[40:43]
  ds_read_b128 v[220:223], v7 offset:6144
  v_mfma_f32_16x16x32_bf16 v[44:47], a[100:103], v[244:247], v[44:47]
  v_mfma_f32_16x16x32_bf16 v[56:59], a[104:107], v[244:247], v[56:59]
  v_mfma_f32_16x16x32_bf16 v[60:63], a[108:111], v[244:247], v[60:63]
  s_waitcnt lgkmcnt(3)
  v_mfma_f32_16x16x32_bf16 v[32:35], a[112:115], v[248:251], v[32:35]
  ds_read_b128 v[224:227], v7 offset:5120
  v_mfma_f32_16x16x32_bf16 v[36:39], a[116:119], v[248:251], v[36:39]
  v_mfma_f32_16x16x32_bf16 v[48:51], a[120:123], v[248:251], v[48:51]
  v_mfma_f32_16x16x32_bf16 v[52:55], a[124:127], v[248:251], v[52:55]
  s_waitcnt lgkmcnt(3)
  v_mfma_f32_16x16x32_bf16 v[40:43], a[112:115], v[252:255], v[40:43]
  ds_read_b128 v[228:231], v7 offset:7168
  v_mfma_f32_16x16x32_bf16 v[44:47], a[116:119], v[252:255], v[44:47]
  v_mfma_f32_16x16x32_bf16 v[56:59], a[120:123], v[252:255], v[56:59]
  v_mfma_f32_16x16x32_bf16 v[60:63], a[124:127], v[252:255], v[60:63]
  s_waitcnt lgkmcnt(3)
  v_mfma_f32_16x16x32_bf16 v[32:35], a[128:131], v[216:219], v[32:35]
  ds_read_b128 v[232:235], v7 offset:12288
  v_mfma_f32_16x16x32_bf16 v[36:39], a[132:135], v[216:219], v[36:39]
  v_mfma_f32_16x16x32_bf16 v[48:51], a[136:139], v[216:219], v[48:51]
  v_mfma_f32_16x16x32_bf16 v[52:55], a[140:143], v[216:219], v[52:55]
  s_waitcnt lgkmcnt(3)
  v_mfma_f32_16x16x32_bf16 v[40:43], a[128:131], v[220:223], v[40:43]
  ds_read_b128 v[236:239], v7 offset:14336
  v_mfma_f32_16x16x32_bf16 v[44:47], a[132:135], v[220:223], v[44:47]
  v_mfma_f32_16x16x32_bf16 v[56:59], a[136:139], v[220:223], v[56:59]
  v_mfma_f32_16x16x32_bf16 v[60:63], a[140:143], v[220:223], v[60:63]
  s_waitcnt lgkmcnt(3)
  v_mfma_f32_16x16x32_bf16 v[32:35], a[144:147], v[224:227], v[32:35]
  ds_read_b128 v[240:243], v7 offset:13312
  v_mfma_f32_16x16x32_bf16 v[36:39], a[148:151], v[224:227], v[36:39]
  v_mfma_f32_16x16x32_bf16 v[48:51], a[152:155], v[224:227], v[48:51]
  v_mfma_f32_16x16x32_bf16 v[52:55], a[156:159], v[224:227], v[52:55]
  s_waitcnt lgkmcnt(3)
  v_mfma_f32_16x16x32_bf16 v[40:43], a[144:147], v[228:231], v[40:43]
  ds_read_b128 v[244:247], v7 offset:15360
  v_mfma_f32_16x16x32_bf16 v[44:47], a[148:151], v[228:231], v[44:47]
  v_mfma_f32_16x16x32_bf16 v[56:59], a[152:155], v[228:231], v[56:59]
  v_mfma_f32_16x16x32_bf16 v[60:63], a[156:159], v[228:231], v[60:63]
  s_waitcnt lgkmcnt(3)
  v_mfma_f32_16x16x32_bf16 v[32:35], a[160:163], v[232:235], v[32:35]
  ds_read_b128 v[248:251], v7 offset:32768
  v_mfma_f32_16x16x32_bf16 v[36:39], a[164:167], v[232:235], v[36:39]
  v_mfma_f32_16x16x32_bf16 v[48:51], a[168:171], v[232:235], v[48:51]
  ds_read_b128 v[252:255], v7 offset:34816
  v_mfma_f32_16x16x32_bf16 v[52:55], a[172:175], v[232:235], v[52:55]
  s_waitcnt lgkmcnt(4)
  v_mfma_f32_16x16x32_bf16 v[40:43], a[160:163], v[236:239], v[40:43]
  ds_read_b128 v[216:219], v7 offset:33792
  v_mfma_f32_16x16x32_bf16 v[44:47], a[164:167], v[236:239], v[44:47]
  v_mfma_f32_16x16x32_bf16 v[56:59], a[168:171], v[236:239], v[56:59]
  ds_read_b128 v[220:223], v7 offset:35840
  v_mfma_f32_16x16x32_bf16 v[60:63], a[172:175], v[236:239], v[60:63]
  s_waitcnt lgkmcnt(5)
  v_mfma_f32_16x16x32_bf16 v[32:35], a[176:179], v[240:243], v[32:35]
  ds_read_b128 v[224:227], v7 offset:40960
  v_mfma_f32_16x16x32_bf16 v[36:39], a[180:183], v[240:243], v[36:39]
  v_mfma_f32_16x16x32_bf16 v[48:51], a[184:187], v[240:243], v[48:51]
  ds_read_b128 v[228:231], v7 offset:43008
  v_mfma_f32_16x16x32_bf16 v[52:55], a[188:191], v[240:243], v[52:55]
  s_waitcnt lgkmcnt(6)
  v_mfma_f32_16x16x32_bf16 v[40:43], a[176:179], v[244:247], v[40:43]
  ds_read_b128 v[232:235], v7 offset:41984
  v_mfma_f32_16x16x32_bf16 v[44:47], a[180:183], v[244:247], v[44:47]
  v_mfma_f32_16x16x32_bf16 v[56:59], a[184:187], v[244:247], v[56:59]
  ds_read_b128 v[236:239], v7 offset:44032
  v_mfma_f32_16x16x32_bf16 v[60:63], a[188:191], v[244:247], v[60:63]
  s_waitcnt lgkmcnt(7)
  v_mfma_f32_16x16x32_bf16 v[48:51], a[200:203], v[248:251], v[48:51]
  v_mfma_f32_16x16x32_bf16 v[52:55], a[204:207], v[248:251], v[52:55]
  s_waitcnt lgkmcnt(6)
  v_mfma_f32_16x16x32_bf16 v[56:59], a[200:203], v[252:255], v[56:59]
  v_mfma_f32_16x16x32_bf16 v[60:63], a[204:207], v[252:255], v[60:63]
  s_waitcnt lgkmcnt(5)
  v_mfma_f32_16x16x32_bf16 v[48:51], a[216:219], v[216:219], v[48:51]
  v_mfma_f32_16x16x32_bf16 v[52:55], a[220:223], v[216:219], v[52:55]
  s_waitcnt lgkmcnt(4)
  v_mfma_f32_16x16x32_bf16 v[56:59], a[216:219], v[220:223], v[56:59]
  v_mfma_f32_16x16x32_bf16 v[60:63], a[220:223], v[220:223], v[60:63]
  s_waitcnt lgkmcnt(3)
  v_mfma_f32_16x16x32_bf16 v[48:51], a[232:235], v[224:227], v[48:51]
  s_add_u32 s59, s47, 3
  buffer_load_dwordx4 v[176:179], v28, s[8:11], s65 offen sc1
  v_mfma_f32_16x16x32_bf16 v[52:55], a[236:239], v[224:227], v[52:55]
  s_waitcnt lgkmcnt(2)
  v_mfma_f32_16x16x32_bf16 v[56:59], a[232:235], v[228:231], v[56:59]
  s_and_b32 s59, s59, 3
  v_mfma_f32_16x16x32_bf16 v[60:63], a[236:239], v[228:231], v[60:63]
  s_waitcnt lgkmcnt(1)
  v_mfma_f32_16x16x32_bf16 v[48:51], a[248:251], v[232:235], v[48:51]
  s_add_u32 s59, s59, s57
  v_mfma_f32_16x16x32_bf16 v[52:55], a[252:255], v[232:235], v[52:55]
  s_waitcnt lgkmcnt(0)
  v_mfma_f32_16x16x32_bf16 v[56:59], a[248:251], v[236:239], v[56:59]
  s_waitcnt vmcnt(12)
  buffer_load_dwordx4 v[180:183], v28, s[8:11], s65 offen offset:1024 sc1
  v_mfma_f32_16x16x32_bf16 v[60:63], a[252:255], v[236:239], v[60:63]
  s_mul_i32 s61, s59, 13
  v_mfma_f32_16x16x32_bf16 v[32:35], a[192:195], v[248:251], v[32:35]
  s_barrier
  ds_read_b128 v[240:243], v7 offset:36864
  v_mfma_f32_16x16x32_bf16 v[36:39], a[196:199], v[248:251], v[36:39]
  s_add_u32 s61, s61, s44
  v_mfma_f32_16x16x32_bf16 v[40:43], a[192:195], v[252:255], v[40:43]
  s_mul_i32 s61, s61, 3328
  v_mfma_f32_16x16x32_bf16 v[44:47], a[196:199], v[252:255], v[44:47]
  s_add_u32 s61, s61, 0x1806800
  ds_write_b128 v4, v[48:51] offset:0
  ds_write_b128 v4, v[52:55] offset:1024
  v_mfma_f32_16x16x32_bf16 v[32:35], a[208:211], v[216:219], v[32:35]
  ds_read_b128 v[244:247], v7 offset:38912
  ds_write_b128 v4, v[56:59] offset:2048
  v_mfma_f32_16x16x32_bf16 v[36:39], a[212:215], v[216:219], v[36:39]
  ds_write_b128 v4, v[60:63] offset:3072
  v_mfma_f32_16x16x32_bf16 v[40:43], a[208:211], v[220:223], v[40:43]
  buffer_load_dwordx4 v[184:187], v28, s[8:11], s65 offen offset:2048 sc1
  v_mfma_f32_16x16x32_bf16 v[44:47], a[212:215], v[220:223], v[44:47]
  v_mfma_f32_16x16x32_bf16 v[32:35], a[224:227], v[224:227], v[32:35]
  ds_read_b128 v[248:251], v7 offset:37888
  v_mfma_f32_16x16x32_bf16 v[36:39], a[228:231], v[224:227], v[36:39]
  v_mfma_f32_16x16x32_bf16 v[40:43], a[224:227], v[228:231], v[40:43]
  s_waitcnt lgkmcnt(1)
  v_mfma_f32_16x16x32_bf16 v[44:47], a[228:231], v[228:231], v[44:47]
  s_barrier
  ds_read_b128 v[96:99], v5 offset:0
  ds_read_b128 v[100:103], v5 offset:1024
  v_mfma_f32_16x16x32_bf16 v[32:35], a[240:243], v[232:235], v[32:35]
  ds_read_b128 v[252:255], v7 offset:39936
  ds_read_b128 v[104:107], v5 offset:2048
  v_mfma_f32_16x16x32_bf16 v[36:39], a[244:247], v[232:235], v[36:39]
  ds_read_b128 v[108:111], v5 offset:3072
  v_mfma_f32_16x16x32_bf16 v[40:43], a[240:243], v[236:239], v[40:43]
  buffer_load_dwordx4 v[188:191], v28, s[8:11], s16 offen sc1
  v_mfma_f32_16x16x32_bf16 v[44:47], a[244:247], v[236:239], v[44:47]
  s_waitcnt lgkmcnt(11)
  v_mfma_f32_16x16x32_bf16 v[64:67], a[0:3], v[240:243], 0
  ds_read_b128 v[216:219], v7 offset:45056
  v_mfma_f32_16x16x32_bf16 v[68:71], a[4:7], v[240:243], 0
  v_mfma_f32_16x16x32_bf16 v[80:83], a[8:11], v[240:243], 0
  s_waitcnt lgkmcnt(1)
  v_add_f32 v32, v32, v96
  v_add_f32 v33, v33, v97
  v_mfma_f32_16x16x32_bf16 v[84:87], a[12:15], v[240:243], 0
  s_waitcnt lgkmcnt(9)
  v_add_f32 v34, v34, v98
  v_add_f32 v35, v35, v99
  v_mfma_f32_16x16x32_bf16 v[72:75], a[0:3], v[244:247], 0
  ds_read_b128 v[220:223], v7 offset:47104
  v_add_f32 v36, v36, v100
  v_mfma_f32_16x16x32_bf16 v[76:79], a[4:7], v[244:247], 0
  buffer_load_dwordx4 v[192:195], v28, s[8:11], s16 offen offset:1024 sc1
  v_add_f32 v37, v37, v101
  v_add_f32 v38, v38, v102
  v_mfma_f32_16x16x32_bf16 v[88:91], a[8:11], v[244:247], 0
  buffer_load_dwordx4 v[196:199], v28, s[8:11], s16 offen offset:2048 sc1
  v_add_f32 v39, v39, v103
  v_add_f32 v40, v40, v104
  v_mfma_f32_16x16x32_bf16 v[92:95], a[12:15], v[244:247], 0
  s_waitcnt lgkmcnt(7)
  v_add_f32 v41, v41, v105
  v_add_f32 v42, v42, v106
  v_mfma_f32_16x16x32_bf16 v[64:67], a[16:19], v[248:251], v[64:67]
  ds_read_b128 v[224:227], v7 offset:46080
  v_add_f32 v43, v43, v107
  v_mfma_f32_16x16x32_bf16 v[68:71], a[20:23], v[248:251], v[68:71]
  v_add_f32 v44, v44, v108
  v_add_f32 v45, v45, v109
  v_mfma_f32_16x16x32_bf16 v[80:83], a[24:27], v[248:251], v[80:83]
  v_add_f32 v46, v46, v110
  v_add_f32 v47, v47, v111
  v_mfma_f32_16x16x32_bf16 v[84:87], a[28:31], v[248:251], v[84:87]
  s_waitcnt lgkmcnt(5)
  v_cvt_pk_bf16_f32 v112, v32, v33
  v_cvt_pk_bf16_f32 v113, v34, v35
  v_mfma_f32_16x16x32_bf16 v[72:75], a[16:19], v[252:255], v[72:75]
  ds_read_b128 v[228:231], v7 offset:48128
  v_cvt_pk_bf16_f32 v114, v36, v37
  v_mfma_f32_16x16x32_bf16 v[76:79], a[20:23], v[252:255], v[76:79]
  v_cvt_pk_bf16_f32 v116, v38, v39
  v_cvt_pk_bf16_f32 v117, v40, v41
  v_mfma_f32_16x16x32_bf16 v[88:91], a[24:27], v[252:255], v[88:91]
  v_cvt_pk_bf16_f32 v118, v42, v43
  v_cvt_pk_bf16_f32 v120, v44, v45
  v_mfma_f32_16x16x32_bf16 v[92:95], a[28:31], v[252:255], v[92:95]
  s_waitcnt lgkmcnt(3)
  v_cvt_pk_bf16_f32 v121, v46, v47
  v_mfma_f32_16x16x32_bf16 v[64:67], a[32:35], v[216:219], v[64:67]
  ds_read_b128 v[232:235], v8 offset:0
  v_mfma_f32_16x16x32_bf16 v[68:71], a[36:39], v[216:219], v[68:71]
  buffer_store_dwordx4 v[112:115], v28, s[8:11], s61 offen sc1
  v_mfma_f32_16x16x32_bf16 v[80:83], a[40:43], v[216:219], v[80:83]
  v_mfma_f32_16x16x32_bf16 v[84:87], a[44:47], v[216:219], v[84:87]
  s_waitcnt lgkmcnt(3)
  v_mfma_f32_16x16x32_bf16 v[72:75], a[32:35], v[220:223], v[72:75]
  ds_read_b128 v[236:239], v8 offset:2048
  v_mfma_f32_16x16x32_bf16 v[76:79], a[36:39], v[220:223], v[76:79]
  v_mfma_f32_16x16x32_bf16 v[88:91], a[40:43], v[220:223], v[88:91]
  v_mfma_f32_16x16x32_bf16 v[92:95], a[44:47], v[220:223], v[92:95]
  s_waitcnt lgkmcnt(3)
  buffer_store_dwordx4 v[116:119], v28, s[8:11], s61 offen offset:1024 sc1
  v_mfma_f32_16x16x32_bf16 v[64:67], a[48:51], v[224:227], v[64:67]
  ds_read_b128 v[240:243], v8 offset:1024
  v_mfma_f32_16x16x32_bf16 v[68:71], a[52:55], v[224:227], v[68:71]
  buffer_store_dwordx4 v[120:123], v28, s[8:11], s61 offen offset:2048 sc1
  v_mfma_f32_16x16x32_bf16 v[80:83], a[56:59], v[224:227], v[80:83]
  v_mfma_f32_16x16x32_bf16 v[84:87], a[60:63], v[224:227], v[84:87]
  s_waitcnt lgkmcnt(3)
  v_mfma_f32_16x16x32_bf16 v[72:75], a[48:51], v[228:231], v[72:75]
  ds_read_b128 v[244:247], v8 offset:3072
  v_mfma_f32_16x16x32_bf16 v[76:79], a[52:55], v[228:231], v[76:79]
  v_mfma_f32_16x16x32_bf16 v[88:91], a[56:59], v[228:231], v[88:91]
  v_mfma_f32_16x16x32_bf16 v[92:95], a[60:63], v[228:231], v[92:95]
  s_waitcnt lgkmcnt(3)
  v_mfma_f32_16x16x32_bf16 v[64:67], a[64:67], v[232:235], v[64:67]
  ds_read_b128 v[248:251], v8 offset:8192
  v_mfma_f32_16x16x32_bf16 v[68:71], a[68:71], v[232:235], v[68:71]
  v_mfma_f32_16x16x32_bf16 v[80:83], a[72:75], v[232:235], v[80:83]
  v_mfma_f32_16x16x32_bf16 v[84:87], a[76:79], v[232:235], v[84:87]
  s_waitcnt lgkmcnt(3)
  v_mfma_f32_16x16x32_bf16 v[72:75], a[64:67], v[236:239], v[72:75]
  ds_read_b128 v[252:255], v8 offset:10240
  v_mfma_f32_16x16x32_bf16 v[76:79], a[68:71], v[236:239], v[76:79]
  v_mfma_f32_16x16x32_bf16 v[88:91], a[72:75], v[236:239], v[88:91]
  v_mfma_f32_16x16x32_bf16 v[92:95], a[76:79], v[236:239], v[92:95]
  s_waitcnt lgkmcnt(3)
  v_mfma_f32_16x16x32_bf16 v[64:67], a[80:83], v[240:243], v[64:67]
  ds_read_b128 v[216:219], v8 offset:9216
  v_mfma_f32_16x16x32_bf16 v[68:71], a[84:87], v[240:243], v[68:71]
  v_mfma_f32_16x16x32_bf16 v[80:83], a[88:91], v[240:243], v[80:83]
  v_mfma_f32_16x16x32_bf16 v[84:87], a[92:95], v[240:243], v[84:87]
  s_waitcnt lgkmcnt(3)
  v_mfma_f32_16x16x32_bf16 v[72:75], a[80:83], v[244:247], v[72:75]
  ds_read_b128 v[220:223], v8 offset:11264
  v_mfma_f32_16x16x32_bf16 v[76:79], a[84:87], v[244:247], v[76:79]
  v_mfma_f32_16x16x32_bf16 v[88:91], a[88:91], v[244:247], v[88:91]
  s_waitcnt vmcnt(12)
  v_mfma_f32_16x16x32_bf16 v[92:95], a[92:95], v[244:247], v[92:95]
  s_waitcnt lgkmcnt(3)
  v_mfma_f32_16x16x32_bf16 v[64:67], a[96:99], v[248:251], v[64:67]
  s_barrier
  ds_read_b128 v[224:227], v8 offset:4096
  v_mfma_f32_16x16x32_bf16 v[68:71], a[100:103], v[248:251], v[68:71]
  s_waitcnt vmcnt(3)
  v_min3_u32 v29, v179, v183, v187
  v_max3_u32 v30, v179, v183, v187
  v_mfma_f32_16x16x32_bf16 v[80:83], a[104:107], v[248:251], v[80:83]
  v_min3_u32 v29, v29, v191, v195
  v_max3_u32 v30, v30, v191, v195
  v_mfma_f32_16x16x32_bf16 v[84:87], a[108:111], v[248:251], v[84:87]
  s_waitcnt lgkmcnt(3)
  v_min3_u32 v29, v29, v199, s43
  v_max3_u32 v30, v30, v199, s43
  v_mfma_f32_16x16x32_bf16 v[72:75], a[96:99], v[252:255], v[72:75]
  ds_read_b128 v[228:231], v8 offset:6144
  v_cmp_ne_u32 vcc, v29, v30
  v_mfma_f32_16x16x32_bf16 v[76:79], a[100:103], v[252:255], v[76:79]
  s_cbranch_vccnz L_spin26
L_back28:
  v_lshlrev_b32 v48, 16, v176
  v_mfma_f32_16x16x32_bf16 v[88:91], a[104:107], v[252:255], v[88:91]
  v_and_b32 v49, 0xffff0000, v176
  v_lshlrev_b32 v29, 16, v188
  v_mfma_f32_16x16x32_bf16 v[92:95], a[108:111], v[252:255], v[92:95]
  s_waitcnt lgkmcnt(3)
  v_and_b32 v30, 0xffff0000, v188
  v_add_f32 v48, v48, v29
  v_mfma_f32_16x16x32_bf16 v[64:67], a[112:115], v[216:219], v[64:67]
  ds_read_b128 v[232:235], v8 offset:5120
  v_add_f32 v49, v49, v30
  v_mfma_f32_16x16x32_bf16 v[68:71], a[116:119], v[216:219], v[68:71]
  v_lshlrev_b32 v50, 16, v177
  v_and_b32 v51, 0xffff0000, v177
  v_mfma_f32_16x16x32_bf16 v[80:83], a[120:123], v[216:219], v[80:83]
  v_lshlrev_b32 v29, 16, v189
  v_and_b32 v30, 0xffff0000, v189
  v_mfma_f32_16x16x32_bf16 v[84:87], a[124:127], v[216:219], v[84:87]
  s_waitcnt lgkmcnt(3)
  v_add_f32 v50, v50, v29
  v_add_f32 v51, v51, v30
  v_mfma_f32_16x16x32_bf16 v[72:75], a[112:115], v[220:223], v[72:75]
  ds_read_b128 v[236:239], v8 offset:7168
  v_lshlrev_b32 v52, 16, v178
  v_mfma_f32_16x16x32_bf16 v[76:79], a[116:119], v[220:223], v[76:79]
  v_and_b32 v53, 0xffff0000, v178
  v_lshlrev_b32 v29, 16, v190
  v_mfma_f32_16x16x32_bf16 v[88:91], a[120:123], v[220:223], v[88:91]
  v_and_b32 v30, 0xffff0000, v190
  v_add_f32 v52, v52, v29
  v_mfma_f32_16x16x32_bf16 v[92:95], a[124:127], v[220:223], v[92:95]
  s_waitcnt lgkmcnt(3)
  v_add_f32 v53, v53, v30
  v_lshlrev_b32 v54, 16, v180
  v_mfma_f32_16x16x32_bf16 v[64:67], a[128:131], v[224:227], v[64:67]
  ds_read_b128 v[240:243], v8 offset:12288
  v_and_b32 v55, 0xffff0000, v180
  v_mfma_f32_16x16x32_bf16 v[68:71], a[132:135], v[224:227], v[68:71]
  v_lshlrev_b32 v29, 16, v192
  v_and_b32 v30, 0xffff0000, v192
  v_mfma_f32_16x16x32_bf16 v[80:83], a[136:139], v[224:227], v[80:83]
  v_add_f32 v54, v54, v29
  v_add_f32 v55, v55, v30
  v_mfma_f32_16x16x32_bf16 v[84:87], a[140:143], v[224:227], v[84:87]
  s_waitcnt lgkmcnt(3)
  v_lshlrev_b32 v56, 16, v181
  v_and_b32 v57, 0xffff0000, v181
  v_mfma_f32_16x16x32_bf16 v[72:75], a[128:131], v[228:231], v[72:75]
  ds_read_b128 v[244:247], v8 offset:14336
  v_lshlrev_b32 v29, 16, v193
  v_mfma_f32_16x16x32_bf16 v[76:79], a[132:135], v[228:231], v[76:79]
  v_and_b32 v30, 0xffff0000, v193
  v_add_f32 v56, v56, v29
  v_mfma_f32_16x16x32_bf16 v[88:91], a[136:139], v[228:231], v[88:91]
  v_add_f32 v57, v57, v30
  v_lshlrev_b32 v58, 16, v182
  v_mfma_f32_16x16x32_bf16 v[92:95], a[140:143], v[228:231], v[92:95]
  s_waitcnt lgkmcnt(3)
  v_and_b32 v59, 0xffff0000, v182
  v_lshlrev_b32 v29, 16, v194
  v_mfma_f32_16x16x32_bf16 v[64:67], a[144:147], v[232:235], v[64:67]
  ds_read_b128 v[248:251], v8 offset:13312
  v_and_b32 v30, 0xffff0000, v194
  v_mfma_f32_16x16x32_bf16 v[68:71], a[148:151], v[232:235], v[68:71]
  v_add_f32 v58, v58, v29
  v_add_f32 v59, v59, v30
  v_mfma_f32_16x16x32_bf16 v[80:83], a[152:155], v[232:235], v[80:83]
  v_lshlrev_b32 v60, 16, v184
  v_and_b32 v61, 0xffff0000, v184
  v_mfma_f32_16x16x32_bf16 v[84:87], a[156:159], v[232:235], v[84:87]
  s_waitcnt lgkmcnt(3)
  v_lshlrev_b32 v29, 16, v196
  v_and_b32 v30, 0xffff0000, v196
  v_mfma_f32_16x16x32_bf16 v[72:75], a[144:147], v[236:239], v[72:75]
  ds_read_b128 v[252:255], v8 offset:15360
  v_add_f32 v60, v60, v29
  v_mfma_f32_16x16x32_bf16 v[76:79], a[148:151], v[236:239], v[76:79]
  v_add_f32 v61, v61, v30
  v_lshlrev_b32 v62, 16, v185
  v_mfma_f32_16x16x32_bf16 v[88:91], a[152:155], v[236:239], v[88:91]
  v_and_b32 v63, 0xffff0000, v185
  v_lshlrev_b32 v29, 16, v197
  v_mfma_f32_16x16x32_bf16 v[92:95], a[156:159], v[236:239], v[92:95]
  s_waitcnt lgkmcnt(3)
  v_and_b32 v30, 0xffff0000, v197
  v_add_f32 v62, v62, v29
  v_mfma_f32_16x16x32_bf16 v[64:67], a[160:163], v[240:243], v[64:67]
  ds_read_b128 v[216:219], v8 offset:32768
  v_add_f32 v63, v63, v30
  v_mfma_f32_16x16x32_bf16 v[68:71], a[164:167], v[240:243], v[68:71]
  v_mfma_f32_16x16x32_bf16 v[80:83], a[168:171], v[240:243], v[80:83]
  ds_read_b128 v[220:223], v8 offset:34816
  v_mfma_f32_16x16x32_bf16 v[84:87], a[172:175], v[240:243], v[84:87]
  s_waitcnt lgkmcnt(4)
  v_mfma_f32_16x16x32_bf16 v[72:75], a[160:163], v[244:247], v[72:75]
  ds_read_b128 v[224:227], v8 offset:33792
  v_mfma_f32_16x16x32_bf16 v[76:79], a[164:167], v[244:247], v[76:79]
  v_mfma_f32_16x16x32_bf16 v[88:91], a[168:171], v[244:247], v[88:91]
  ds_read_b128 v[228:231], v8 offset:35840
  v_mfma_f32_16x16x32_bf16 v[92:95], a[172:175], v[244:247], v[92:95]
  s_waitcnt lgkmcnt(5)
  v_mfma_f32_16x16x32_bf16 v[64:67], a[176:179], v[248:251], v[64:67]
  ds_read_b128 v[232:235], v8 offset:40960
  v_mfma_f32_16x16x32_bf16 v[68:71], a[180:183], v[248:251], v[68:71]
  v_mfma_f32_16x16x32_bf16 v[80:83], a[184:187], v[248:251], v[80:83]
  ds_read_b128 v[236:239], v8 offset:43008
  v_mfma_f32_16x16x32_bf16 v[84:87], a[188:191], v[248:251], v[84:87]
  s_waitcnt lgkmcnt(6)
  v_mfma_f32_16x16x32_bf16 v[72:75], a[176:179], v[252:255], v[72:75]
  ds_read_b128 v[240:243], v8 offset:41984
  v_mfma_f32_16x16x32_bf16 v[76:79], a[180:183], v[252:255], v[76:79]
  v_mfma_f32_16x16x32_bf16 v[88:91], a[184:187], v[252:255], v[88:91]
  ds_read_b128 v[244:247], v8 offset:44032
  v_mfma_f32_16x16x32_bf16 v[92:95], a[188:191], v[252:255], v[92:95]
  s_waitcnt lgkmcnt(7)
  v_mfma_f32_16x16x32_bf16 v[80:83], a[200:203], v[216:219], v[80:83]
  v_mfma_f32_16x16x32_bf16 v[84:87], a[204:207], v[216:219], v[84:87]
  s_waitcnt lgkmcnt(6)
  v_mfma_f32_16x16x32_bf16 v[88:91], a[200:203], v[220:223], v[88:91]
  v_mfma_f32_16x16x32_bf16 v[92:95], a[204:207], v[220:223], v[92:95]
  s_waitcnt lgkmcnt(5)
  v_mfma_f32_16x16x32_bf16 v[80:83], a[216:219], v[224:227], v[80:83]
  v_mfma_f32_16x16x32_bf16 v[84:87], a[220:223], v[224:227], v[84:87]
  s_waitcnt lgkmcnt(4)
  v_mfma_f32_16x16x32_bf16 v[88:91], a[216:219], v[228:231], v[88:91]
  v_mfma_f32_16x16x32_bf16 v[92:95], a[220:223], v[228:231], v[92:95]
  s_waitcnt lgkmcnt(3)
  buffer_load_dwordx4 v[200:203], v28, s[8:11], s17 offen sc1
  v_mfma_f32_16x16x32_bf16 v[80:83], a[232:235], v[232:235], v[80:83]
  v_mfma_f32_16x16x32_bf16 v[84:87], a[236:239], v[232:235], v[84:87]
  s_waitcnt lgkmcnt(2)
  v_mfma_f32_16x16x32_bf16 v[88:91], a[232:235], v[236:239], v[88:91]
  v_mfma_f32_16x16x32_bf16 v[92:95], a[236:239], v[236:239], v[92:95]
  s_waitcnt lgkmcnt(1)
  v_mfma_f32_16x16x32_bf16 v[80:83], a[248:251], v[240:243], v[80:83]
  v_mfma_f32_16x16x32_bf16 v[84:87], a[252:255], v[240:243], v[84:87]
  s_waitcnt lgkmcnt(0)
  buffer_load_dwordx4 v[204:207], v28, s[8:11], s17 offen offset:1024 sc1
  v_mfma_f32_16x16x32_bf16 v[88:91], a[248:251], v[244:247], v[88:91]
  v_mfma_f32_16x16x32_bf16 v[92:95], a[252:255], v[244:247], v[92:95]
  v_mfma_f32_16x16x32_bf16 v[64:67], a[192:195], v[216:219], v[64:67]
  v_mfma_f32_16x16x32_bf16 v[68:71], a[196:199], v[216:219], v[68:71]
  v_mfma_f32_16x16x32_bf16 v[72:75], a[192:195], v[220:223], v[72:75]
  v_mfma_f32_16x16x32_bf16 v[76:79], a[196:199], v[220:223], v[76:79]
  ds_write_b128 v4, v[80:83] offset:0
  buffer_load_dwordx4 v[208:211], v28, s[8:11], s17 offen offset:2048 sc1
  v_mfma_f32_16x16x32_bf16 v[64:67], a[208:211], v[224:227], v[64:67]
  ds_write_b128 v4, v[84:87] offset:1024
  v_mfma_f32_16x16x32_bf16 v[68:71], a[212:215], v[224:227], v[68:71]
  ds_write_b128 v4, v[88:91] offset:2048
  v_mfma_f32_16x16x32_bf16 v[72:75], a[208:211], v[228:231], v[72:75]
  ds_write_b128 v4, v[92:95] offset:3072
  v_mfma_f32_16x16x32_bf16 v[76:79], a[212:215], v[228:231], v[76:79]
  v_mfma_f32_16x16x32_bf16 v[64:67], a[224:227], v[232:235], v[64:67]
  v_mfma_f32_16x16x32_bf16 v[68:71], a[228:231], v[232:235], v[68:71]
  v_mfma_f32_16x16x32_bf16 v[72:75], a[224:227], v[236:239], v[72:75]
  s_waitcnt lgkmcnt(0)
  v_mfma_f32_16x16x32_bf16 v[76:79], a[228:231], v[236:239], v[76:79]
  s_barrier
  ds_read_b128 v[96:99], v5 offset:0
  v_mfma_f32_16x16x32_bf16 v[64:67], a[240:243], v[240:243], v[64:67]
  ds_read_b128 v[100:103], v5 offset:1024
  v_mfma_f32_16x16x32_bf16 v[68:71], a[244:247], v[240:243], v[68:71]
  ds_read_b128 v[104:107], v5 offset:2048
  v_mfma_f32_16x16x32_bf16 v[72:75], a[240:243], v[244:247], v[72:75]
  ds_read_b128 v[108:111], v5 offset:3072
  v_mfma_f32_16x16x32_bf16 v[76:79], a[244:247], v[244:247], v[76:79]
  s_waitcnt lgkmcnt(0)
  v_add_f32 v48, v48, v96
  v_add_f32 v49, v49, v97
  v_add_f32 v50, v50, v98
  v_add_f32 v51, v51, v99
  v_add_f32 v52, v52, v100
  v_add_f32 v53, v53, v101
  v_add_f32 v54, v54, v102
  v_add_f32 v55, v55, v103
  v_add_f32 v56, v56, v104
  v_add_f32 v57, v57, v105
  v_add_f32 v58, v58, v106
  v_add_f32 v59, v59, v107
  v_add_f32 v60, v60, v108
  v_add_f32 v61, v61, v109
  v_add_f32 v62, v62, v110
  v_add_f32 v63, v63, v111
  v_add_f32 v64, v64, v48
  v_add_f32 v65, v65, v49
  v_add_f32 v66, v66, v50
  v_add_f32 v67, v67, v51
  v_add_f32 v68, v68, v52
  v_add_f32 v69, v69, v53
  v_add_f32 v70, v70, v54
  v_add_f32 v71, v71, v55
  v_add_f32 v72, v72, v56
  v_add_f32 v73, v73, v57
  v_add_f32 v74, v74, v58
  v_add_f32 v75, v75, v59
  v_add_f32 v76, v76, v60
  v_add_f32 v77, v77, v61
  v_add_f32 v78, v78, v62
  v_add_f32 v79, v79, v63
  s_waitcnt vmcnt(0)
  v_min3_u32 v29, v203, v207, v211
  v_max3_u32 v30, v203, v207, v211
  v_min_u32 v29, s43, v29
  v_max_u32 v30, s43, v30
  v_cmp_ne_u32 vcc, v29, v30
  s_nop 0
  s_cbranch_vccnz L_spin29
L_back31:
  v_lshlrev_b32 v29, 16, v200
  v_and_b32 v30, 0xffff0000, v200
  v_add_f32 v64, v64, v29
  v_add_f32 v65, v65, v30
  v_lshlrev_b32 v29, 16, v201
  v_and_b32 v30, 0xffff0000, v201
  v_add_f32 v66, v66, v29
  v_add_f32 v67, v67, v30
  v_lshlrev_b32 v29, 16, v202
  v_and_b32 v30, 0xffff0000, v202
  v_add_f32 v68, v68, v29
  v_add_f32 v69, v69, v30
  v_lshlrev_b32 v29, 16, v204
  v_and_b32 v30, 0xffff0000, v204
  v_add_f32 v70, v70, v29
  v_add_f32 v71, v71, v30
  v_cvt_pk_bf16_f32 v29, v64, v65
  v_lshlrev_b32 v64, 16, v29
  v_and_b32 v65, 0xffff0000, v29
  v_mul_f32 v64, v64, v144
  v_mul_f32 v65, v65, v145
  v_cvt_pk_bf16_f32 v29, v64, v65
  v_lshlrev_b32 v64, 16, v29
  v_and_b32 v65, 0xffff0000, v29
  v_add_f32 v64, v64, v160
  v_add_f32 v65, v65, v161
  v_cvt_pk_bf16_f32 v128, v64, v65
  v_cvt_pk_bf16_f32 v29, v66, v67
  v_lshlrev_b32 v66, 16, v29
  v_and_b32 v67, 0xffff0000, v29
  v_mul_f32 v66, v66, v146
  v_mul_f32 v67, v67, v147
  v_cvt_pk_bf16_f32 v29, v66, v67
  v_lshlrev_b32 v66, 16, v29
  v_and_b32 v67, 0xffff0000, v29
  v_add_f32 v66, v66, v162
  v_add_f32 v67, v67, v163
  v_cvt_pk_bf16_f32 v129, v66, v67
  v_cvt_pk_bf16_f32 v29, v68, v69
  v_lshlrev_b32 v68, 16, v29
  v_and_b32 v69, 0xffff0000, v29
  v_mul_f32 v68, v68, v148
  v_mul_f32 v69, v69, v149
  v_cvt_pk_bf16_f32 v29, v68, v69
  v_lshlrev_b32 v68, 16, v29
  v_and_b32 v69, 0xffff0000, v29
  v_add_f32 v68, v68, v164
  v_add_f32 v69, v69, v165
  v_cvt_pk_bf16_f32 v130, v68, v69
  v_cvt_pk_bf16_f32 v29, v70, v71
  v_lshlrev_b32 v70, 16, v29
  v_and_b32 v71, 0xffff0000, v29
  v_mul_f32 v70, v70, v150
  v_mul_f32 v71, v71, v151
  v_cvt_pk_bf16_f32 v29, v70, v71
  v_lshlrev_b32 v70, 16, v29
  v_and_b32 v71, 0xffff0000, v29
  v_add_f32 v70, v70, v166
  v_add_f32 v71, v71, v167
  v_cvt_pk_bf16_f32 v131, v70, v71
  buffer_store_dwordx4 v[128:131], v24, s[12:15], 0 offen
  v_lshlrev_b32 v29, 16, v205
  v_and_b32 v30, 0xffff0000, v205
  v_add_f32 v72, v72, v29
  v_add_f32 v73, v73, v30
  v_lshlrev_b32 v29, 16, v206
  v_and_b32 v30, 0xffff0000, v206
  v_add_f32 v74, v74, v29
  v_add_f32 v75, v75, v30
  v_lshlrev_b32 v29, 16, v208
  v_and_b32 v30, 0xffff0000, v208
  v_add_f32 v76, v76, v29
  v_add_f32 v77, v77, v30
  v_lshlrev_b32 v29, 16, v209
  v_and_b32 v30, 0xffff0000, v209
  v_add_f32 v78, v78, v29
  v_add_f32 v79, v79, v30
  v_cvt_pk_bf16_f32 v29, v72, v73
  v_lshlrev_b32 v72, 16, v29
  v_and_b32 v73, 0xffff0000, v29
  v_mul_f32 v72, v72, v152
  v_mul_f32 v73, v73, v153
  v_cvt_pk_bf16_f32 v29, v72, v73
  v_lshlrev_b32 v72, 16, v29
  v_and_b32 v73, 0xffff0000, v29
  v_add_f32 v72, v72, v168
  v_add_f32 v73, v73, v169
  v_cvt_pk_bf16_f32 v132, v72, v73
  v_cvt_pk_bf16_f32 v29, v74, v75
  v_lshlrev_b32 v74, 16, v29
  v_and_b32 v75, 0xffff0000, v29
  v_mul_f32 v74, v74, v154
  v_mul_f32 v75, v75, v155
  v_cvt_pk_bf16_f32 v29, v74, v75
  v_lshlrev_b32 v74, 16, v29
  v_and_b32 v75, 0xffff0000, v29
  v_add_f32 v74, v74, v170
  v_add_f32 v75, v75, v171
  v_cvt_pk_bf16_f32 v133, v74, v75
  v_cvt_pk_bf16_f32 v29, v76, v77
  v_lshlrev_b32 v76, 16, v29
  v_and_b32 v77, 0xffff0000, v29
  v_mul_f32 v76, v76, v156
  v_mul_f32 v77, v77, v157
  v_cvt_pk_bf16_f32 v29, v76, v77
  v_lshlrev_b32 v76, 16, v29
  v_and_b32 v77, 0xffff0000, v29
  v_add_f32 v76, v76, v172
  v_add_f32 v77, v77, v173
  v_cvt_pk_bf16_f32 v134, v76, v77
  v_cvt_pk_bf16_f32 v29, v78, v79
  v_lshlrev_b32 v78, 16, v29
  v_and_b32 v79, 0xffff0000, v29
  v_mul_f32 v78, v78, v158
  v_mul_f32 v79, v79, v159
  v_cvt_pk_bf16_f32 v29, v78, v79
  v_lshlrev_b32 v78, 16, v29
  v_and_b32 v79, 0xffff0000, v29
  v_add_f32 v78, v78, v174
  v_add_f32 v79, v79, v175
  v_cvt_pk_bf16_f32 v135, v78, v79
  buffer_store_dwordx4 v[132:135], v25, s[12:15], 0 offen
L_end1:
  s_endpgm
  s_waitcnt vmcnt(0) lgkmcnt(0)
L_spin3:
  s_mov_b32 s42, 0
L_splp4:
  buffer_load_dword v105, v110, s[36:39], 0 offen sc1
  s_waitcnt vmcnt(0)
  v_cmp_eq_u32 vcc, 0, v105
  s_nop 1
  s_cbranch_vccz L_back5
  s_add_u32 s42, s42, 1
  s_cmp_lt_u32 s42, 0x40000
  s_cbranch_scc1 L_splp4
  s_branch L_back5
L_spin6:
  s_mov_b32 s42, 0
L_splp7:
  buffer_load_dwordx2 v[112:113], v111, s[8:11], s69 offen sc1
  buffer_load_dwordx2 v[114:115], v111, s[8:11], s69 offen offset:256 sc1
  buffer_load_dwordx2 v[116:117], v111, s[8:11], s69 offen offset:512 sc1
  buffer_load_dwordx2 v[118:119], v111, s[8:11], s69 offen offset:768 sc1
  s_waitcnt vmcnt(0)
  v_xor_b32 v104, s43, v113
  v_xor_b32 v105, s43, v115
  v_xor_b32 v107, s43, v117
  v_or3_b32 v104, v104, v105, v107
  v_xor_b32 v105, s43, v119
  v_or_b32 v104, v104, v105
  v_cmp_ne_u32 vcc, 0, v104
  s_nop 1
  s_cbranch_vccz L_back8
  s_add_u32 s42, s42, 1
  s_cmp_lt_u32 s42, 0x40000
  s_cbranch_scc1 L_splp7
  s_branch L_back8
L_spin9:
  s_mov_b32 s42, 0
L_splp10:
  buffer_load_dwordx4 v[104:107], v28, s[8:11], s50 offen sc1
  buffer_load_dwordx4 v[108:111], v28, s[8:11], s50 offen offset:1024 sc1
  buffer_load_dwordx4 v[112:115], v28, s[8:11], s50 offen offset:2048 sc1
  buffer_load_dwordx4 v[116:119], v28, s[8:11], s50 offen offset:3072 sc1
  s_waitcnt vmcnt(0)
  v_min3_u32 v0, v105, v107, v109
  v_max3_u32 v31, v105, v107, v109
  v_min3_u32 v0, v0, v111, v113
  v_max3_u32 v31, v31, v111, v113
  v_min3_u32 v0, v0, v115, v117
  v_max3_u32 v31, v31, v115, v117
  v_min3_u32 v0, v0, v119, s43
  v_max3_u32 v31, v31, v119, s43
  v_cmp_ne_u32 vcc, v0, v31
  s_nop 1
  s_cbranch_vccz L_back11
  s_add_u32 s42, s42, 1
  s_cmp_lt_u32 s42, 0x40000
  s_cbranch_scc1 L_splp10
  s_branch L_back11
L_spin12:
  s_mov_b32 s42, 0
L_splp13:
  buffer_load_dword v104, v105, s[8:11], s69 offen sc1
  s_waitcnt vmcnt(0)
  v_cmp_ne_u32 vcc, s3, v104
  s_nop 1
  s_cbranch_vccz L_back14
  s_add_u32 s42, s42, 1
  s_cmp_lt_u32 s42, 0x40000
  s_cbranch_scc1 L_splp13
  s_branch L_back14
L_slow15:
  s_waitcnt vmcnt(0)
  s_sub_u32 s61, s60, s50
  s_add_u32 s3, s44, 0
  s_and_b32 s3, s3, 3
  s_lshl_b32 s3, s3, 6
  v_lshlrev_b32 v8, 8, v3
  v_lshl_add_u32 v8, v2, 4, v8
  v_add_u32 v8, s3, v8
  s_add_u32 s3, s44, 1
  s_and_b32 s3, s3, 3
  s_lshl_b32 s3, s3, 6
  v_lshlrev_b32 v9, 8, v3
  v_lshl_add_u32 v9, v2, 4, v9
  v_add_u32 v9, s3, v9
  s_add_u32 s3, s44, 2
  s_and_b32 s3, s3, 3
  s_lshl_b32 s3, s3, 6
  v_lshlrev_b32 v10, 8, v3
  v_lshl_add_u32 v10, v2, 4, v10
  v_add_u32 v10, s3, v10
  s_add_u32 s3, s44, 3
  s_and_b32 s3, s3, 3
  s_lshl_b32 s3, s3, 6
  v_lshlrev_b32 v11, 8, v3
  v_lshl_add_u32 v11, v2, 4, v11
  v_add_u32 v11, s3, v11
  v_lshl_add_u32 v12, v2, 2, v29
  v_lshlrev_b32 v12, 8, v12
  v_lshl_add_u32 v12, v30, 3, v12
  v_add_u32 v12, s51, v12
  v_add_u32 v12, 65536, v12
  v_mov_b32 v104, 0xff800000
  v_mov_b32 v105, 0xff800000
  v_mov_b32 v106, 0xff800000
  v_mov_b32 v107, 0xff800000
  s_mov_b32 s59, s61
  s_mov_b32 s69, 0
L_sl117:
  s_add_u32 s3, s59, 0
  buffer_load_dwordx4 a[64:67], v8, s[16:19], s3 offen
  buffer_load_dwordx4 a[68:71], v9, s[16:19], s3 offen
  buffer_load_dwordx4 a[72:75], v10, s[16:19], s3 offen
  buffer_load_dwordx4 a[76:79], v11, s[16:19], s3 offen
  s_add_u32 s3, s59, 4096
  buffer_load_dwordx4 a[80:83], v8, s[16:19], s3 offen
  buffer_load_dwordx4 a[84:87], v9, s[16:19], s3 offen
  buffer_load_dwordx4 a[88:91], v10, s[16:19], s3 offen
  buffer_load_dwordx4 a[92:95], v11, s[16:19], s3 offen
  s_waitcnt vmcnt(0)
  v_mfma_f32_16x16x32_bf16 v[32:35], a[64:67], a[0:3], 0
  v_mfma_f32_16x16x32_bf16 v[32:35], a[68:71], a[4:7], v[32:35]
  v_mfma_f32_16x16x32_bf16 v[32:35], a[72:75], a[8:11], v[32:35]
  v_mfma_f32_16x16x32_bf16 v[32:35], a[76:79], a[12:15], v[32:35]
  v_mfma_f32_16x16x32_bf16 v[36:39], a[80:83], a[0:3], 0
  v_mfma_f32_16x16x32_bf16 v[36:39], a[84:87], a[4:7], v[36:39]
  v_mfma_f32_16x16x32_bf16 v[36:39], a[88:91], a[8:11], v[36:39]
  v_mfma_f32_16x16x32_bf16 v[36:39], a[92:95], a[12:15], v[36:39]
  v_mfma_f32_16x16x32_bf16 v[40:43], a[64:67], a[16:19], 0
  v_mfma_f32_16x16x32_bf16 v[40:43], a[68:71], a[20:23], v[40:43]
  v_mfma_f32_16x16x32_bf16 v[40:43], a[72:75], a[24:27], v[40:43]
  v_mfma_f32_16x16x32_bf16 v[40:43], a[76:79], a[28:31], v[40:43]
  v_mfma_f32_16x16x32_bf16 v[44:47], a[80:83], a[16:19], 0
  v_mfma_f32_16x16x32_bf16 v[44:47], a[84:87], a[20:23], v[44:47]
  v_mfma_f32_16x16x32_bf16 v[44:47], a[88:91], a[24:27], v[44:47]
  v_mfma_f32_16x16x32_bf16 v[44:47], a[92:95], a[28:31], v[44:47]
  v_mfma_f32_16x16x32_bf16 v[96:99], a[64:67], a[32:35], 0
  v_mfma_f32_16x16x32_bf16 v[96:99], a[68:71], a[36:39], v[96:99]
  v_mfma_f32_16x16x32_bf16 v[96:99], a[72:75], a[40:43], v[96:99]
  v_mfma_f32_16x16x32_bf16 v[96:99], a[76:79], a[44:47], v[96:99]
  v_mfma_f32_16x16x32_bf16 v[100:103], a[80:83], a[32:35], 0
  v_mfma_f32_16x16x32_bf16 v[100:103], a[84:87], a[36:39], v[100:103]
  v_mfma_f32_16x16x32_bf16 v[100:103], a[88:91], a[40:43], v[100:103]
  v_mfma_f32_16x16x32_bf16 v[100:103], a[92:95], a[44:47], v[100:103]
  v_mfma_f32_16x16x32_bf16 v[112:115], a[64:67], a[48:51], 0
  v_mfma_f32_16x16x32_bf16 v[112:115], a[68:71], a[52:55], v[112:115]
  v_mfma_f32_16x16x32_bf16 v[112:115], a[72:75], a[56:59], v[112:115]
  v_mfma_f32_16x16x32_bf16 v[112:115], a[76:79], a[60:63], v[112:115]
  v_mfma_f32_16x16x32_bf16 v[116:119], a[80:83], a[48:51], 0
  v_mfma_f32_16x16x32_bf16 v[116:119], a[84:87], a[52:55], v[116:119]
  v_mfma_f32_16x16x32_bf16 v[116:119], a[88:91], a[56:59], v[116:119]
  v_mfma_f32_16x16x32_bf16 v[116:119], a[92:95], a[60:63], v[116:119]
  s_nop 7
  v_max3_f32 v104, v104, v32, v33
  v_max3_f32 v104, v104, v34, v35
  v_max3_f32 v104, v104, v36, v37
  v_max3_f32 v104, v104, v38, v39
  v_max3_f32 v105, v105, v40, v41
  v_max3_f32 v105, v105, v42, v43
  v_max3_f32 v105, v105, v44, v45
  v_max3_f32 v105, v105, v46, v47
  v_max3_f32 v106, v106, v96, v97
  v_max3_f32 v106, v106, v98, v99
  v_max3_f32 v106, v106, v100, v101
  v_max3_f32 v106, v106, v102, v103
  v_max3_f32 v107, v107, v112, v113
  v_max3_f32 v107, v107, v114, v115
  v_max3_f32 v107, v107, v116, v117
  v_max3_f32 v107, v107, v118, v119
  s_add_u32 s59, s59, 8192
  s_add_u32 s69, s69, 1
  s_cmp_lt_u32 s69, 16
  s_cbranch_scc1 L_sl117
  v_mov_b32 v108, v104
  s_nop 1
  v_permlane32_swap_b32 v104, v108
  v_max_f32 v104, v104, v108
  v_mov_b32 v108, v104
  s_nop 1
  v_permlane16_swap_b32 v104, v108
  v_max_f32 v104, v104, v108
  v_sub_f32 v80, 0, v104
  v_sub_f32 v81, 0, v104
  v_sub_f32 v82, 0, v104
  v_sub_f32 v83, 0, v104
  v_mov_b32 v108, v105
  s_nop 1
  v_permlane32_swap_b32 v105, v108
  v_max_f32 v105, v105, v108
  v_mov_b32 v108, v105
  s_nop 1
  v_permlane16_swap_b32 v105, v108
  v_max_f32 v105, v105, v108
  v_sub_f32 v84, 0, v105
  v_sub_f32 v85, 0, v105
  v_sub_f32 v86, 0, v105
  v_sub_f32 v87, 0, v105
  v_mov_b32 v108, v106
  s_nop 1
  v_permlane32_swap_b32 v106, v108
  v_max_f32 v106, v106, v108
  v_mov_b32 v108, v106
  s_nop 1
  v_permlane16_swap_b32 v106, v108
  v_max_f32 v106, v106, v108
  v_sub_f32 v88, 0, v106
  v_sub_f32 v89, 0, v106
  v_sub_f32 v90, 0, v106
  v_sub_f32 v91, 0, v106
  v_mov_b32 v108, v107
  s_nop 1
  v_permlane32_swap_b32 v107, v108
  v_max_f32 v107, v107, v108
  v_mov_b32 v108, v107
  s_nop 1
  v_permlane16_swap_b32 v107, v108
  v_max_f32 v107, v107, v108
  v_sub_f32 v92, 0, v107
  v_sub_f32 v93, 0, v107
  v_sub_f32 v94, 0, v107
  v_sub_f32 v95, 0, v107
  v_mov_b32 v48, 0
  v_mov_b32 v49, 0
  v_mov_b32 v50, 0
  v_mov_b32 v51, 0
  v_mov_b32 v52, 0
  v_mov_b32 v53, 0
  v_mov_b32 v54, 0
  v_mov_b32 v55, 0
  v_mov_b32 v56, 0
  v_mov_b32 v57, 0
  v_mov_b32 v58, 0
  v_mov_b32 v59, 0
  v_mov_b32 v60, 0
  v_mov_b32 v61, 0
  v_mov_b32 v62, 0
  v_mov_b32 v63, 0
  v_mov_b32 v128, 0
  v_mov_b32 v129, 0
  v_mov_b32 v130, 0
  v_mov_b32 v131, 0
  v_mov_b32 v132, 0
  v_mov_b32 v133, 0
  v_mov_b32 v134, 0
  v_mov_b32 v135, 0
  v_mov_b32 v136, 0
  v_mov_b32 v137, 0
  v_mov_b32 v138, 0
  v_mov_b32 v139, 0
  v_mov_b32 v140, 0
  v_mov_b32 v141, 0
  v_mov_b32 v142, 0
  v_mov_b32 v143, 0
  v_mov_b32 v144, 0
  v_mov_b32 v145, 0
  v_mov_b32 v146, 0
  v_mov_b32 v147, 0
  v_mov_b32 v148, 0
  v_mov_b32 v149, 0
  v_mov_b32 v150, 0
  v_mov_b32 v151, 0
  v_mov_b32 v152, 0
  v_mov_b32 v153, 0
  v_mov_b32 v154, 0
  v_mov_b32 v155, 0
  v_mov_b32 v156, 0
  v_mov_b32 v157, 0
  v_mov_b32 v158, 0
  v_mov_b32 v159, 0
  v_mov_b32 v160, 0
  v_mov_b32 v161, 0
  v_mov_b32 v162, 0
  v_mov_b32 v163, 0
  v_mov_b32 v164, 0
  v_mov_b32 v165, 0
  v_mov_b32 v166, 0
  v_mov_b32 v167, 0
  v_mov_b32 v168, 0
  v_mov_b32 v169, 0
  v_mov_b32 v170, 0
  v_mov_b32 v171, 0
  v_mov_b32 v172, 0
  v_mov_b32 v173, 0
  v_mov_b32 v174, 0
  v_mov_b32 v175, 0
  v_mov_b32 v176, 0
  v_mov_b32 v177, 0
  v_mov_b32 v178, 0
  v_mov_b32 v179, 0
  v_mov_b32 v180, 0
  v_mov_b32 v181, 0
  v_mov_b32 v182, 0
  v_mov_b32 v183, 0
  v_mov_b32 v184, 0
  v_mov_b32 v185, 0
  v_mov_b32 v186, 0
  v_mov_b32 v187, 0
  v_mov_b32 v188, 0
  v_mov_b32 v189, 0
  v_mov_b32 v190, 0
  v_mov_b32 v191, 0
  v_mov_b32 v192, 0
  v_mov_b32 v193, 0
  v_mov_b32 v194, 0
  v_mov_b32 v195, 0
  v_mov_b32 v196, 0
  v_mov_b32 v197, 0
  v_mov_b32 v198, 0
  v_mov_b32 v199, 0
  v_mov_b32 v200, 0
  v_mov_b32 v201, 0
  v_mov_b32 v202, 0
  v_mov_b32 v203, 0
  v_mov_b32 v204, 0
  v_mov_b32 v205, 0
  v_mov_b32 v206, 0
  v_mov_b32 v207, 0
  v_mov_b32 v208, 0
  v_mov_b32 v209, 0
  v_mov_b32 v210, 0
  v_mov_b32 v211, 0
  v_mov_b32 v212, 0
  v_mov_b32 v213, 0
  v_mov_b32 v214, 0
  v_mov_b32 v215, 0
  v_mov_b32 v216, 0
  v_mov_b32 v217, 0
  v_mov_b32 v218, 0
  v_mov_b32 v219, 0
  v_mov_b32 v220, 0
  v_mov_b32 v221, 0
  v_mov_b32 v222, 0
  v_mov_b32 v223, 0
  v_mov_b32 v224, 0
  v_mov_b32 v225, 0
  v_mov_b32 v226, 0
  v_mov_b32 v227, 0
  v_mov_b32 v228, 0
  v_mov_b32 v229, 0
  v_mov_b32 v230, 0
  v_mov_b32 v231, 0
  v_mov_b32 v232, 0
  v_mov_b32 v233, 0
  v_mov_b32 v234, 0
  v_mov_b32 v235, 0
  v_mov_b32 v236, 0
  v_mov_b32 v237, 0
  v_mov_b32 v238, 0
  v_mov_b32 v239, 0
  v_mov_b32 v240, 0
  v_mov_b32 v241, 0
  v_mov_b32 v242, 0
  v_mov_b32 v243, 0
  v_mov_b32 v244, 0
  v_mov_b32 v245, 0
  v_mov_b32 v246, 0
  v_mov_b32 v247, 0
  v_mov_b32 v248, 0
  v_mov_b32 v249, 0
  v_mov_b32 v250, 0
  v_mov_b32 v251, 0
  v_mov_b32 v252, 0
  v_mov_b32 v253, 0
  v_mov_b32 v254, 0
  v_mov_b32 v255, 0
  s_mov_b32 s59, s61
  s_mov_b32 s69, 0
L_sl218:
  s_add_u32 s3, s59, 0
  buffer_load_dwordx4 a[64:67], v8, s[16:19], s3 offen
  buffer_load_dwordx4 a[68:71], v9, s[16:19], s3 offen
  buffer_load_dwordx4 a[72:75], v10, s[16:19], s3 offen
  buffer_load_dwordx4 a[76:79], v11, s[16:19], s3 offen
  s_add_u32 s3, s59, 4096
  buffer_load_dwordx4 a[80:83], v8, s[16:19], s3 offen
  buffer_load_dwordx4 a[84:87], v9, s[16:19], s3 offen
  buffer_load_dwordx4 a[88:91], v10, s[16:19], s3 offen
  buffer_load_dwordx4 a[92:95], v11, s[16:19], s3 offen
  s_add_u32 m0, s51, 65536
  s_add_u32 s3, s59, 0
  buffer_load_dwordx4 v28, s[20:23], s3 offen lds
  buffer_load_dwordx4 v28, s[20:23], s3 offen offset:1024 lds
  buffer_load_dwordx4 v28, s[20:23], s3 offen offset:2048 lds
  buffer_load_dwordx4 v28, s[20:23], s3 offen offset:3072 lds
  s_add_u32 m0, s51, 69632
  s_add_u32 s3, s59, 4096
  buffer_load_dwordx4 v28, s[20:23], s3 offen lds
  buffer_load_dwordx4 v28, s[20:23], s3 offen offset:1024 lds
  buffer_load_dwordx4 v28, s[20:23], s3 offen offset:2048 lds
  buffer_load_dwordx4 v28, s[20:23], s3 offen offset:3072 lds
  s_waitcnt vmcnt(0)
  ds_read_b64_tr_b16 a[128:129], v12 offset:0
  ds_read_b64_tr_b16 a[130:131], v12 offset:4096
  ds_read_b64_tr_b16 a[132:133], v12 offset:32
  ds_read_b64_tr_b16 a[134:135], v12 offset:4128
  ds_read_b64_tr_b16 a[136:137], v12 offset:64
  ds_read_b64_tr_b16 a[138:139], v12 offset:4160
  ds_read_b64_tr_b16 a[140:141], v12 offset:96
  ds_read_b64_tr_b16 a[142:143], v12 offset:4192
  s_waitcnt lgkmcnt(0)
  ds_read_b64_tr_b16 a[144:145], v12 offset:128
  ds_read_b64_tr_b16 a[146:147], v12 offset:4224
  ds_read_b64_tr_b16 a[148:149], v12 offset:160
  ds_read_b64_tr_b16 a[150:151], v12 offset:4256
  ds_read_b64_tr_b16 a[152:153], v12 offset:192
  ds_read_b64_tr_b16 a[154:155], v12 offset:4288
  ds_read_b64_tr_b16 a[156:157], v12 offset:224
  ds_read_b64_tr_b16 a[158:159], v12 offset:4320
  v_mfma_f32_16x16x32_bf16 v[32:35], a[64:67], a[0:3], v[80:83]
  v_mfma_f32_16x16x32_bf16 v[32:35], a[68:71], a[4:7], v[32:35]
  v_mfma_f32_16x16x32_bf16 v[32:35], a[72:75], a[8:11], v[32:35]
  v_mfma_f32_16x16x32_bf16 v[32:35], a[76:79], a[12:15], v[32:35]
  v_mfma_f32_16x16x32_bf16 v[36:39], a[80:83], a[0:3], v[80:83]
  v_mfma_f32_16x16x32_bf16 v[36:39], a[84:87], a[4:7], v[36:39]
  v_mfma_f32_16x16x32_bf16 v[36:39], a[88:91], a[8:11], v[36:39]
  v_mfma_f32_16x16x32_bf16 v[36:39], a[92:95], a[12:15], v[36:39]
  v_mfma_f32_16x16x32_bf16 v[40:43], a[64:67], a[16:19], v[84:87]
  v_mfma_f32_16x16x32_bf16 v[40:43], a[68:71], a[20:23], v[40:43]
  v_mfma_f32_16x16x32_bf16 v[40:43], a[72:75], a[24:27], v[40:43]
  v_mfma_f32_16x16x32_bf16 v[40:43], a[76:79], a[28:31], v[40:43]
  v_mfma_f32_16x16x32_bf16 v[44:47], a[80:83], a[16:19], v[84:87]
  v_mfma_f32_16x16x32_bf16 v[44:47], a[84:87], a[20:23], v[44:47]
  v_mfma_f32_16x16x32_bf16 v[44:47], a[88:91], a[24:27], v[44:47]
  v_mfma_f32_16x16x32_bf16 v[44:47], a[92:95], a[28:31], v[44:47]
  v_mfma_f32_16x16x32_bf16 v[96:99], a[64:67], a[32:35], v[88:91]
  v_mfma_f32_16x16x32_bf16 v[96:99], a[68:71], a[36:39], v[96:99]
  v_mfma_f32_16x16x32_bf16 v[96:99], a[72:75], a[40:43], v[96:99]
  v_mfma_f32_16x16x32_bf16 v[96:99], a[76:79], a[44:47], v[96:99]
  v_mfma_f32_16x16x32_bf16 v[100:103], a[80:83], a[32:35], v[88:91]
  v_mfma_f32_16x16x32_bf16 v[100:103], a[84:87], a[36:39], v[100:103]
  v_mfma_f32_16x16x32_bf16 v[100:103], a[88:91], a[40:43], v[100:103]
  v_mfma_f32_16x16x32_bf16 v[100:103], a[92:95], a[44:47], v[100:103]
  v_mfma_f32_16x16x32_bf16 v[112:115], a[64:67], a[48:51], v[92:95]
  v_mfma_f32_16x16x32_bf16 v[112:115], a[68:71], a[52:55], v[112:115]
  v_mfma_f32_16x16x32_bf16 v[112:115], a[72:75], a[56:59], v[112:115]
  v_mfma_f32_16x16x32_bf16 v[112:115], a[76:79], a[60:63], v[112:115]
  v_mfma_f32_16x16x32_bf16 v[116:119], a[80:83], a[48:51], v[92:95]
  v_mfma_f32_16x16x32_bf16 v[116:119], a[84:87], a[52:55], v[116:119]
  v_mfma_f32_16x16x32_bf16 v[116:119], a[88:91], a[56:59], v[116:119]
  v_mfma_f32_16x16x32_bf16 v[116:119], a[92:95], a[60:63], v[116:119]
  s_nop 7
  v_exp_f32 v32, v32
  v_exp_f32 v33, v33
  v_exp_f32 v34, v34
  v_exp_f32 v35, v35
  v_exp_f32 v36, v36
  v_exp_f32 v37, v37
  v_exp_f32 v38, v38
  v_exp_f32 v39, v39
  v_cvt_pk_bf16_f32 v64, v32, v33
  v_cvt_pk_bf16_f32 v65, v34, v35
  v_cvt_pk_bf16_f32 v66, v36, v37
  v_cvt_pk_bf16_f32 v67, v38, v39
  v_exp_f32 v40, v40
  v_exp_f32 v41, v41
  v_exp_f32 v42, v42
  v_exp_f32 v43, v43
  v_exp_f32 v44, v44
  v_exp_f32 v45, v45
  v_exp_f32 v46, v46
  v_exp_f32 v47, v47
  v_cvt_pk_bf16_f32 v68, v40, v41
  v_cvt_pk_bf16_f32 v69, v42, v43
  v_cvt_pk_bf16_f32 v70, v44, v45
  v_cvt_pk_bf16_f32 v71, v46, v47
  v_exp_f32 v96, v96
  v_exp_f32 v97, v97
  v_exp_f32 v98, v98
  v_exp_f32 v99, v99
  v_exp_f32 v100, v100
  v_exp_f32 v101, v101
  v_exp_f32 v102, v102
  v_exp_f32 v103, v103
  v_cvt_pk_bf16_f32 v72, v96, v97
  v_cvt_pk_bf16_f32 v73, v98, v99
  v_cvt_pk_bf16_f32 v74, v100, v101
  v_cvt_pk_bf16_f32 v75, v102, v103
  v_exp_f32 v112, v112
  v_exp_f32 v113, v113
  v_exp_f32 v114, v114
  v_exp_f32 v115, v115
  v_exp_f32 v116, v116
  v_exp_f32 v117, v117
  v_exp_f32 v118, v118
  v_exp_f32 v119, v119
  v_cvt_pk_bf16_f32 v76, v112, v113
  v_cvt_pk_bf16_f32 v77, v114, v115
  v_cvt_pk_bf16_f32 v78, v116, v117
  v_cvt_pk_bf16_f32 v79, v118, v119
  s_waitcnt lgkmcnt(0)
  s_nop 1
  v_mfma_f32_16x16x32_bf16 v[128:131], a[128:131], v[64:67], v[128:131]
  v_mfma_f32_16x16x32_bf16 v[144:147], a[132:135], v[64:67], v[144:147]
  v_mfma_f32_16x16x32_bf16 v[160:163], a[136:139], v[64:67], v[160:163]
  v_mfma_f32_16x16x32_bf16 v[176:179], a[140:143], v[64:67], v[176:179]
  v_mfma_f32_16x16x32_bf16 v[192:195], a[144:147], v[64:67], v[192:195]
  v_mfma_f32_16x16x32_bf16 v[208:211], a[148:151], v[64:67], v[208:211]
  v_mfma_f32_16x16x32_bf16 v[224:227], a[152:155], v[64:67], v[224:227]
  v_mfma_f32_16x16x32_bf16 v[240:243], a[156:159], v[64:67], v[240:243]
  v_mfma_f32_16x16x32_bf16 v[48:51], v[124:127], v[64:67], v[48:51]
  v_mfma_f32_16x16x32_bf16 v[132:135], a[128:131], v[68:71], v[132:135]
  v_mfma_f32_16x16x32_bf16 v[148:151], a[132:135], v[68:71], v[148:151]
  v_mfma_f32_16x16x32_bf16 v[164:167], a[136:139], v[68:71], v[164:167]
  v_mfma_f32_16x16x32_bf16 v[180:183], a[140:143], v[68:71], v[180:183]
  v_mfma_f32_16x16x32_bf16 v[196:199], a[144:147], v[68:71], v[196:199]
  v_mfma_f32_16x16x32_bf16 v[212:215], a[148:151], v[68:71], v[212:215]
  v_mfma_f32_16x16x32_bf16 v[228:231], a[152:155], v[68:71], v[228:231]
  v_mfma_f32_16x16x32_bf16 v[244:247], a[156:159], v[68:71], v[244:247]
  v_mfma_f32_16x16x32_bf16 v[52:55], v[124:127], v[68:71], v[52:55]
  v_mfma_f32_16x16x32_bf16 v[136:139], a[128:131], v[72:75], v[136:139]
  v_mfma_f32_16x16x32_bf16 v[152:155], a[132:135], v[72:75], v[152:155]
  v_mfma_f32_16x16x32_bf16 v[168:171], a[136:139], v[72:75], v[168:171]
  v_mfma_f32_16x16x32_bf16 v[184:187], a[140:143], v[72:75], v[184:187]
  v_mfma_f32_16x16x32_bf16 v[200:203], a[144:147], v[72:75], v[200:203]
  v_mfma_f32_16x16x32_bf16 v[216:219], a[148:151], v[72:75], v[216:219]
  v_mfma_f32_16x16x32_bf16 v[232:235], a[152:155], v[72:75], v[232:235]
  v_mfma_f32_16x16x32_bf16 v[248:251], a[156:159], v[72:75], v[248:251]
  v_mfma_f32_16x16x32_bf16 v[56:59], v[124:127], v[72:75], v[56:59]
  v_mfma_f32_16x16x32_bf16 v[140:143], a[128:131], v[76:79], v[140:143]
  v_mfma_f32_16x16x32_bf16 v[156:159], a[132:135], v[76:79], v[156:159]
  v_mfma_f32_16x16x32_bf16 v[172:175], a[136:139], v[76:79], v[172:175]
  v_mfma_f32_16x16x32_bf16 v[188:191], a[140:143], v[76:79], v[188:191]
  v_mfma_f32_16x16x32_bf16 v[204:207], a[144:147], v[76:79], v[204:207]
  v_mfma_f32_16x16x32_bf16 v[220:223], a[148:151], v[76:79], v[220:223]
  v_mfma_f32_16x16x32_bf16 v[236:239], a[152:155], v[76:79], v[236:239]
  v_mfma_f32_16x16x32_bf16 v[252:255], a[156:159], v[76:79], v[252:255]
  v_mfma_f32_16x16x32_bf16 v[60:63], v[124:127], v[76:79], v[60:63]
  s_add_u32 s59, s59, 8192
  s_add_u32 s69, s69, 1
  s_cmp_lt_u32 s69, 16
  s_cbranch_scc1 L_sl218
  s_nop 7
  v_rcp_f32 v104, v48
  s_nop 0
  v_mul_f32 v128, v128, v104
  v_mul_f32 v129, v129, v104
  v_mul_f32 v130, v130, v104
  v_mul_f32 v131, v131, v104
  v_mul_f32 v144, v144, v104
  v_mul_f32 v145, v145, v104
  v_mul_f32 v146, v146, v104
  v_mul_f32 v147, v147, v104
  v_cvt_pk_bf16_f32 v128, v128, v129
  v_cvt_pk_bf16_f32 v129, v130, v131
  v_cvt_pk_bf16_f32 v130, v144, v145
  v_cvt_pk_bf16_f32 v131, v146, v147
  s_add_u32 s66, s65, 0
  buffer_store_dwordx4 v[128:131], v28, s[8:11], s66 offen sc1
  v_mul_f32 v160, v160, v104
  v_mul_f32 v161, v161, v104
  v_mul_f32 v162, v162, v104
  v_mul_f32 v163, v163, v104
  v_mul_f32 v176, v176, v104
  v_mul_f32 v177, v177, v104
  v_mul_f32 v178, v178, v104
  v_mul_f32 v179, v179, v104
  v_cvt_pk_bf16_f32 v160, v160, v161
  v_cvt_pk_bf16_f32 v161, v162, v163
  v_cvt_pk_bf16_f32 v162, v176, v177
  v_cvt_pk_bf16_f32 v163, v178, v179
  buffer_store_dwordx4 v[160:163], v28, s[8:11], s66 offen offset:1024 sc1
  v_mul_f32 v192, v192, v104
  v_mul_f32 v193, v193, v104
  v_mul_f32 v194, v194, v104
  v_mul_f32 v195, v195, v104
  v_mul_f32 v208, v208, v104
  v_mul_f32 v209, v209, v104
  v_mul_f32 v210, v210, v104
  v_mul_f32 v211, v211, v104
  v_cvt_pk_bf16_f32 v192, v192, v193
  v_cvt_pk_bf16_f32 v193, v194, v195
  v_cvt_pk_bf16_f32 v194, v208, v209
  v_cvt_pk_bf16_f32 v195, v210, v211
  buffer_store_dwordx4 v[192:195], v28, s[8:11], s66 offen offset:2048 sc1
  v_mul_f32 v224, v224, v104
  v_mul_f32 v225, v225, v104
  v_mul_f32 v226, v226, v104
  v_mul_f32 v227, v227, v104
  v_mul_f32 v240, v240, v104
  v_mul_f32 v241, v241, v104
  v_mul_f32 v242, v242, v104
  v_mul_f32 v243, v243, v104
  v_cvt_pk_bf16_f32 v224, v224, v225
  v_cvt_pk_bf16_f32 v225, v226, v227
  v_cvt_pk_bf16_f32 v226, v240, v241
  v_cvt_pk_bf16_f32 v227, v242, v243
  buffer_store_dwordx4 v[224:227], v28, s[8:11], s66 offen offset:3072 sc1
  v_rcp_f32 v106, v52
  s_nop 0
  v_mul_f32 v132, v132, v106
  v_mul_f32 v133, v133, v106
  v_mul_f32 v134, v134, v106
  v_mul_f32 v135, v135, v106
  v_mul_f32 v148, v148, v106
  v_mul_f32 v149, v149, v106
  v_mul_f32 v150, v150, v106
  v_mul_f32 v151, v151, v106
  v_cvt_pk_bf16_f32 v132, v132, v133
  v_cvt_pk_bf16_f32 v133, v134, v135
  v_cvt_pk_bf16_f32 v134, v148, v149
  v_cvt_pk_bf16_f32 v135, v150, v151
  s_add_u32 s66, s65, 4096
  buffer_store_dwordx4 v[132:135], v28, s[8:11], s66 offen sc1
  v_mul_f32 v164, v164, v106
  v_mul_f32 v165, v165, v106
  v_mul_f32 v166, v166, v106
  v_mul_f32 v167, v167, v106
  v_mul_f32 v180, v180, v106
  v_mul_f32 v181, v181, v106
  v_mul_f32 v182, v182, v106
  v_mul_f32 v183, v183, v106
  v_cvt_pk_bf16_f32 v164, v164, v165
  v_cvt_pk_bf16_f32 v165, v166, v167
  v_cvt_pk_bf16_f32 v166, v180, v181
  v_cvt_pk_bf16_f32 v167, v182, v183
  buffer_store_dwordx4 v[164:167], v28, s[8:11], s66 offen offset:1024 sc1
  v_mul_f32 v196, v196, v106
  v_mul_f32 v197, v197, v106
  v_mul_f32 v198, v198, v106
  v_mul_f32 v199, v199, v106
  v_mul_f32 v212, v212, v106
  v_mul_f32 v213, v213, v106
  v_mul_f32 v214, v214, v106
  v_mul_f32 v215, v215, v106
  v_cvt_pk_bf16_f32 v196, v196, v197
  v_cvt_pk_bf16_f32 v197, v198, v199
  v_cvt_pk_bf16_f32 v198, v212, v213
  v_cvt_pk_bf16_f32 v199, v214, v215
  buffer_store_dwordx4 v[196:199], v28, s[8:11], s66 offen offset:2048 sc1
  v_mul_f32 v228, v228, v106
  v_mul_f32 v229, v229, v106
  v_mul_f32 v230, v230, v106
  v_mul_f32 v231, v231, v106
  v_mul_f32 v244, v244, v106
  v_mul_f32 v245, v245, v106
  v_mul_f32 v246, v246, v106
  v_mul_f32 v247, v247, v106
  v_cvt_pk_bf16_f32 v228, v228, v229
  v_cvt_pk_bf16_f32 v229, v230, v231
  v_cvt_pk_bf16_f32 v230, v244, v245
  v_cvt_pk_bf16_f32 v231, v246, v247
  buffer_store_dwordx4 v[228:231], v28, s[8:11], s66 offen offset:3072 sc1
  v_rcp_f32 v108, v56
  s_nop 0
  v_mul_f32 v136, v136, v108
  v_mul_f32 v137, v137, v108
  v_mul_f32 v138, v138, v108
  v_mul_f32 v139, v139, v108
  v_mul_f32 v152, v152, v108
  v_mul_f32 v153, v153, v108
  v_mul_f32 v154, v154, v108
  v_mul_f32 v155, v155, v108
  v_cvt_pk_bf16_f32 v136, v136, v137
  v_cvt_pk_bf16_f32 v137, v138, v139
  v_cvt_pk_bf16_f32 v138, v152, v153
  v_cvt_pk_bf16_f32 v139, v154, v155
  s_add_u32 s66, s65, 8192
  buffer_store_dwordx4 v[136:139], v28, s[8:11], s66 offen sc1
  v_mul_f32 v168, v168, v108
  v_mul_f32 v169, v169, v108
  v_mul_f32 v170, v170, v108
  v_mul_f32 v171, v171, v108
  v_mul_f32 v184, v184, v108
  v_mul_f32 v185, v185, v108
  v_mul_f32 v186, v186, v108
  v_mul_f32 v187, v187, v108
  v_cvt_pk_bf16_f32 v168, v168, v169
  v_cvt_pk_bf16_f32 v169, v170, v171
  v_cvt_pk_bf16_f32 v170, v184, v185
  v_cvt_pk_bf16_f32 v171, v186, v187
  buffer_store_dwordx4 v[168:171], v28, s[8:11], s66 offen offset:1024 sc1
  v_mul_f32 v200, v200, v108
  v_mul_f32 v201, v201, v108
  v_mul_f32 v202, v202, v108
  v_mul_f32 v203, v203, v108
  v_mul_f32 v216, v216, v108
  v_mul_f32 v217, v217, v108
  v_mul_f32 v218, v218, v108
  v_mul_f32 v219, v219, v108
  v_cvt_pk_bf16_f32 v200, v200, v201
  v_cvt_pk_bf16_f32 v201, v202, v203
  v_cvt_pk_bf16_f32 v202, v216, v217
  v_cvt_pk_bf16_f32 v203, v218, v219
  buffer_store_dwordx4 v[200:203], v28, s[8:11], s66 offen offset:2048 sc1
  v_mul_f32 v232, v232, v108
  v_mul_f32 v233, v233, v108
  v_mul_f32 v234, v234, v108
  v_mul_f32 v235, v235, v108
  v_mul_f32 v248, v248, v108
  v_mul_f32 v249, v249, v108
  v_mul_f32 v250, v250, v108
  v_mul_f32 v251, v251, v108
  v_cvt_pk_bf16_f32 v232, v232, v233
  v_cvt_pk_bf16_f32 v233, v234, v235
  v_cvt_pk_bf16_f32 v234, v248, v249
  v_cvt_pk_bf16_f32 v235, v250, v251
  buffer_store_dwordx4 v[232:235], v28, s[8:11], s66 offen offset:3072 sc1
  v_rcp_f32 v110, v60
  s_nop 0
  v_mul_f32 v140, v140, v110
  v_mul_f32 v141, v141, v110
  v_mul_f32 v142, v142, v110
  v_mul_f32 v143, v143, v110
  v_mul_f32 v156, v156, v110
  v_mul_f32 v157, v157, v110
  v_mul_f32 v158, v158, v110
  v_mul_f32 v159, v159, v110
  v_cvt_pk_bf16_f32 v140, v140, v141
  v_cvt_pk_bf16_f32 v141, v142, v143
  v_cvt_pk_bf16_f32 v142, v156, v157
  v_cvt_pk_bf16_f32 v143, v158, v159
  s_add_u32 s66, s65, 12288
  buffer_store_dwordx4 v[140:143], v28, s[8:11], s66 offen sc1
  v_mul_f32 v172, v172, v110
  v_mul_f32 v173, v173, v110
  v_mul_f32 v174, v174, v110
  v_mul_f32 v175, v175, v110
  v_mul_f32 v188, v188, v110
  v_mul_f32 v189, v189, v110
  v_mul_f32 v190, v190, v110
  v_mul_f32 v191, v191, v110
  v_cvt_pk_bf16_f32 v172, v172, v173
  v_cvt_pk_bf16_f32 v173, v174, v175
  v_cvt_pk_bf16_f32 v174, v188, v189
  v_cvt_pk_bf16_f32 v175, v190, v191
  buffer_store_dwordx4 v[172:175], v28, s[8:11], s66 offen offset:1024 sc1
  v_mul_f32 v204, v204, v110
  v_mul_f32 v205, v205, v110
  v_mul_f32 v206, v206, v110
  v_mul_f32 v207, v207, v110
  v_mul_f32 v220, v220, v110
  v_mul_f32 v221, v221, v110
  v_mul_f32 v222, v222, v110
  v_mul_f32 v223, v223, v110
  v_cvt_pk_bf16_f32 v204, v204, v205
  v_cvt_pk_bf16_f32 v205, v206, v207
  v_cvt_pk_bf16_f32 v206, v220, v221
  v_cvt_pk_bf16_f32 v207, v222, v223
  buffer_store_dwordx4 v[204:207], v28, s[8:11], s66 offen offset:2048 sc1
  v_mul_f32 v236, v236, v110
  v_mul_f32 v237, v237, v110
  v_mul_f32 v238, v238, v110
  v_mul_f32 v239, v239, v110
  v_mul_f32 v252, v252, v110
  v_mul_f32 v253, v253, v110
  v_mul_f32 v254, v254, v110
  v_mul_f32 v255, v255, v110
  v_cvt_pk_bf16_f32 v236, v236, v237
  v_cvt_pk_bf16_f32 v237, v238, v239
  v_cvt_pk_bf16_f32 v238, v252, v253
  v_cvt_pk_bf16_f32 v239, v254, v255
  buffer_store_dwordx4 v[236:239], v28, s[8:11], s66 offen offset:3072 sc1
  s_sub_u32 s62, s62, 327680
  s_and_b32 s62, s62, 0xf8000
  s_or_b32 s64, s62, s63
  s_add_u32 m0, s51, 65536
  s_nop 0
  buffer_load_dwordx4 v120, s[24:27], s64 offen lds
  buffer_load_dwordx4 v121, s[24:27], s64 offen offset:1024 lds
  buffer_load_dwordx4 v122, s[24:27], s64 offen offset:2048 lds
  buffer_load_dwordx4 v123, s[24:27], s64 offen offset:3072 lds
  s_add_u32 s62, s62, 32768
  s_and_b32 s62, s62, 0xf8000
  s_or_b32 s64, s62, s63
  s_add_u32 m0, s51, 69632
  s_nop 0
  buffer_load_dwordx4 v120, s[24:27], s64 offen lds
  buffer_load_dwordx4 v121, s[24:27], s64 offen offset:1024 lds
  buffer_load_dwordx4 v122, s[24:27], s64 offen offset:2048 lds
  buffer_load_dwordx4 v123, s[24:27], s64 offen offset:3072 lds
  s_add_u32 s62, s62, 32768
  s_and_b32 s62, s62, 0xf8000
  s_or_b32 s64, s62, s63
  s_add_u32 s62, s62, 262144
  s_and_b32 s62, s62, 0xf8000
  s_or_b32 s64, s62, s63
  s_waitcnt vmcnt(0)
  s_branch L_sback16
L_spin20:
  s_mov_b32 s42, 0
L_splp21:
  buffer_load_dword v12, v13, s[8:11], s69 offen sc1
  s_waitcnt vmcnt(0)
  v_cmp_ne_u32 vcc, s43, v12
  s_nop 1
  s_cbranch_vccz L_back22
  s_add_u32 s42, s42, 1
  s_cmp_lt_u32 s42, 0x40000
  s_cbranch_scc1 L_splp21
  s_branch L_back22
L_spin23:
  s_mov_b32 s42, 0
L_splp24:
  buffer_load_dword v22, v21, s[8:11], s52 offen sc1
  s_waitcnt vmcnt(0)
  v_cmp_ne_u32 vcc, s43, v22
  s_nop 1
  s_cbranch_vccz L_back25
  s_add_u32 s42, s42, 1
  s_cmp_lt_u32 s42, 0x40000
  s_cbranch_scc1 L_splp24
  s_branch L_back25
L_spin26:
  s_mov_b32 s42, 0
L_splp27:
  buffer_load_dwordx4 v[176:179], v28, s[8:11], s65 offen sc1
  buffer_load_dwordx4 v[180:183], v28, s[8:11], s65 offen offset:1024 sc1
  buffer_load_dwordx4 v[184:187], v28, s[8:11], s65 offen offset:2048 sc1
  buffer_load_dwordx4 v[188:191], v28, s[8:11], s16 offen sc1
  buffer_load_dwordx4 v[192:195], v28, s[8:11], s16 offen offset:1024 sc1
  buffer_load_dwordx4 v[196:199], v28, s[8:11], s16 offen offset:2048 sc1
  s_waitcnt vmcnt(0)
  v_min3_u32 v29, v179, v183, v187
  v_max3_u32 v30, v179, v183, v187
  v_min3_u32 v29, v29, v191, v195
  v_max3_u32 v30, v30, v191, v195
  v_min3_u32 v29, v29, v199, s43
  v_max3_u32 v30, v30, v199, s43
  v_cmp_ne_u32 vcc, v29, v30
  s_nop 1
  s_cbranch_vccz L_back28
  s_add_u32 s42, s42, 1
  s_cmp_lt_u32 s42, 0x40000
  s_cbranch_scc1 L_splp27
  s_branch L_back28
L_spin29:
  s_mov_b32 s42, 0
L_splp30:
  buffer_load_dwordx4 v[200:203], v28, s[8:11], s17 offen sc1
  buffer_load_dwordx4 v[204:207], v28, s[8:11], s17 offen offset:1024 sc1
  buffer_load_dwordx4 v[208:211], v28, s[8:11], s17 offen offset:2048 sc1
  s_waitcnt vmcnt(0)
  v_min3_u32 v29, v203, v207, v211
  v_max3_u32 v30, v203, v207, v211
  v_min_u32 v29, s43, v29
  v_max_u32 v30, s43, v30
  v_cmp_ne_u32 vcc, v29, v30
  s_nop 1
  s_cbranch_vccz L_back31
  s_add_u32 s42, s42, 1
  s_cmp_lt_u32 s42, 0x40000
  s_cbranch_scc1 L_splp30
  s_branch L_back31

.section .rodata,"a"
.p2align 6
.amdhsa_kernel recurrent_scan__sliding_block_cached__moe_arch_mod__prompt_kernel
  .amdhsa_next_free_vgpr 512
  .amdhsa_next_free_sgpr 102
  .amdhsa_accum_offset 256
  .amdhsa_group_segment_fixed_size 0
  .amdhsa_kernarg_size 104
  .amdhsa_user_sgpr_count 2
  .amdhsa_user_sgpr_kernarg_segment_ptr 1
  .amdhsa_system_sgpr_workgroup_id_x 1
  .amdhsa_float_denorm_mode_32 3
.end_amdhsa_kernel
```
